```python
import torch

def _softmax(x, axis=-1):
    return torch.softmax(x, dim=axis)
def _gelu(x):
    return torch.nn.functional.gelu(x, approximate="tanh")
def _silu(x):
    return torch.nn.functional.silu(x)
def _sigmoid(x):
    return torch.sigmoid(x)
def _layernorm(x, axis=-1, eps=1e-5):
    m = x.mean(dim=axis, keepdim=True)
    v = x.var(dim=axis, keepdim=True, unbiased=False)
    return (x - m) / torch.sqrt(v + eps)
def _scatter_add(tgt, idx, src, axis=0):
    return tgt.clone().index_add_(axis, idx, src)
def _segment_sum(src, seg, n):
    out = torch.zeros((n,) + src.shape[1:], dtype=src.dtype)
    return out.index_add_(0, seg, src)
def _pad(x, pw):
    flat = tuple(v for pair in reversed(pw) for v in pair)
    return torch.nn.functional.pad(x, flat)

kernel_name = 'concat_heads__mha_block__softmax_full_mha__prompt'

def setup_inputs():

    _w = (lambda a: (lambda t: t.to(torch.bfloat16) if t.is_floating_point() else t)(torch.as_tensor(a)))
    def _A_setup():
        B, S, D, H = 1, 2048, 1024, 32
        return {
            "x": _w((lambda *s: torch.randn(*s, dtype=torch.bfloat16) * 0.2)(B, S, D)),
            "wqkv": _w((lambda *s: torch.randn(*s, dtype=torch.bfloat16) * 0.2)(D, 3 * D)),
            "wo": _w((lambda *s: torch.randn(*s, dtype=torch.bfloat16) * 0.05)(D, D)),
        }
    _A_in = _A_setup()

    def _B_setup():
        B, S, D = 1, 2048, 1024
        return {
            "x": _w((lambda *s: torch.randn(*s, dtype=torch.bfloat16) * 0.2)(B, S, D)),
            "wqkv": _w((lambda *s: torch.randn(*s, dtype=torch.bfloat16) * 0.2)(D, 3 * D)),
            "wo": _w((lambda *s: torch.randn(*s, dtype=torch.bfloat16) * 0.05)(D, D)),
        }
    _B_in = _B_setup()

    return {
        "A_x": _A_in["x"],
        "A_wqkv": _A_in["wqkv"],
        "A_wo": _A_in["wo"],
        "B_x": _B_in["x"],
        "B_wqkv": _B_in["wqkv"],
        "B_wo": _B_in["wo"],
    }

def reference(A_x, A_wqkv, A_wo, B_x, B_wqkv, B_wo):
    def _A_ref(x, wqkv, wo):
        B, S, D = x.shape
        H = 32
        Dh = D // H
        qkv = (lambda x, *d: x.permute(*d))((x @ wqkv).reshape(B, S, 3, H, Dh), 2, 0, 3, 1, 4)
        q, k, v = qkv[0], qkv[1], qkv[2]
        scores = torch.einsum("bhqd,bhkd->bhqk", q, k) * (Dh ** -0.5)
        p = _softmax(scores, axis=-1)
        o = torch.einsum("bhqk,bhkd->bhqd", p, v)
        return (lambda x, *d: x.permute(*d))(o, 0, 2, 1, 3).reshape(B, S, D) @ wo

    def _B_ref(x, wqkv, wo):
        B, S, D = x.shape
        H = 32; Dh = D // H
        qkv = (lambda x, *d: x.permute(*d))((x @ wqkv).reshape(B, S, 3, H, Dh), 2, 0, 3, 1, 4)
        q, k, v = qkv[0], qkv[1], qkv[2]
        scale = Dh ** -0.5
        scores = torch.einsum("bhqd,bhkd->bhqk", q, k) * scale
        p = _softmax(scores, axis=-1)
        o = torch.einsum("bhqk,bhkd->bhqd", p, v)
        return (lambda x, *d: x.permute(*d))(o, 0, 2, 1, 3).reshape(B, S, D) @ wo

    a = _A_ref(A_x, A_wqkv, A_wo)
    b = _B_ref(B_x, B_wqkv, B_wo)
    return torch.concatenate([a, b], axis=-1)
```

```asm
; @launch grid=(256,1,1) block=(512,1,1) lds=163840
.amdgcn_target "amdgcn-amd-amdhsa--gfx950"
.text
.globl concat_heads__mha_block__softmax_full_mha__prompt_kernel
.p2align 8
.type concat_heads__mha_block__softmax_full_mha__prompt_kernel,@function
concat_heads__mha_block__softmax_full_mha__prompt_kernel:
    s_cmp_ge_u32 s2, 256
    s_cbranch_scc1 Lend
    s_load_dwordx16 s[32:47], s[0:1], 0
    v_xor_b32 v2, 256, v0
    v_cmp_gt_u32 vcc, 512, v2
    s_and_saveexec_b64 s[30:31], vcc
    s_cbranch_execz Lepf_e
    s_getpc_b64 s[26:27]
Lpcref0:
    v_lshlrev_b32 v2, 7, v2
    v_min_u32 v2, Lcode_end-Lpcref0-4, v2
    v_mov_b32 v3, s27
    v_add_co_u32 v2, vcc, s26, v2
    s_nop 1
    v_addc_co_u32 v3, vcc, 0, v3, vcc
    global_load_dword v223, v[2:3], off
Lepf_e:
    s_mov_b64 exec, -1
    s_load_dwordx2 s[48:49], s[0:1], 64
    v_lshrrev_b32 v1, 6, v0
    s_and_b32 s26, s2, 7
    s_lshr_b32 s27, s2, 3
    v_readfirstlane_b32 s16, v1
    s_lshr_b32 s17, s26, 2
    s_and_b32 s28, s26, 1
    s_lshl_b32 s28, s28, 2
    s_and_b32 s29, s27, 3
    s_add_u32 s18, s28, s29
    s_bfe_u32 s28, s26, 0x10001
    s_lshl_b32 s28, s28, 3
    s_lshr_b32 s29, s27, 2
    s_add_u32 s19, s28, s29
    v_and_b32 v1, 63, v0
    s_mul_i32 s51, s26, 2
    s_and_b32 s51, s51, 15
    s_lshl_b32 s14, s51, 1
    s_lshl_b32 s15, s51, 7
    s_mov_b32 s64, 0
    s_cmp_lt_u32 s16, 4
    s_cselect_b64 vcc, -1, 0
    s_cbranch_scc0 Lsetup1
    s_setprio 1
Lsetup1:
    s_and_b32 s30, s16, 3
    s_mul_i32 s22, s30, 24576
    s_mul_i32 s26, s30, 3072
    s_add_u32 s23, s26, 98304
    v_lshrrev_b32 v2, 3, v1
    s_lshl_b32 s26, s30, 6
    v_add_u32 v7, s26, v2
    v_and_b32 v3, 7, v1
    v_lshrrev_b32 v4, 4, v1
    v_xor_b32 v5, v3, v4
    v_lshlrev_b32 v5, 4, v5
    v_lshl_add_u32 v184, v7, 11, v5
    v_xor_b32 v5, 64, v5
    v_lshl_add_u32 v185, v7, 11, v5
    v_add_u32 v185, 16384, v185
    v_add_u32 v186, 32768, v184
    v_add_u32 v187, 32768, v185
    v_add_u32 v188, 32768, v186
    v_add_u32 v189, 32768, v187
    v_add_u32 v190, 32768, v188
    v_add_u32 v191, 32768, v189
    s_mul_i32 s26, s30, 24
    v_add_u32 v7, s26, v2
    s_add_u32 s26, s26, 8
    v_lshrrev_b32 v4, 5, v7
    v_and_b32 v7, 31, v7
    v_and_b32 v5, 2, v7
    v_bfe_u32 v6, v7, 3, 1
    v_lshl_or_b32 v5, v6, 2, v5
    v_xor_b32 v5, v3, v5
    v_lshlrev_b32 v5, 4, v5
    v_lshl_add_u32 v5, v4, 11, v5
    v_mul_u32_u24 v7, 6144, v7
    v_add_u32 v212, v7, v5
    v_add_u32 v7, s26, v2
    s_add_u32 s26, s26, 8
    v_lshrrev_b32 v4, 5, v7
    v_and_b32 v7, 31, v7
    v_and_b32 v5, 2, v7
    v_bfe_u32 v6, v7, 3, 1
    v_lshl_or_b32 v5, v6, 2, v5
    v_xor_b32 v5, v3, v5
    v_lshlrev_b32 v5, 4, v5
    v_lshl_add_u32 v5, v4, 11, v5
    v_mul_u32_u24 v7, 6144, v7
    v_add_u32 v213, v7, v5
    v_add_u32 v7, s26, v2
    s_add_u32 s26, s26, 8
    v_lshrrev_b32 v4, 5, v7
    v_and_b32 v7, 31, v7
    v_and_b32 v5, 2, v7
    v_bfe_u32 v6, v7, 3, 1
    v_lshl_or_b32 v5, v6, 2, v5
    v_xor_b32 v5, v3, v5
    v_lshlrev_b32 v5, 4, v5
    v_lshl_add_u32 v5, v4, 11, v5
    v_mul_u32_u24 v7, 6144, v7
    v_add_u32 v214, v7, v5
    s_waitcnt lgkmcnt(0)
    s_cmp_eq_u32 s17, 0
    s_cselect_b32 s26, s32, s38
    s_cselect_b32 s27, s33, s39
    s_cselect_b32 s28, s34, s40
    s_cselect_b32 s29, s35, s41
    s_lshl_b32 s30, s18, 19
    s_add_u32 s4, s26, s30
    s_addc_u32 s5, s27, 0
    s_and_b32 s5, s5, 0xffff
    s_mov_b32 s6, 524288
    s_mov_b32 s7, 0x00020000
    s_lshl_b32 s30, s19, 7
    s_sub_u32 s31, 6291456, s30
    s_add_u32 s8, s28, s30
    s_addc_u32 s9, s29, 0
    s_and_b32 s9, s9, 0xffff
    s_mov_b32 s10, s31
    s_mov_b32 s11, 0x00020000
    s_cbranch_vccz Lskip3
    s_add_u32 s20, s15, 0
    s_add_u32 m0, s22, 0
    s_and_b32 s20, s20, 0x780
    buffer_load_dwordx4 v184, s[4:7], s20 offen lds
    s_add_u32 m0, s22, 1024
    s_nop 0
    buffer_load_dwordx4 v185, s[4:7], s20 offen lds
    s_add_u32 m0, s22, 2048
    s_nop 0
    buffer_load_dwordx4 v186, s[4:7], s20 offen lds
    s_add_u32 m0, s22, 3072
    s_nop 0
    buffer_load_dwordx4 v187, s[4:7], s20 offen lds
    s_add_u32 m0, s22, 4096
    s_nop 0
    buffer_load_dwordx4 v188, s[4:7], s20 offen lds
    s_add_u32 m0, s22, 5120
    s_nop 0
    buffer_load_dwordx4 v189, s[4:7], s20 offen lds
    s_add_u32 m0, s22, 6144
    s_nop 0
    buffer_load_dwordx4 v190, s[4:7], s20 offen lds
    s_add_u32 m0, s22, 7168
    s_nop 0
    buffer_load_dwordx4 v191, s[4:7], s20 offen lds
Lskip3:
    s_cbranch_vccz Lskip4
    s_add_u32 s21, s14, 0
    s_and_b32 s21, s21, 31
    s_add_u32 m0, s23, 0
    s_mul_i32 s21, s21, 196608
    buffer_load_dwordx4 v212, s[8:11], s21 offen lds
    s_add_u32 m0, s23, 1024
    s_nop 0
    buffer_load_dwordx4 v213, s[8:11], s21 offen lds
    s_add_u32 m0, s23, 2048
    s_nop 0
    buffer_load_dwordx4 v214, s[8:11], s21 offen lds
Lskip4:
    s_and_b32 s30, s16, 3
    s_mul_i32 s30, s30, 24576
    v_and_b32 v2, 15, v1
    v_lshrrev_b32 v4, 4, v1
    v_lshrrev_b32 v5, 1, v2
    v_xor_b32 v5, v4, v5
    v_lshlrev_b32 v5, 4, v5
    v_lshl_add_u32 v5, v2, 7, v5
    v_add_u32 v208, s30, v5
    v_xor_b32 v209, 64, v208
    v_bfe_u32 v2, v1, 2, 2
    v_and_b32 v3, 3, v1
    v_lshl_add_u32 v5, v4, 3, v2
    v_lshrrev_b32 v6, 1, v2
    v_and_b32 v7, 1, v4
    v_lshl_or_b32 v6, v7, 1, v6
    s_lshr_b32 s30, s16, 2
    s_lshl_b32 s30, s30, 1
    v_xor_b32 v6, s30, v6
    v_lshlrev_b32 v6, 5, v6
    v_lshl_add_u32 v6, v3, 3, v6
    v_lshl_add_u32 v6, v5, 7, v6
    v_add_u32 v210, 98304, v6
    v_xor_b32 v211, 32, v210
    s_lshr_b32 s30, s18, 2
    s_lshl_b32 s30, s30, 21
    s_add_u32 s52, s26, s30
    s_addc_u32 s53, s27, 0
    s_and_b32 s53, s53, 0xffff
    s_mov_b32 s54, 2097152
    s_mov_b32 s55, 0x00020000
    s_lshr_b32 s30, s19, 3
    s_lshl_b32 s30, s30, 10
    s_sub_u32 s31, 6291456, s30
    s_add_u32 s56, s28, s30
    s_addc_u32 s57, s29, 0
    s_and_b32 s57, s57, 0xffff
    s_mov_b32 s58, s31
    s_mov_b32 s59, 0x00020000
    s_lshr_b32 s12, s2, 3
    s_lshl_b32 s12, s12, 3
    s_add_u32 s12, s12, s16
    v_lshlrev_b32 v218, 11, v1
    v_add_u32 v218, 384, v218
    v_and_b32 v2, 3, v1
    v_lshlrev_b32 v2, 11, v2
    v_bfe_u32 v3, v1, 2, 1
    v_lshl_add_u32 v2, v3, 10, v2
    s_lshl_b32 s13, s12, 13
    s_add_u32 s13, s13, 384
    v_add_u32 v219, s13, v2
    s_lshl_b32 s13, s51, 6
    s_add_u32 s12, s12, s13
    v_mov_b32 v221, 0
    s_or_b32 s26, s2, s16
    s_cmp_lg_u32 s26, 0
    s_cbranch_scc1 Lnononce
    s_memrealtime s[26:27]
    s_mov_b32 s28, s46
    s_and_b32 s29, s47, 0xffff
    s_mov_b32 s30, 256
    s_mov_b32 s31, 0x00020000
    s_waitcnt lgkmcnt(0)
    s_or_b32 s26, s26, 1
    v_mov_b32 v2, s26
    v_mov_b32 v3, s27
    s_mov_b64 exec, 1
    buffer_store_dwordx2 v[2:3], v221, s[28:31], 0 offen sc1
    s_mov_b64 exec, -1
Lnononce:
    s_add_u32 s13, s12, 0
    s_and_b32 s13, s13, 1023
    s_mov_b64 exec, 7
    s_mul_i32 s13, s13, 6144
    buffer_load_dword v223, v218, s[56:59], s13 offen
    s_mov_b64 exec, -1
    s_barrier
    s_cbranch_vccz Lskip5
    s_add_u32 s21, s14, 1
    s_and_b32 s21, s21, 31
    s_add_u32 m0, s23, 12288
    s_mul_i32 s21, s21, 196608
    buffer_load_dwordx4 v212, s[8:11], s21 offen lds
    s_add_u32 m0, s23, 13312
    s_nop 0
    buffer_load_dwordx4 v213, s[8:11], s21 offen lds
    s_add_u32 m0, s23, 14336
    s_nop 0
    buffer_load_dwordx4 v214, s[8:11], s21 offen lds
Lskip5:
    s_cbranch_vccz Lskip6
    s_add_u32 s20, s15, 128
    s_add_u32 m0, s22, 8192
    s_and_b32 s20, s20, 0x780
    buffer_load_dwordx4 v184, s[4:7], s20 offen lds
    s_add_u32 m0, s22, 9216
    s_nop 0
    buffer_load_dwordx4 v185, s[4:7], s20 offen lds
    s_add_u32 m0, s22, 10240
    s_nop 0
    buffer_load_dwordx4 v186, s[4:7], s20 offen lds
    s_add_u32 m0, s22, 11264
    s_nop 0
    buffer_load_dwordx4 v187, s[4:7], s20 offen lds
    s_add_u32 m0, s22, 12288
    s_nop 0
    buffer_load_dwordx4 v188, s[4:7], s20 offen lds
    s_add_u32 m0, s22, 13312
    s_nop 0
    buffer_load_dwordx4 v189, s[4:7], s20 offen lds
    s_add_u32 m0, s22, 14336
    s_nop 0
    buffer_load_dwordx4 v190, s[4:7], s20 offen lds
    s_add_u32 m0, s22, 15360
    s_nop 0
    buffer_load_dwordx4 v191, s[4:7], s20 offen lds
Lskip6:
    s_cbranch_vccz Lskip7
    s_add_u32 s21, s14, 2
    s_and_b32 s21, s21, 31
    s_add_u32 m0, s23, 24576
    s_mul_i32 s21, s21, 196608
    buffer_load_dwordx4 v212, s[8:11], s21 offen lds
    s_add_u32 m0, s23, 25600
    s_nop 0
    buffer_load_dwordx4 v213, s[8:11], s21 offen lds
    s_add_u32 m0, s23, 26624
    s_nop 0
    buffer_load_dwordx4 v214, s[8:11], s21 offen lds
Lskip7:
    s_waitcnt vmcnt(15)
    s_barrier
    ds_read_b128 v[104:107], v208 offset:0
    ds_read_b64_tr_b16 v[120:121], v210 offset:0
    ds_read_b64_tr_b16 v[122:123], v210 offset:512
    ds_read_b64_tr_b16 v[124:125], v211 offset:0
    ds_read_b64_tr_b16 v[126:127], v211 offset:512
    ds_read_b64_tr_b16 v[128:129], v210 offset:4096
    ds_read_b64_tr_b16 v[130:131], v210 offset:4608
    ds_read_b128 v[108:111], v208 offset:2048
    ds_read_b64_tr_b16 v[132:133], v211 offset:4096
    ds_read_b64_tr_b16 v[134:135], v211 offset:4608
    ds_read_b64_tr_b16 v[136:137], v210 offset:8192
    ds_read_b64_tr_b16 v[138:139], v210 offset:8704
    ds_read_b64_tr_b16 v[140:141], v211 offset:8192
    ds_read_b64_tr_b16 v[142:143], v211 offset:8704
    ds_read_b128 v[112:115], v208 offset:4096
    ds_read_b128 v[116:119], v208 offset:6144
    s_waitcnt vmcnt(11) lgkmcnt(0)
    s_barrier
    v_mfma_f32_16x16x32_bf16 v[8:11], v[120:123], v[104:107], 0
    ds_read_b128 v[144:147], v209 offset:0
    v_mfma_f32_16x16x32_bf16 v[12:15], v[124:127], v[104:107], 0
    ds_read_b64_tr_b16 v[160:161], v210 offset:12288
    s_cbranch_vccz Lskip8
    s_add_u32 s21, s14, 3
    s_and_b32 s21, s21, 31
    s_add_u32 m0, s23, 36864
    s_mul_i32 s21, s21, 196608
    buffer_load_dwordx4 v212, s[8:11], s21 offen lds
    s_add_u32 m0, s23, 37888
    s_nop 0
    buffer_load_dwordx4 v213, s[8:11], s21 offen lds
    s_add_u32 m0, s23, 38912
    s_nop 0
    buffer_load_dwordx4 v214, s[8:11], s21 offen lds
Lskip8:
    v_mfma_f32_16x16x32_bf16 v[16:19], v[128:131], v[104:107], 0
    ds_read_b64_tr_b16 v[162:163], v210 offset:12800
    v_mfma_f32_16x16x32_bf16 v[20:23], v[132:135], v[104:107], 0
    ds_read_b64_tr_b16 v[164:165], v211 offset:12288
    v_mfma_f32_16x16x32_bf16 v[44:47], v[132:135], v[108:111], 0
    ds_read_b64_tr_b16 v[166:167], v211 offset:12800
    v_mfma_f32_16x16x32_bf16 v[40:43], v[128:131], v[108:111], 0
    ds_read_b64_tr_b16 v[168:169], v210 offset:16384
    v_mfma_f32_16x16x32_bf16 v[36:39], v[124:127], v[108:111], 0
    ds_read_b64_tr_b16 v[170:171], v210 offset:16896
    v_mfma_f32_16x16x32_bf16 v[32:35], v[120:123], v[108:111], 0
    ds_read_b128 v[148:151], v209 offset:2048
    v_mfma_f32_16x16x32_bf16 v[56:59], v[120:123], v[112:115], 0
    ds_read_b64_tr_b16 v[172:173], v211 offset:16384
    v_mfma_f32_16x16x32_bf16 v[60:63], v[124:127], v[112:115], 0
    ds_read_b64_tr_b16 v[174:175], v211 offset:16896
    v_mfma_f32_16x16x32_bf16 v[64:67], v[128:131], v[112:115], 0
    ds_read_b64_tr_b16 v[176:177], v210 offset:20480
    v_mfma_f32_16x16x32_bf16 v[68:71], v[132:135], v[112:115], 0
    ds_read_b64_tr_b16 v[178:179], v210 offset:20992
    s_cbranch_vccz Lskip9
    s_add_u32 s20, s15, 256
    s_add_u32 m0, s22, 16384
    s_and_b32 s20, s20, 0x780
    buffer_load_dwordx4 v184, s[4:7], s20 offen lds
    s_add_u32 m0, s22, 17408
    s_nop 0
    buffer_load_dwordx4 v185, s[4:7], s20 offen lds
    s_add_u32 m0, s22, 18432
    s_nop 0
    buffer_load_dwordx4 v186, s[4:7], s20 offen lds
    s_add_u32 m0, s22, 19456
    s_nop 0
    buffer_load_dwordx4 v187, s[4:7], s20 offen lds
    s_add_u32 m0, s22, 20480
    s_nop 0
    buffer_load_dwordx4 v188, s[4:7], s20 offen lds
    s_add_u32 m0, s22, 21504
    s_nop 0
    buffer_load_dwordx4 v189, s[4:7], s20 offen lds
    s_add_u32 m0, s22, 22528
    s_nop 0
    buffer_load_dwordx4 v190, s[4:7], s20 offen lds
    s_add_u32 m0, s22, 23552
    s_nop 0
    buffer_load_dwordx4 v191, s[4:7], s20 offen lds
Lskip9:
    v_mfma_f32_16x16x32_bf16 v[92:95], v[132:135], v[116:119], 0
    ds_read_b64_tr_b16 v[180:181], v211 offset:20480
    v_mfma_f32_16x16x32_bf16 v[88:91], v[128:131], v[116:119], 0
    ds_read_b64_tr_b16 v[182:183], v211 offset:20992
    v_mfma_f32_16x16x32_bf16 v[84:87], v[124:127], v[116:119], 0
    ds_read_b128 v[152:155], v209 offset:4096
    v_mfma_f32_16x16x32_bf16 v[80:83], v[120:123], v[116:119], 0
    ds_read_b128 v[156:159], v209 offset:6144
    v_mfma_f32_16x16x32_bf16 v[96:99], v[116:119], v[136:139], 0
    v_mfma_f32_16x16x32_bf16 v[100:103], v[116:119], v[140:143], 0
    v_mfma_f32_16x16x32_bf16 v[76:79], v[112:115], v[140:143], 0
    v_mfma_f32_16x16x32_bf16 v[72:75], v[112:115], v[136:139], 0
    v_mfma_f32_16x16x32_bf16 v[48:51], v[108:111], v[136:139], 0
    v_mfma_f32_16x16x32_bf16 v[52:55], v[108:111], v[140:143], 0
    s_add_u32 s13, s12, 256
    s_and_b32 s13, s13, 1023
    s_mov_b64 exec, 7
    s_mul_i32 s13, s13, 6144
    buffer_load_dword v223, v218, s[56:59], s13 offen
    s_mov_b64 exec, -1
    v_mfma_f32_16x16x32_bf16 v[28:31], v[104:107], v[140:143], 0
    v_mfma_f32_16x16x32_bf16 v[24:27], v[104:107], v[136:139], 0
    s_waitcnt vmcnt(9) lgkmcnt(0)
    s_barrier
    v_mfma_f32_16x16x32_bf16 v[8:11], v[160:163], v[144:147], v[8:11]
    ds_read_b128 v[104:107], v208 offset:8192
    v_mfma_f32_16x16x32_bf16 v[12:15], v[164:167], v[144:147], v[12:15]
    ds_read_b64_tr_b16 v[120:121], v210 offset:24576
    s_cbranch_vccz Lskip10
    s_add_u32 s21, s14, 4
    s_and_b32 s21, s21, 31
    s_add_u32 m0, s23, 49152
    s_mul_i32 s21, s21, 196608
    buffer_load_dwordx4 v212, s[8:11], s21 offen lds
    s_add_u32 m0, s23, 50176
    s_nop 0
    buffer_load_dwordx4 v213, s[8:11], s21 offen lds
    s_add_u32 m0, s23, 51200
    s_nop 0
    buffer_load_dwordx4 v214, s[8:11], s21 offen lds
Lskip10:
    v_mfma_f32_16x16x32_bf16 v[16:19], v[168:171], v[144:147], v[16:19]
    ds_read_b64_tr_b16 v[122:123], v210 offset:25088
    v_mfma_f32_16x16x32_bf16 v[20:23], v[172:175], v[144:147], v[20:23]
    ds_read_b64_tr_b16 v[124:125], v211 offset:24576
    v_mfma_f32_16x16x32_bf16 v[44:47], v[172:175], v[148:151], v[44:47]
    ds_read_b64_tr_b16 v[126:127], v211 offset:25088
    v_mfma_f32_16x16x32_bf16 v[40:43], v[168:171], v[148:151], v[40:43]
    ds_read_b64_tr_b16 v[128:129], v210 offset:28672
    v_mfma_f32_16x16x32_bf16 v[36:39], v[164:167], v[148:151], v[36:39]
    ds_read_b64_tr_b16 v[130:131], v210 offset:29184
    v_mfma_f32_16x16x32_bf16 v[32:35], v[160:163], v[148:151], v[32:35]
    ds_read_b128 v[108:111], v208 offset:10240
    v_mfma_f32_16x16x32_bf16 v[56:59], v[160:163], v[152:155], v[56:59]
    ds_read_b64_tr_b16 v[132:133], v211 offset:28672
    v_mfma_f32_16x16x32_bf16 v[60:63], v[164:167], v[152:155], v[60:63]
    ds_read_b64_tr_b16 v[134:135], v211 offset:29184
    v_mfma_f32_16x16x32_bf16 v[64:67], v[168:171], v[152:155], v[64:67]
    ds_read_b64_tr_b16 v[136:137], v210 offset:32768
    v_mfma_f32_16x16x32_bf16 v[68:71], v[172:175], v[152:155], v[68:71]
    ds_read_b64_tr_b16 v[138:139], v210 offset:33280
    s_cbranch_vccz Lskip11
    s_add_u32 s21, s14, 5
    s_and_b32 s21, s21, 31
    s_add_u32 m0, s23, 0
    s_mul_i32 s21, s21, 196608
    buffer_load_dwordx4 v212, s[8:11], s21 offen lds
    s_add_u32 m0, s23, 1024
    s_nop 0
    buffer_load_dwordx4 v213, s[8:11], s21 offen lds
    s_add_u32 m0, s23, 2048
    s_nop 0
    buffer_load_dwordx4 v214, s[8:11], s21 offen lds
Lskip11:
    v_mfma_f32_16x16x32_bf16 v[92:95], v[172:175], v[156:159], v[92:95]
    ds_read_b64_tr_b16 v[140:141], v211 offset:32768
    v_mfma_f32_16x16x32_bf16 v[88:91], v[168:171], v[156:159], v[88:91]
    ds_read_b64_tr_b16 v[142:143], v211 offset:33280
    v_mfma_f32_16x16x32_bf16 v[84:87], v[164:167], v[156:159], v[84:87]
    ds_read_b128 v[112:115], v208 offset:12288
    v_mfma_f32_16x16x32_bf16 v[80:83], v[160:163], v[156:159], v[80:83]
    ds_read_b128 v[116:119], v208 offset:14336
    v_mfma_f32_16x16x32_bf16 v[96:99], v[156:159], v[176:179], v[96:99]
    v_mfma_f32_16x16x32_bf16 v[100:103], v[156:159], v[180:183], v[100:103]
    v_mfma_f32_16x16x32_bf16 v[76:79], v[152:155], v[180:183], v[76:79]
    v_mfma_f32_16x16x32_bf16 v[72:75], v[152:155], v[176:179], v[72:75]
    v_mfma_f32_16x16x32_bf16 v[48:51], v[148:151], v[176:179], v[48:51]
    v_mfma_f32_16x16x32_bf16 v[52:55], v[148:151], v[180:183], v[52:55]
    s_cbranch_vccz Lskip12
    s_add_u32 s20, s15, 384
    s_add_u32 m0, s22, 0
    s_and_b32 s20, s20, 0x780
    buffer_load_dwordx4 v184, s[4:7], s20 offen lds
    s_add_u32 m0, s22, 1024
    s_nop 0
    buffer_load_dwordx4 v185, s[4:7], s20 offen lds
    s_add_u32 m0, s22, 2048
    s_nop 0
    buffer_load_dwordx4 v186, s[4:7], s20 offen lds
    s_add_u32 m0, s22, 3072
    s_nop 0
    buffer_load_dwordx4 v187, s[4:7], s20 offen lds
Lskip12:
    v_mfma_f32_16x16x32_bf16 v[28:31], v[144:147], v[180:183], v[28:31]
    v_mfma_f32_16x16x32_bf16 v[24:27], v[144:147], v[176:179], v[24:27]
    s_waitcnt lgkmcnt(0)
    v_mfma_f32_16x16x32_bf16 v[8:11], v[120:123], v[104:107], v[8:11]
    ds_read_b128 v[144:147], v209 offset:8192
    v_mfma_f32_16x16x32_bf16 v[12:15], v[124:127], v[104:107], v[12:15]
    ds_read_b64_tr_b16 v[160:161], v210 offset:36864
    s_cbranch_vccz Lskip13
    s_add_u32 s21, s14, 6
    s_and_b32 s21, s21, 31
    s_add_u32 m0, s23, 12288
    s_mul_i32 s21, s21, 196608
    buffer_load_dwordx4 v212, s[8:11], s21 offen lds
    s_add_u32 m0, s23, 13312
    s_nop 0
    buffer_load_dwordx4 v213, s[8:11], s21 offen lds
    s_add_u32 m0, s23, 14336
    s_nop 0
    buffer_load_dwordx4 v214, s[8:11], s21 offen lds
Lskip13:
    v_mfma_f32_16x16x32_bf16 v[16:19], v[128:131], v[104:107], v[16:19]
    ds_read_b64_tr_b16 v[162:163], v210 offset:37376
    v_mfma_f32_16x16x32_bf16 v[20:23], v[132:135], v[104:107], v[20:23]
    ds_read_b64_tr_b16 v[164:165], v211 offset:36864
    v_mfma_f32_16x16x32_bf16 v[44:47], v[132:135], v[108:111], v[44:47]
    ds_read_b64_tr_b16 v[166:167], v211 offset:37376
    v_mfma_f32_16x16x32_bf16 v[40:43], v[128:131], v[108:111], v[40:43]
    ds_read_b64_tr_b16 v[168:169], v210 offset:40960
    v_mfma_f32_16x16x32_bf16 v[36:39], v[124:127], v[108:111], v[36:39]
    ds_read_b64_tr_b16 v[170:171], v210 offset:41472
    v_mfma_f32_16x16x32_bf16 v[32:35], v[120:123], v[108:111], v[32:35]
    ds_read_b128 v[148:151], v209 offset:10240
    v_mfma_f32_16x16x32_bf16 v[56:59], v[120:123], v[112:115], v[56:59]
    ds_read_b64_tr_b16 v[172:173], v211 offset:40960
    v_mfma_f32_16x16x32_bf16 v[60:63], v[124:127], v[112:115], v[60:63]
    ds_read_b64_tr_b16 v[174:175], v211 offset:41472
    v_mfma_f32_16x16x32_bf16 v[64:67], v[128:131], v[112:115], v[64:67]
    ds_read_b64_tr_b16 v[176:177], v210 offset:45056
    v_mfma_f32_16x16x32_bf16 v[68:71], v[132:135], v[112:115], v[68:71]
    ds_read_b64_tr_b16 v[178:179], v210 offset:45568
    s_cbranch_vccz Lskip14
    s_add_u32 s20, s15, 384
    s_add_u32 m0, s22, 4096
    s_and_b32 s20, s20, 0x780
    buffer_load_dwordx4 v188, s[4:7], s20 offen lds
    s_add_u32 m0, s22, 5120
    s_nop 0
    buffer_load_dwordx4 v189, s[4:7], s20 offen lds
    s_add_u32 m0, s22, 6144
    s_nop 0
    buffer_load_dwordx4 v190, s[4:7], s20 offen lds
    s_add_u32 m0, s22, 7168
    s_nop 0
    buffer_load_dwordx4 v191, s[4:7], s20 offen lds
Lskip14:
    v_mfma_f32_16x16x32_bf16 v[92:95], v[132:135], v[116:119], v[92:95]
    ds_read_b64_tr_b16 v[180:181], v211 offset:45056
    v_mfma_f32_16x16x32_bf16 v[88:91], v[128:131], v[116:119], v[88:91]
    ds_read_b64_tr_b16 v[182:183], v211 offset:45568
    v_mfma_f32_16x16x32_bf16 v[84:87], v[124:127], v[116:119], v[84:87]
    ds_read_b128 v[152:155], v209 offset:12288
    v_mfma_f32_16x16x32_bf16 v[80:83], v[120:123], v[116:119], v[80:83]
    ds_read_b128 v[156:159], v209 offset:14336
    v_mfma_f32_16x16x32_bf16 v[96:99], v[116:119], v[136:139], v[96:99]
    v_mfma_f32_16x16x32_bf16 v[100:103], v[116:119], v[140:143], v[100:103]
    v_mfma_f32_16x16x32_bf16 v[76:79], v[112:115], v[140:143], v[76:79]
    v_mfma_f32_16x16x32_bf16 v[72:75], v[112:115], v[136:139], v[72:75]
    v_mfma_f32_16x16x32_bf16 v[48:51], v[108:111], v[136:139], v[48:51]
    v_mfma_f32_16x16x32_bf16 v[52:55], v[108:111], v[140:143], v[52:55]
    v_mfma_f32_16x16x32_bf16 v[28:31], v[104:107], v[140:143], v[28:31]
    v_mfma_f32_16x16x32_bf16 v[24:27], v[104:107], v[136:139], v[24:27]
    s_waitcnt vmcnt(11) lgkmcnt(0)
    s_barrier
    v_mfma_f32_16x16x32_bf16 v[8:11], v[160:163], v[144:147], v[8:11]
    ds_read_b128 v[104:107], v208 offset:16384
    v_mfma_f32_16x16x32_bf16 v[12:15], v[164:167], v[144:147], v[12:15]
    ds_read_b64_tr_b16 v[120:121], v210 offset:49152
    s_cbranch_vccz Lskip15
    s_add_u32 s21, s14, 7
    s_and_b32 s21, s21, 31
    s_add_u32 m0, s23, 24576
    s_mul_i32 s21, s21, 196608
    buffer_load_dwordx4 v212, s[8:11], s21 offen lds
    s_add_u32 m0, s23, 25600
    s_nop 0
    buffer_load_dwordx4 v213, s[8:11], s21 offen lds
    s_add_u32 m0, s23, 26624
    s_nop 0
    buffer_load_dwordx4 v214, s[8:11], s21 offen lds
Lskip15:
    v_mfma_f32_16x16x32_bf16 v[16:19], v[168:171], v[144:147], v[16:19]
    ds_read_b64_tr_b16 v[122:123], v210 offset:49664
    v_mfma_f32_16x16x32_bf16 v[20:23], v[172:175], v[144:147], v[20:23]
    ds_read_b64_tr_b16 v[124:125], v211 offset:49152
    v_mfma_f32_16x16x32_bf16 v[44:47], v[172:175], v[148:151], v[44:47]
    ds_read_b64_tr_b16 v[126:127], v211 offset:49664
    v_mfma_f32_16x16x32_bf16 v[40:43], v[168:171], v[148:151], v[40:43]
    ds_read_b64_tr_b16 v[128:129], v210 offset:53248
    v_mfma_f32_16x16x32_bf16 v[36:39], v[164:167], v[148:151], v[36:39]
    ds_read_b64_tr_b16 v[130:131], v210 offset:53760
    v_mfma_f32_16x16x32_bf16 v[32:35], v[160:163], v[148:151], v[32:35]
    ds_read_b128 v[108:111], v208 offset:18432
    v_mfma_f32_16x16x32_bf16 v[56:59], v[160:163], v[152:155], v[56:59]
    ds_read_b64_tr_b16 v[132:133], v211 offset:53248
    v_mfma_f32_16x16x32_bf16 v[60:63], v[164:167], v[152:155], v[60:63]
    ds_read_b64_tr_b16 v[134:135], v211 offset:53760
    v_mfma_f32_16x16x32_bf16 v[64:67], v[168:171], v[152:155], v[64:67]
    ds_read_b64_tr_b16 v[136:137], v210 offset:57344
    v_mfma_f32_16x16x32_bf16 v[68:71], v[172:175], v[152:155], v[68:71]
    ds_read_b64_tr_b16 v[138:139], v210 offset:57856
    s_cbranch_vccz Lskip16
    s_add_u32 s20, s15, 512
    s_add_u32 m0, s22, 8192
    s_and_b32 s20, s20, 0x780
    buffer_load_dwordx4 v184, s[4:7], s20 offen lds
    s_add_u32 m0, s22, 9216
    s_nop 0
    buffer_load_dwordx4 v185, s[4:7], s20 offen lds
    s_add_u32 m0, s22, 10240
    s_nop 0
    buffer_load_dwordx4 v186, s[4:7], s20 offen lds
    s_add_u32 m0, s22, 11264
    s_nop 0
    buffer_load_dwordx4 v187, s[4:7], s20 offen lds
Lskip16:
    v_mfma_f32_16x16x32_bf16 v[92:95], v[172:175], v[156:159], v[92:95]
    ds_read_b64_tr_b16 v[140:141], v211 offset:57344
    v_mfma_f32_16x16x32_bf16 v[88:91], v[168:171], v[156:159], v[88:91]
    ds_read_b64_tr_b16 v[142:143], v211 offset:57856
    v_mfma_f32_16x16x32_bf16 v[84:87], v[164:167], v[156:159], v[84:87]
    ds_read_b128 v[112:115], v208 offset:20480
    v_mfma_f32_16x16x32_bf16 v[80:83], v[160:163], v[156:159], v[80:83]
    ds_read_b128 v[116:119], v208 offset:22528
    v_mfma_f32_16x16x32_bf16 v[96:99], v[156:159], v[176:179], v[96:99]
    v_mfma_f32_16x16x32_bf16 v[100:103], v[156:159], v[180:183], v[100:103]
    v_mfma_f32_16x16x32_bf16 v[76:79], v[152:155], v[180:183], v[76:79]
    v_mfma_f32_16x16x32_bf16 v[72:75], v[152:155], v[176:179], v[72:75]
    v_mfma_f32_16x16x32_bf16 v[48:51], v[148:151], v[176:179], v[48:51]
    v_mfma_f32_16x16x32_bf16 v[52:55], v[148:151], v[180:183], v[52:55]
    v_mfma_f32_16x16x32_bf16 v[28:31], v[144:147], v[180:183], v[28:31]
    v_mfma_f32_16x16x32_bf16 v[24:27], v[144:147], v[176:179], v[24:27]
    s_waitcnt lgkmcnt(0)
    v_mfma_f32_16x16x32_bf16 v[8:11], v[120:123], v[104:107], v[8:11]
    ds_read_b128 v[144:147], v209 offset:16384
    v_mfma_f32_16x16x32_bf16 v[12:15], v[124:127], v[104:107], v[12:15]
    ds_read_b64_tr_b16 v[160:161], v210 offset:0
    s_cbranch_vccz Lskip17
    s_add_u32 s21, s14, 8
    s_and_b32 s21, s21, 31
    s_add_u32 m0, s23, 36864
    s_mul_i32 s21, s21, 196608
    buffer_load_dwordx4 v212, s[8:11], s21 offen lds
    s_add_u32 m0, s23, 37888
    s_nop 0
    buffer_load_dwordx4 v213, s[8:11], s21 offen lds
    s_add_u32 m0, s23, 38912
    s_nop 0
    buffer_load_dwordx4 v214, s[8:11], s21 offen lds
Lskip17:
    v_mfma_f32_16x16x32_bf16 v[16:19], v[128:131], v[104:107], v[16:19]
    ds_read_b64_tr_b16 v[162:163], v210 offset:512
    v_mfma_f32_16x16x32_bf16 v[20:23], v[132:135], v[104:107], v[20:23]
    ds_read_b64_tr_b16 v[164:165], v211 offset:0
    v_mfma_f32_16x16x32_bf16 v[44:47], v[132:135], v[108:111], v[44:47]
    ds_read_b64_tr_b16 v[166:167], v211 offset:512
    v_mfma_f32_16x16x32_bf16 v[40:43], v[128:131], v[108:111], v[40:43]
    ds_read_b64_tr_b16 v[168:169], v210 offset:4096
    v_mfma_f32_16x16x32_bf16 v[36:39], v[124:127], v[108:111], v[36:39]
    ds_read_b64_tr_b16 v[170:171], v210 offset:4608
    v_mfma_f32_16x16x32_bf16 v[32:35], v[120:123], v[108:111], v[32:35]
    ds_read_b128 v[148:151], v209 offset:18432
    v_mfma_f32_16x16x32_bf16 v[56:59], v[120:123], v[112:115], v[56:59]
    ds_read_b64_tr_b16 v[172:173], v211 offset:4096
    v_mfma_f32_16x16x32_bf16 v[60:63], v[124:127], v[112:115], v[60:63]
    ds_read_b64_tr_b16 v[174:175], v211 offset:4608
    v_mfma_f32_16x16x32_bf16 v[64:67], v[128:131], v[112:115], v[64:67]
    ds_read_b64_tr_b16 v[176:177], v210 offset:8192
    v_mfma_f32_16x16x32_bf16 v[68:71], v[132:135], v[112:115], v[68:71]
    ds_read_b64_tr_b16 v[178:179], v210 offset:8704
    s_cbranch_vccz Lskip18
    s_add_u32 s20, s15, 512
    s_add_u32 m0, s22, 12288
    s_and_b32 s20, s20, 0x780
    buffer_load_dwordx4 v188, s[4:7], s20 offen lds
    s_add_u32 m0, s22, 13312
    s_nop 0
    buffer_load_dwordx4 v189, s[4:7], s20 offen lds
    s_add_u32 m0, s22, 14336
    s_nop 0
    buffer_load_dwordx4 v190, s[4:7], s20 offen lds
    s_add_u32 m0, s22, 15360
    s_nop 0
    buffer_load_dwordx4 v191, s[4:7], s20 offen lds
Lskip18:
    v_mfma_f32_16x16x32_bf16 v[92:95], v[132:135], v[116:119], v[92:95]
    ds_read_b64_tr_b16 v[180:181], v211 offset:8192
    v_mfma_f32_16x16x32_bf16 v[88:91], v[128:131], v[116:119], v[88:91]
    ds_read_b64_tr_b16 v[182:183], v211 offset:8704
    v_mfma_f32_16x16x32_bf16 v[84:87], v[124:127], v[116:119], v[84:87]
    ds_read_b128 v[152:155], v209 offset:20480
    v_mfma_f32_16x16x32_bf16 v[80:83], v[120:123], v[116:119], v[80:83]
    ds_read_b128 v[156:159], v209 offset:22528
    v_mfma_f32_16x16x32_bf16 v[96:99], v[116:119], v[136:139], v[96:99]
    v_mfma_f32_16x16x32_bf16 v[100:103], v[116:119], v[140:143], v[100:103]
    v_mfma_f32_16x16x32_bf16 v[76:79], v[112:115], v[140:143], v[76:79]
    v_mfma_f32_16x16x32_bf16 v[72:75], v[112:115], v[136:139], v[72:75]
    v_mfma_f32_16x16x32_bf16 v[48:51], v[108:111], v[136:139], v[48:51]
    v_mfma_f32_16x16x32_bf16 v[52:55], v[108:111], v[140:143], v[52:55]
    v_mfma_f32_16x16x32_bf16 v[28:31], v[104:107], v[140:143], v[28:31]
    v_mfma_f32_16x16x32_bf16 v[24:27], v[104:107], v[136:139], v[24:27]
    s_waitcnt vmcnt(11) lgkmcnt(0)
    s_barrier
    v_mfma_f32_16x16x32_bf16 v[8:11], v[160:163], v[144:147], v[8:11]
    ds_read_b128 v[104:107], v208 offset:0
    v_mfma_f32_16x16x32_bf16 v[12:15], v[164:167], v[144:147], v[12:15]
    ds_read_b64_tr_b16 v[120:121], v210 offset:12288
    s_cbranch_vccz Lskip19
    s_add_u32 s21, s14, 9
    s_and_b32 s21, s21, 31
    s_add_u32 m0, s23, 49152
    s_mul_i32 s21, s21, 196608
    buffer_load_dwordx4 v212, s[8:11], s21 offen lds
    s_add_u32 m0, s23, 50176
    s_nop 0
    buffer_load_dwordx4 v213, s[8:11], s21 offen lds
    s_add_u32 m0, s23, 51200
    s_nop 0
    buffer_load_dwordx4 v214, s[8:11], s21 offen lds
Lskip19:
    v_mfma_f32_16x16x32_bf16 v[16:19], v[168:171], v[144:147], v[16:19]
    ds_read_b64_tr_b16 v[122:123], v210 offset:12800
    v_mfma_f32_16x16x32_bf16 v[20:23], v[172:175], v[144:147], v[20:23]
    ds_read_b64_tr_b16 v[124:125], v211 offset:12288
    v_mfma_f32_16x16x32_bf16 v[44:47], v[172:175], v[148:151], v[44:47]
    ds_read_b64_tr_b16 v[126:127], v211 offset:12800
    v_mfma_f32_16x16x32_bf16 v[40:43], v[168:171], v[148:151], v[40:43]
    ds_read_b64_tr_b16 v[128:129], v210 offset:16384
    v_mfma_f32_16x16x32_bf16 v[36:39], v[164:167], v[148:151], v[36:39]
    ds_read_b64_tr_b16 v[130:131], v210 offset:16896
    v_mfma_f32_16x16x32_bf16 v[32:35], v[160:163], v[148:151], v[32:35]
    ds_read_b128 v[108:111], v208 offset:2048
    v_mfma_f32_16x16x32_bf16 v[56:59], v[160:163], v[152:155], v[56:59]
    ds_read_b64_tr_b16 v[132:133], v211 offset:16384
    v_mfma_f32_16x16x32_bf16 v[60:63], v[164:167], v[152:155], v[60:63]
    ds_read_b64_tr_b16 v[134:135], v211 offset:16896
    v_mfma_f32_16x16x32_bf16 v[64:67], v[168:171], v[152:155], v[64:67]
    ds_read_b64_tr_b16 v[136:137], v210 offset:20480
    v_mfma_f32_16x16x32_bf16 v[68:71], v[172:175], v[152:155], v[68:71]
    ds_read_b64_tr_b16 v[138:139], v210 offset:20992
    s_cbranch_vccz Lskip20
    s_add_u32 s20, s15, 640
    s_add_u32 m0, s22, 16384
    s_and_b32 s20, s20, 0x780
    buffer_load_dwordx4 v184, s[4:7], s20 offen lds
    s_add_u32 m0, s22, 17408
    s_nop 0
    buffer_load_dwordx4 v185, s[4:7], s20 offen lds
    s_add_u32 m0, s22, 18432
    s_nop 0
    buffer_load_dwordx4 v186, s[4:7], s20 offen lds
    s_add_u32 m0, s22, 19456
    s_nop 0
    buffer_load_dwordx4 v187, s[4:7], s20 offen lds
Lskip20:
    v_mfma_f32_16x16x32_bf16 v[92:95], v[172:175], v[156:159], v[92:95]
    ds_read_b64_tr_b16 v[140:141], v211 offset:20480
    v_mfma_f32_16x16x32_bf16 v[88:91], v[168:171], v[156:159], v[88:91]
    ds_read_b64_tr_b16 v[142:143], v211 offset:20992
    v_mfma_f32_16x16x32_bf16 v[84:87], v[164:167], v[156:159], v[84:87]
    ds_read_b128 v[112:115], v208 offset:4096
    v_mfma_f32_16x16x32_bf16 v[80:83], v[160:163], v[156:159], v[80:83]
    ds_read_b128 v[116:119], v208 offset:6144
    v_mfma_f32_16x16x32_bf16 v[96:99], v[156:159], v[176:179], v[96:99]
    v_mfma_f32_16x16x32_bf16 v[100:103], v[156:159], v[180:183], v[100:103]
    v_mfma_f32_16x16x32_bf16 v[76:79], v[152:155], v[180:183], v[76:79]
    v_mfma_f32_16x16x32_bf16 v[72:75], v[152:155], v[176:179], v[72:75]
    v_mfma_f32_16x16x32_bf16 v[48:51], v[148:151], v[176:179], v[48:51]
    v_mfma_f32_16x16x32_bf16 v[52:55], v[148:151], v[180:183], v[52:55]
    v_mfma_f32_16x16x32_bf16 v[28:31], v[144:147], v[180:183], v[28:31]
    v_mfma_f32_16x16x32_bf16 v[24:27], v[144:147], v[176:179], v[24:27]
    s_waitcnt lgkmcnt(0)
    v_mfma_f32_16x16x32_bf16 v[8:11], v[120:123], v[104:107], v[8:11]
    ds_read_b128 v[144:147], v209 offset:0
    v_mfma_f32_16x16x32_bf16 v[12:15], v[124:127], v[104:107], v[12:15]
    ds_read_b64_tr_b16 v[160:161], v210 offset:24576
    s_cbranch_vccz Lskip21
    s_add_u32 s21, s14, 10
    s_and_b32 s21, s21, 31
    s_add_u32 m0, s23, 0
    s_mul_i32 s21, s21, 196608
    buffer_load_dwordx4 v212, s[8:11], s21 offen lds
    s_add_u32 m0, s23, 1024
    s_nop 0
    buffer_load_dwordx4 v213, s[8:11], s21 offen lds
    s_add_u32 m0, s23, 2048
    s_nop 0
    buffer_load_dwordx4 v214, s[8:11], s21 offen lds
Lskip21:
    v_mfma_f32_16x16x32_bf16 v[16:19], v[128:131], v[104:107], v[16:19]
    ds_read_b64_tr_b16 v[162:163], v210 offset:25088
    v_mfma_f32_16x16x32_bf16 v[20:23], v[132:135], v[104:107], v[20:23]
    ds_read_b64_tr_b16 v[164:165], v211 offset:24576
    v_mfma_f32_16x16x32_bf16 v[44:47], v[132:135], v[108:111], v[44:47]
    ds_read_b64_tr_b16 v[166:167], v211 offset:25088
    v_mfma_f32_16x16x32_bf16 v[40:43], v[128:131], v[108:111], v[40:43]
    ds_read_b64_tr_b16 v[168:169], v210 offset:28672
    v_mfma_f32_16x16x32_bf16 v[36:39], v[124:127], v[108:111], v[36:39]
    ds_read_b64_tr_b16 v[170:171], v210 offset:29184
    v_mfma_f32_16x16x32_bf16 v[32:35], v[120:123], v[108:111], v[32:35]
    ds_read_b128 v[148:151], v209 offset:2048
    v_mfma_f32_16x16x32_bf16 v[56:59], v[120:123], v[112:115], v[56:59]
    ds_read_b64_tr_b16 v[172:173], v211 offset:28672
    v_mfma_f32_16x16x32_bf16 v[60:63], v[124:127], v[112:115], v[60:63]
    ds_read_b64_tr_b16 v[174:175], v211 offset:29184
    v_mfma_f32_16x16x32_bf16 v[64:67], v[128:131], v[112:115], v[64:67]
    ds_read_b64_tr_b16 v[176:177], v210 offset:32768
    v_mfma_f32_16x16x32_bf16 v[68:71], v[132:135], v[112:115], v[68:71]
    ds_read_b64_tr_b16 v[178:179], v210 offset:33280
    s_cbranch_vccz Lskip22
    s_add_u32 s20, s15, 640
    s_add_u32 m0, s22, 20480
    s_and_b32 s20, s20, 0x780
    buffer_load_dwordx4 v188, s[4:7], s20 offen lds
    s_add_u32 m0, s22, 21504
    s_nop 0
    buffer_load_dwordx4 v189, s[4:7], s20 offen lds
    s_add_u32 m0, s22, 22528
    s_nop 0
    buffer_load_dwordx4 v190, s[4:7], s20 offen lds
    s_add_u32 m0, s22, 23552
    s_nop 0
    buffer_load_dwordx4 v191, s[4:7], s20 offen lds
Lskip22:
    v_mfma_f32_16x16x32_bf16 v[92:95], v[132:135], v[116:119], v[92:95]
    ds_read_b64_tr_b16 v[180:181], v211 offset:32768
    v_mfma_f32_16x16x32_bf16 v[88:91], v[128:131], v[116:119], v[88:91]
    ds_read_b64_tr_b16 v[182:183], v211 offset:33280
    v_mfma_f32_16x16x32_bf16 v[84:87], v[124:127], v[116:119], v[84:87]
    ds_read_b128 v[152:155], v209 offset:4096
    v_mfma_f32_16x16x32_bf16 v[80:83], v[120:123], v[116:119], v[80:83]
    ds_read_b128 v[156:159], v209 offset:6144
    v_mfma_f32_16x16x32_bf16 v[96:99], v[116:119], v[136:139], v[96:99]
    v_mfma_f32_16x16x32_bf16 v[100:103], v[116:119], v[140:143], v[100:103]
    v_mfma_f32_16x16x32_bf16 v[76:79], v[112:115], v[140:143], v[76:79]
    v_mfma_f32_16x16x32_bf16 v[72:75], v[112:115], v[136:139], v[72:75]
    v_mfma_f32_16x16x32_bf16 v[48:51], v[108:111], v[136:139], v[48:51]
    v_mfma_f32_16x16x32_bf16 v[52:55], v[108:111], v[140:143], v[52:55]
    v_mfma_f32_16x16x32_bf16 v[28:31], v[104:107], v[140:143], v[28:31]
    v_mfma_f32_16x16x32_bf16 v[24:27], v[104:107], v[136:139], v[24:27]
    s_waitcnt vmcnt(11) lgkmcnt(0)
    s_barrier
    v_mfma_f32_16x16x32_bf16 v[8:11], v[160:163], v[144:147], v[8:11]
    ds_read_b128 v[104:107], v208 offset:8192
    v_mfma_f32_16x16x32_bf16 v[12:15], v[164:167], v[144:147], v[12:15]
    ds_read_b64_tr_b16 v[120:121], v210 offset:36864
    s_cbranch_vccz Lskip23
    s_add_u32 s21, s14, 11
    s_and_b32 s21, s21, 31
    s_add_u32 m0, s23, 12288
    s_mul_i32 s21, s21, 196608
    buffer_load_dwordx4 v212, s[8:11], s21 offen lds
    s_add_u32 m0, s23, 13312
    s_nop 0
    buffer_load_dwordx4 v213, s[8:11], s21 offen lds
    s_add_u32 m0, s23, 14336
    s_nop 0
    buffer_load_dwordx4 v214, s[8:11], s21 offen lds
Lskip23:
    v_mfma_f32_16x16x32_bf16 v[16:19], v[168:171], v[144:147], v[16:19]
    ds_read_b64_tr_b16 v[122:123], v210 offset:37376
    v_mfma_f32_16x16x32_bf16 v[20:23], v[172:175], v[144:147], v[20:23]
    ds_read_b64_tr_b16 v[124:125], v211 offset:36864
    v_mfma_f32_16x16x32_bf16 v[44:47], v[172:175], v[148:151], v[44:47]
    ds_read_b64_tr_b16 v[126:127], v211 offset:37376
    v_mfma_f32_16x16x32_bf16 v[40:43], v[168:171], v[148:151], v[40:43]
    ds_read_b64_tr_b16 v[128:129], v210 offset:40960
    v_mfma_f32_16x16x32_bf16 v[36:39], v[164:167], v[148:151], v[36:39]
    ds_read_b64_tr_b16 v[130:131], v210 offset:41472
    v_mfma_f32_16x16x32_bf16 v[32:35], v[160:163], v[148:151], v[32:35]
    ds_read_b128 v[108:111], v208 offset:10240
    v_mfma_f32_16x16x32_bf16 v[56:59], v[160:163], v[152:155], v[56:59]
    ds_read_b64_tr_b16 v[132:133], v211 offset:40960
    v_mfma_f32_16x16x32_bf16 v[60:63], v[164:167], v[152:155], v[60:63]
    ds_read_b64_tr_b16 v[134:135], v211 offset:41472
    v_mfma_f32_16x16x32_bf16 v[64:67], v[168:171], v[152:155], v[64:67]
    ds_read_b64_tr_b16 v[136:137], v210 offset:45056
    v_mfma_f32_16x16x32_bf16 v[68:71], v[172:175], v[152:155], v[68:71]
    ds_read_b64_tr_b16 v[138:139], v210 offset:45568
    s_cbranch_vccz Lskip24
    s_add_u32 s20, s15, 768
    s_add_u32 m0, s22, 0
    s_and_b32 s20, s20, 0x780
    buffer_load_dwordx4 v184, s[4:7], s20 offen lds
    s_add_u32 m0, s22, 1024
    s_nop 0
    buffer_load_dwordx4 v185, s[4:7], s20 offen lds
    s_add_u32 m0, s22, 2048
    s_nop 0
    buffer_load_dwordx4 v186, s[4:7], s20 offen lds
    s_add_u32 m0, s22, 3072
    s_nop 0
    buffer_load_dwordx4 v187, s[4:7], s20 offen lds
Lskip24:
    v_mfma_f32_16x16x32_bf16 v[92:95], v[172:175], v[156:159], v[92:95]
    ds_read_b64_tr_b16 v[140:141], v211 offset:45056
    v_mfma_f32_16x16x32_bf16 v[88:91], v[168:171], v[156:159], v[88:91]
    ds_read_b64_tr_b16 v[142:143], v211 offset:45568
    v_mfma_f32_16x16x32_bf16 v[84:87], v[164:167], v[156:159], v[84:87]
    ds_read_b128 v[112:115], v208 offset:12288
    v_mfma_f32_16x16x32_bf16 v[80:83], v[160:163], v[156:159], v[80:83]
    ds_read_b128 v[116:119], v208 offset:14336
    v_mfma_f32_16x16x32_bf16 v[96:99], v[156:159], v[176:179], v[96:99]
    v_mfma_f32_16x16x32_bf16 v[100:103], v[156:159], v[180:183], v[100:103]
    v_mfma_f32_16x16x32_bf16 v[76:79], v[152:155], v[180:183], v[76:79]
    v_mfma_f32_16x16x32_bf16 v[72:75], v[152:155], v[176:179], v[72:75]
    v_mfma_f32_16x16x32_bf16 v[48:51], v[148:151], v[176:179], v[48:51]
    v_mfma_f32_16x16x32_bf16 v[52:55], v[148:151], v[180:183], v[52:55]
    v_mfma_f32_16x16x32_bf16 v[28:31], v[144:147], v[180:183], v[28:31]
    v_mfma_f32_16x16x32_bf16 v[24:27], v[144:147], v[176:179], v[24:27]
    s_waitcnt lgkmcnt(0)
    v_mfma_f32_16x16x32_bf16 v[8:11], v[120:123], v[104:107], v[8:11]
    ds_read_b128 v[144:147], v209 offset:8192
    v_mfma_f32_16x16x32_bf16 v[12:15], v[124:127], v[104:107], v[12:15]
    ds_read_b64_tr_b16 v[160:161], v210 offset:49152
    s_add_u32 s13, s12, 512
    s_and_b32 s13, s13, 1023
    s_mov_b64 exec, 7
    s_mul_i32 s13, s13, 6144
    buffer_load_dword v223, v218, s[56:59], s13 offen
    s_mov_b64 exec, -1
    v_mfma_f32_16x16x32_bf16 v[16:19], v[128:131], v[104:107], v[16:19]
    ds_read_b64_tr_b16 v[162:163], v210 offset:49664
    v_mfma_f32_16x16x32_bf16 v[20:23], v[132:135], v[104:107], v[20:23]
    ds_read_b64_tr_b16 v[164:165], v211 offset:49152
    v_mfma_f32_16x16x32_bf16 v[44:47], v[132:135], v[108:111], v[44:47]
    ds_read_b64_tr_b16 v[166:167], v211 offset:49664
    v_mfma_f32_16x16x32_bf16 v[40:43], v[128:131], v[108:111], v[40:43]
    ds_read_b64_tr_b16 v[168:169], v210 offset:53248
    v_mfma_f32_16x16x32_bf16 v[36:39], v[124:127], v[108:111], v[36:39]
    ds_read_b64_tr_b16 v[170:171], v210 offset:53760
    v_mfma_f32_16x16x32_bf16 v[32:35], v[120:123], v[108:111], v[32:35]
    ds_read_b128 v[148:151], v209 offset:10240
    v_mfma_f32_16x16x32_bf16 v[56:59], v[120:123], v[112:115], v[56:59]
    ds_read_b64_tr_b16 v[172:173], v211 offset:53248
    v_mfma_f32_16x16x32_bf16 v[60:63], v[124:127], v[112:115], v[60:63]
    ds_read_b64_tr_b16 v[174:175], v211 offset:53760
    v_mfma_f32_16x16x32_bf16 v[64:67], v[128:131], v[112:115], v[64:67]
    ds_read_b64_tr_b16 v[176:177], v210 offset:57344
    v_mfma_f32_16x16x32_bf16 v[68:71], v[132:135], v[112:115], v[68:71]
    ds_read_b64_tr_b16 v[178:179], v210 offset:57856
    s_cbranch_vccz Lskip25
    s_add_u32 s21, s14, 12
    s_and_b32 s21, s21, 31
    s_add_u32 m0, s23, 24576
    s_mul_i32 s21, s21, 196608
    buffer_load_dwordx4 v212, s[8:11], s21 offen lds
    s_add_u32 m0, s23, 25600
    s_nop 0
    buffer_load_dwordx4 v213, s[8:11], s21 offen lds
    s_add_u32 m0, s23, 26624
    s_nop 0
    buffer_load_dwordx4 v214, s[8:11], s21 offen lds
Lskip25:
    v_mfma_f32_16x16x32_bf16 v[92:95], v[132:135], v[116:119], v[92:95]
    ds_read_b64_tr_b16 v[180:181], v211 offset:57344
    v_mfma_f32_16x16x32_bf16 v[88:91], v[128:131], v[116:119], v[88:91]
    ds_read_b64_tr_b16 v[182:183], v211 offset:57856
    v_mfma_f32_16x16x32_bf16 v[84:87], v[124:127], v[116:119], v[84:87]
    ds_read_b128 v[152:155], v209 offset:12288
    v_mfma_f32_16x16x32_bf16 v[80:83], v[120:123], v[116:119], v[80:83]
    ds_read_b128 v[156:159], v209 offset:14336
    v_mfma_f32_16x16x32_bf16 v[96:99], v[116:119], v[136:139], v[96:99]
    v_mfma_f32_16x16x32_bf16 v[100:103], v[116:119], v[140:143], v[100:103]
    v_mfma_f32_16x16x32_bf16 v[76:79], v[112:115], v[140:143], v[76:79]
    v_mfma_f32_16x16x32_bf16 v[72:75], v[112:115], v[136:139], v[72:75]
    v_mfma_f32_16x16x32_bf16 v[48:51], v[108:111], v[136:139], v[48:51]
    v_mfma_f32_16x16x32_bf16 v[52:55], v[108:111], v[140:143], v[52:55]
    s_cbranch_vccz Lskip26
    s_add_u32 s20, s15, 768
    s_add_u32 m0, s22, 4096
    s_and_b32 s20, s20, 0x780
    buffer_load_dwordx4 v188, s[4:7], s20 offen lds
    s_add_u32 m0, s22, 5120
    s_nop 0
    buffer_load_dwordx4 v189, s[4:7], s20 offen lds
    s_add_u32 m0, s22, 6144
    s_nop 0
    buffer_load_dwordx4 v190, s[4:7], s20 offen lds
    s_add_u32 m0, s22, 7168
    s_nop 0
    buffer_load_dwordx4 v191, s[4:7], s20 offen lds
Lskip26:
    v_mfma_f32_16x16x32_bf16 v[28:31], v[104:107], v[140:143], v[28:31]
    v_mfma_f32_16x16x32_bf16 v[24:27], v[104:107], v[136:139], v[24:27]
    s_waitcnt vmcnt(12) lgkmcnt(0)
    s_barrier
    v_mfma_f32_16x16x32_bf16 v[8:11], v[160:163], v[144:147], v[8:11]
    ds_read_b128 v[104:107], v208 offset:16384
    v_mfma_f32_16x16x32_bf16 v[12:15], v[164:167], v[144:147], v[12:15]
    ds_read_b64_tr_b16 v[120:121], v210 offset:0
    s_cbranch_vccz Lskip27
    s_add_u32 s21, s14, 13
    s_and_b32 s21, s21, 31
    s_add_u32 m0, s23, 36864
    s_mul_i32 s21, s21, 196608
    buffer_load_dwordx4 v212, s[8:11], s21 offen lds
    s_add_u32 m0, s23, 37888
    s_nop 0
    buffer_load_dwordx4 v213, s[8:11], s21 offen lds
    s_add_u32 m0, s23, 38912
    s_nop 0
    buffer_load_dwordx4 v214, s[8:11], s21 offen lds
Lskip27:
    v_mfma_f32_16x16x32_bf16 v[16:19], v[168:171], v[144:147], v[16:19]
    ds_read_b64_tr_b16 v[122:123], v210 offset:512
    v_mfma_f32_16x16x32_bf16 v[20:23], v[172:175], v[144:147], v[20:23]
    ds_read_b64_tr_b16 v[124:125], v211 offset:0
    v_mfma_f32_16x16x32_bf16 v[44:47], v[172:175], v[148:151], v[44:47]
    ds_read_b64_tr_b16 v[126:127], v211 offset:512
    v_mfma_f32_16x16x32_bf16 v[40:43], v[168:171], v[148:151], v[40:43]
    ds_read_b64_tr_b16 v[128:129], v210 offset:4096
    v_mfma_f32_16x16x32_bf16 v[36:39], v[164:167], v[148:151], v[36:39]
    ds_read_b64_tr_b16 v[130:131], v210 offset:4608
    v_mfma_f32_16x16x32_bf16 v[32:35], v[160:163], v[148:151], v[32:35]
    ds_read_b128 v[108:111], v208 offset:18432
    v_mfma_f32_16x16x32_bf16 v[56:59], v[160:163], v[152:155], v[56:59]
    ds_read_b64_tr_b16 v[132:133], v211 offset:4096
    v_mfma_f32_16x16x32_bf16 v[60:63], v[164:167], v[152:155], v[60:63]
    ds_read_b64_tr_b16 v[134:135], v211 offset:4608
    v_mfma_f32_16x16x32_bf16 v[64:67], v[168:171], v[152:155], v[64:67]
    ds_read_b64_tr_b16 v[136:137], v210 offset:8192
    v_mfma_f32_16x16x32_bf16 v[68:71], v[172:175], v[152:155], v[68:71]
    ds_read_b64_tr_b16 v[138:139], v210 offset:8704
    s_cbranch_vccz Lskip28
    s_add_u32 s20, s15, 896
    s_add_u32 m0, s22, 8192
    s_and_b32 s20, s20, 0x780
    buffer_load_dwordx4 v184, s[4:7], s20 offen lds
    s_add_u32 m0, s22, 9216
    s_nop 0
    buffer_load_dwordx4 v185, s[4:7], s20 offen lds
    s_add_u32 m0, s22, 10240
    s_nop 0
    buffer_load_dwordx4 v186, s[4:7], s20 offen lds
    s_add_u32 m0, s22, 11264
    s_nop 0
    buffer_load_dwordx4 v187, s[4:7], s20 offen lds
Lskip28:
    v_mfma_f32_16x16x32_bf16 v[92:95], v[172:175], v[156:159], v[92:95]
    ds_read_b64_tr_b16 v[140:141], v211 offset:8192
    v_mfma_f32_16x16x32_bf16 v[88:91], v[168:171], v[156:159], v[88:91]
    ds_read_b64_tr_b16 v[142:143], v211 offset:8704
    v_mfma_f32_16x16x32_bf16 v[84:87], v[164:167], v[156:159], v[84:87]
    ds_read_b128 v[112:115], v208 offset:20480
    v_mfma_f32_16x16x32_bf16 v[80:83], v[160:163], v[156:159], v[80:83]
    ds_read_b128 v[116:119], v208 offset:22528
    v_mfma_f32_16x16x32_bf16 v[96:99], v[156:159], v[176:179], v[96:99]
    v_mfma_f32_16x16x32_bf16 v[100:103], v[156:159], v[180:183], v[100:103]
    v_mfma_f32_16x16x32_bf16 v[76:79], v[152:155], v[180:183], v[76:79]
    v_mfma_f32_16x16x32_bf16 v[72:75], v[152:155], v[176:179], v[72:75]
    v_mfma_f32_16x16x32_bf16 v[48:51], v[148:151], v[176:179], v[48:51]
    v_mfma_f32_16x16x32_bf16 v[52:55], v[148:151], v[180:183], v[52:55]
    v_mfma_f32_16x16x32_bf16 v[28:31], v[144:147], v[180:183], v[28:31]
    v_mfma_f32_16x16x32_bf16 v[24:27], v[144:147], v[176:179], v[24:27]
    s_waitcnt lgkmcnt(0)
    v_mfma_f32_16x16x32_bf16 v[8:11], v[120:123], v[104:107], v[8:11]
    ds_read_b128 v[144:147], v209 offset:16384
    v_mfma_f32_16x16x32_bf16 v[12:15], v[124:127], v[104:107], v[12:15]
    ds_read_b64_tr_b16 v[160:161], v210 offset:12288
    s_cbranch_vccz Lskip29
    s_add_u32 s21, s14, 14
    s_and_b32 s21, s21, 31
    s_add_u32 m0, s23, 49152
    s_mul_i32 s21, s21, 196608
    buffer_load_dwordx4 v212, s[8:11], s21 offen lds
    s_add_u32 m0, s23, 50176
    s_nop 0
    buffer_load_dwordx4 v213, s[8:11], s21 offen lds
    s_add_u32 m0, s23, 51200
    s_nop 0
    buffer_load_dwordx4 v214, s[8:11], s21 offen lds
Lskip29:
    v_mfma_f32_16x16x32_bf16 v[16:19], v[128:131], v[104:107], v[16:19]
    ds_read_b64_tr_b16 v[162:163], v210 offset:12800
    v_mfma_f32_16x16x32_bf16 v[20:23], v[132:135], v[104:107], v[20:23]
    ds_read_b64_tr_b16 v[164:165], v211 offset:12288
    v_mfma_f32_16x16x32_bf16 v[44:47], v[132:135], v[108:111], v[44:47]
    ds_read_b64_tr_b16 v[166:167], v211 offset:12800
    v_mfma_f32_16x16x32_bf16 v[40:43], v[128:131], v[108:111], v[40:43]
    ds_read_b64_tr_b16 v[168:169], v210 offset:16384
    v_mfma_f32_16x16x32_bf16 v[36:39], v[124:127], v[108:111], v[36:39]
    ds_read_b64_tr_b16 v[170:171], v210 offset:16896
    v_mfma_f32_16x16x32_bf16 v[32:35], v[120:123], v[108:111], v[32:35]
    ds_read_b128 v[148:151], v209 offset:18432
    v_mfma_f32_16x16x32_bf16 v[56:59], v[120:123], v[112:115], v[56:59]
    ds_read_b64_tr_b16 v[172:173], v211 offset:16384
    v_mfma_f32_16x16x32_bf16 v[60:63], v[124:127], v[112:115], v[60:63]
    ds_read_b64_tr_b16 v[174:175], v211 offset:16896
    v_mfma_f32_16x16x32_bf16 v[64:67], v[128:131], v[112:115], v[64:67]
    ds_read_b64_tr_b16 v[176:177], v210 offset:20480
    v_mfma_f32_16x16x32_bf16 v[68:71], v[132:135], v[112:115], v[68:71]
    ds_read_b64_tr_b16 v[178:179], v210 offset:20992
    s_cbranch_vccz Lskip30
    s_add_u32 s20, s15, 896
    s_add_u32 m0, s22, 12288
    s_and_b32 s20, s20, 0x780
    buffer_load_dwordx4 v188, s[4:7], s20 offen lds
    s_add_u32 m0, s22, 13312
    s_nop 0
    buffer_load_dwordx4 v189, s[4:7], s20 offen lds
    s_add_u32 m0, s22, 14336
    s_nop 0
    buffer_load_dwordx4 v190, s[4:7], s20 offen lds
    s_add_u32 m0, s22, 15360
    s_nop 0
    buffer_load_dwordx4 v191, s[4:7], s20 offen lds
Lskip30:
    v_mfma_f32_16x16x32_bf16 v[92:95], v[132:135], v[116:119], v[92:95]
    ds_read_b64_tr_b16 v[180:181], v211 offset:20480
    v_mfma_f32_16x16x32_bf16 v[88:91], v[128:131], v[116:119], v[88:91]
    ds_read_b64_tr_b16 v[182:183], v211 offset:20992
    v_mfma_f32_16x16x32_bf16 v[84:87], v[124:127], v[116:119], v[84:87]
    ds_read_b128 v[152:155], v209 offset:20480
    v_mfma_f32_16x16x32_bf16 v[80:83], v[120:123], v[116:119], v[80:83]
    ds_read_b128 v[156:159], v209 offset:22528
    v_mfma_f32_16x16x32_bf16 v[96:99], v[116:119], v[136:139], v[96:99]
    v_mfma_f32_16x16x32_bf16 v[100:103], v[116:119], v[140:143], v[100:103]
    v_mfma_f32_16x16x32_bf16 v[76:79], v[112:115], v[140:143], v[76:79]
    v_mfma_f32_16x16x32_bf16 v[72:75], v[112:115], v[136:139], v[72:75]
    v_mfma_f32_16x16x32_bf16 v[48:51], v[108:111], v[136:139], v[48:51]
    v_mfma_f32_16x16x32_bf16 v[52:55], v[108:111], v[140:143], v[52:55]
    v_mfma_f32_16x16x32_bf16 v[28:31], v[104:107], v[140:143], v[28:31]
    v_mfma_f32_16x16x32_bf16 v[24:27], v[104:107], v[136:139], v[24:27]
    s_waitcnt vmcnt(11) lgkmcnt(0)
    s_barrier
    v_mfma_f32_16x16x32_bf16 v[8:11], v[160:163], v[144:147], v[8:11]
    ds_read_b128 v[104:107], v208 offset:0
    v_mfma_f32_16x16x32_bf16 v[12:15], v[164:167], v[144:147], v[12:15]
    ds_read_b64_tr_b16 v[120:121], v210 offset:24576
    s_cbranch_vccz Lskip31
    s_add_u32 s21, s14, 15
    s_and_b32 s21, s21, 31
    s_add_u32 m0, s23, 0
    s_mul_i32 s21, s21, 196608
    buffer_load_dwordx4 v212, s[8:11], s21 offen lds
    s_add_u32 m0, s23, 1024
    s_nop 0
    buffer_load_dwordx4 v213, s[8:11], s21 offen lds
    s_add_u32 m0, s23, 2048
    s_nop 0
    buffer_load_dwordx4 v214, s[8:11], s21 offen lds
Lskip31:
    v_mfma_f32_16x16x32_bf16 v[16:19], v[168:171], v[144:147], v[16:19]
    ds_read_b64_tr_b16 v[122:123], v210 offset:25088
    v_mfma_f32_16x16x32_bf16 v[20:23], v[172:175], v[144:147], v[20:23]
    ds_read_b64_tr_b16 v[124:125], v211 offset:24576
    v_mfma_f32_16x16x32_bf16 v[44:47], v[172:175], v[148:151], v[44:47]
    ds_read_b64_tr_b16 v[126:127], v211 offset:25088
    v_mfma_f32_16x16x32_bf16 v[40:43], v[168:171], v[148:151], v[40:43]
    ds_read_b64_tr_b16 v[128:129], v210 offset:28672
    v_mfma_f32_16x16x32_bf16 v[36:39], v[164:167], v[148:151], v[36:39]
    ds_read_b64_tr_b16 v[130:131], v210 offset:29184
    v_mfma_f32_16x16x32_bf16 v[32:35], v[160:163], v[148:151], v[32:35]
    ds_read_b128 v[108:111], v208 offset:2048
    v_mfma_f32_16x16x32_bf16 v[56:59], v[160:163], v[152:155], v[56:59]
    ds_read_b64_tr_b16 v[132:133], v211 offset:28672
    v_mfma_f32_16x16x32_bf16 v[60:63], v[164:167], v[152:155], v[60:63]
    ds_read_b64_tr_b16 v[134:135], v211 offset:29184
    v_mfma_f32_16x16x32_bf16 v[64:67], v[168:171], v[152:155], v[64:67]
    ds_read_b64_tr_b16 v[136:137], v210 offset:32768
    v_mfma_f32_16x16x32_bf16 v[68:71], v[172:175], v[152:155], v[68:71]
    ds_read_b64_tr_b16 v[138:139], v210 offset:33280
    s_cbranch_vccz Lskip32
    s_add_u32 s20, s15, 1024
    s_add_u32 m0, s22, 16384
    s_and_b32 s20, s20, 0x780
    buffer_load_dwordx4 v184, s[4:7], s20 offen lds
    s_add_u32 m0, s22, 17408
    s_nop 0
    buffer_load_dwordx4 v185, s[4:7], s20 offen lds
    s_add_u32 m0, s22, 18432
    s_nop 0
    buffer_load_dwordx4 v186, s[4:7], s20 offen lds
    s_add_u32 m0, s22, 19456
    s_nop 0
    buffer_load_dwordx4 v187, s[4:7], s20 offen lds
Lskip32:
    v_mfma_f32_16x16x32_bf16 v[92:95], v[172:175], v[156:159], v[92:95]
    ds_read_b64_tr_b16 v[140:141], v211 offset:32768
    v_mfma_f32_16x16x32_bf16 v[88:91], v[168:171], v[156:159], v[88:91]
    ds_read_b64_tr_b16 v[142:143], v211 offset:33280
    v_mfma_f32_16x16x32_bf16 v[84:87], v[164:167], v[156:159], v[84:87]
    ds_read_b128 v[112:115], v208 offset:4096
    v_mfma_f32_16x16x32_bf16 v[80:83], v[160:163], v[156:159], v[80:83]
    ds_read_b128 v[116:119], v208 offset:6144
    v_mfma_f32_16x16x32_bf16 v[96:99], v[156:159], v[176:179], v[96:99]
    v_mfma_f32_16x16x32_bf16 v[100:103], v[156:159], v[180:183], v[100:103]
    v_mfma_f32_16x16x32_bf16 v[76:79], v[152:155], v[180:183], v[76:79]
    v_mfma_f32_16x16x32_bf16 v[72:75], v[152:155], v[176:179], v[72:75]
    v_mfma_f32_16x16x32_bf16 v[48:51], v[148:151], v[176:179], v[48:51]
    v_mfma_f32_16x16x32_bf16 v[52:55], v[148:151], v[180:183], v[52:55]
    v_mfma_f32_16x16x32_bf16 v[28:31], v[144:147], v[180:183], v[28:31]
    v_mfma_f32_16x16x32_bf16 v[24:27], v[144:147], v[176:179], v[24:27]
    s_waitcnt lgkmcnt(0)
    v_mfma_f32_16x16x32_bf16 v[8:11], v[120:123], v[104:107], v[8:11]
    ds_read_b128 v[144:147], v209 offset:0
    s_getpc_b64 s[74:75]
Lpcref_0:
    v_mfma_f32_16x16x32_bf16 v[12:15], v[124:127], v[104:107], v[12:15]
    ds_read_b64_tr_b16 v[160:161], v210 offset:36864
    s_cbranch_vccz Lskip33
    s_add_u32 s21, s14, 16
    s_and_b32 s21, s21, 31
    s_add_u32 m0, s23, 12288
    s_mul_i32 s21, s21, 196608
    buffer_load_dwordx4 v212, s[8:11], s21 offen lds
    s_add_u32 m0, s23, 13312
    s_nop 0
    buffer_load_dwordx4 v213, s[8:11], s21 offen lds
    s_add_u32 m0, s23, 14336
    s_nop 0
    buffer_load_dwordx4 v214, s[8:11], s21 offen lds
Lskip33:
    s_and_b32 s62, s16, 3
    v_mfma_f32_16x16x32_bf16 v[16:19], v[128:131], v[104:107], v[16:19]
    ds_read_b64_tr_b16 v[162:163], v210 offset:37376
    s_lshl_b32 s62, s62, 13
    v_mfma_f32_16x16x32_bf16 v[20:23], v[132:135], v[104:107], v[20:23]
    ds_read_b64_tr_b16 v[164:165], v211 offset:36864
    v_lshlrev_b32 v2, 7, v1
    v_mfma_f32_16x16x32_bf16 v[44:47], v[132:135], v[108:111], v[44:47]
    ds_read_b64_tr_b16 v[166:167], v211 offset:37376
    v_add_u32 v2, s62, v2
    v_mfma_f32_16x16x32_bf16 v[40:43], v[128:131], v[108:111], v[40:43]
    ds_read_b64_tr_b16 v[168:169], v210 offset:40960
    v_min_u32 v2, Lcode_end-Lgemm_end-4, v2
    v_mfma_f32_16x16x32_bf16 v[36:39], v[124:127], v[108:111], v[36:39]
    ds_read_b64_tr_b16 v[170:171], v210 offset:41472
    s_add_u32 s74, s74, Lgemm_end-Lpcref_0
    s_addc_u32 s75, s75, 0
    v_mfma_f32_16x16x32_bf16 v[32:35], v[120:123], v[108:111], v[32:35]
    ds_read_b128 v[148:151], v209 offset:2048
    v_mov_b32 v3, 0
    v_mfma_f32_16x16x32_bf16 v[56:59], v[120:123], v[112:115], v[56:59]
    ds_read_b64_tr_b16 v[172:173], v211 offset:40960
    v_lshl_add_u64 v[2:3], v[2:3], 0, s[74:75]
    v_mfma_f32_16x16x32_bf16 v[60:63], v[124:127], v[112:115], v[60:63]
    ds_read_b64_tr_b16 v[174:175], v211 offset:41472
    s_cbranch_vccnz Lskip2
    global_load_dword v223, v[2:3], off
Lskip2:
    v_mfma_f32_16x16x32_bf16 v[64:67], v[128:131], v[112:115], v[64:67]
    ds_read_b64_tr_b16 v[176:177], v210 offset:45056
    v_mfma_f32_16x16x32_bf16 v[68:71], v[132:135], v[112:115], v[68:71]
    ds_read_b64_tr_b16 v[178:179], v210 offset:45568
    s_cbranch_vccz Lskip34
    s_add_u32 s20, s15, 1024
    s_add_u32 m0, s22, 20480
    s_and_b32 s20, s20, 0x780
    buffer_load_dwordx4 v188, s[4:7], s20 offen lds
    s_add_u32 m0, s22, 21504
    s_nop 0
    buffer_load_dwordx4 v189, s[4:7], s20 offen lds
    s_add_u32 m0, s22, 22528
    s_nop 0
    buffer_load_dwordx4 v190, s[4:7], s20 offen lds
    s_add_u32 m0, s22, 23552
    s_nop 0
    buffer_load_dwordx4 v191, s[4:7], s20 offen lds
Lskip34:
    v_mfma_f32_16x16x32_bf16 v[92:95], v[132:135], v[116:119], v[92:95]
    ds_read_b64_tr_b16 v[180:181], v211 offset:45056
    v_mfma_f32_16x16x32_bf16 v[88:91], v[128:131], v[116:119], v[88:91]
    ds_read_b64_tr_b16 v[182:183], v211 offset:45568
    v_mfma_f32_16x16x32_bf16 v[84:87], v[124:127], v[116:119], v[84:87]
    ds_read_b128 v[152:155], v209 offset:4096
    v_mfma_f32_16x16x32_bf16 v[80:83], v[120:123], v[116:119], v[80:83]
    ds_read_b128 v[156:159], v209 offset:6144
    v_mfma_f32_16x16x32_bf16 v[96:99], v[116:119], v[136:139], v[96:99]
    v_mfma_f32_16x16x32_bf16 v[100:103], v[116:119], v[140:143], v[100:103]
    v_mfma_f32_16x16x32_bf16 v[76:79], v[112:115], v[140:143], v[76:79]
    v_mfma_f32_16x16x32_bf16 v[72:75], v[112:115], v[136:139], v[72:75]
    v_mfma_f32_16x16x32_bf16 v[48:51], v[108:111], v[136:139], v[48:51]
    v_mfma_f32_16x16x32_bf16 v[52:55], v[108:111], v[140:143], v[52:55]
    v_mfma_f32_16x16x32_bf16 v[28:31], v[104:107], v[140:143], v[28:31]
    v_mfma_f32_16x16x32_bf16 v[24:27], v[104:107], v[136:139], v[24:27]
    s_waitcnt vmcnt(11) lgkmcnt(0)
    s_barrier
    v_mfma_f32_16x16x32_bf16 v[8:11], v[160:163], v[144:147], v[8:11]
    ds_read_b128 v[104:107], v208 offset:8192
    v_mfma_f32_16x16x32_bf16 v[12:15], v[164:167], v[144:147], v[12:15]
    ds_read_b64_tr_b16 v[120:121], v210 offset:49152
    s_cbranch_vccz Lskip35
    s_add_u32 s21, s14, 17
    s_and_b32 s21, s21, 31
    s_add_u32 m0, s23, 24576
    s_mul_i32 s21, s21, 196608
    buffer_load_dwordx4 v212, s[8:11], s21 offen lds
    s_add_u32 m0, s23, 25600
    s_nop 0
    buffer_load_dwordx4 v213, s[8:11], s21 offen lds
    s_add_u32 m0, s23, 26624
    s_nop 0
    buffer_load_dwordx4 v214, s[8:11], s21 offen lds
Lskip35:
    v_mfma_f32_16x16x32_bf16 v[16:19], v[168:171], v[144:147], v[16:19]
    ds_read_b64_tr_b16 v[122:123], v210 offset:49664
    v_mfma_f32_16x16x32_bf16 v[20:23], v[172:175], v[144:147], v[20:23]
    ds_read_b64_tr_b16 v[124:125], v211 offset:49152
    v_mfma_f32_16x16x32_bf16 v[44:47], v[172:175], v[148:151], v[44:47]
    ds_read_b64_tr_b16 v[126:127], v211 offset:49664
    v_mfma_f32_16x16x32_bf16 v[40:43], v[168:171], v[148:151], v[40:43]
    ds_read_b64_tr_b16 v[128:129], v210 offset:53248
    v_mfma_f32_16x16x32_bf16 v[36:39], v[164:167], v[148:151], v[36:39]
    ds_read_b64_tr_b16 v[130:131], v210 offset:53760
    v_mfma_f32_16x16x32_bf16 v[32:35], v[160:163], v[148:151], v[32:35]
    ds_read_b128 v[108:111], v208 offset:10240
    v_mfma_f32_16x16x32_bf16 v[56:59], v[160:163], v[152:155], v[56:59]
    ds_read_b64_tr_b16 v[132:133], v211 offset:53248
    v_mfma_f32_16x16x32_bf16 v[60:63], v[164:167], v[152:155], v[60:63]
    ds_read_b64_tr_b16 v[134:135], v211 offset:53760
    v_mfma_f32_16x16x32_bf16 v[64:67], v[168:171], v[152:155], v[64:67]
    ds_read_b64_tr_b16 v[136:137], v210 offset:57344
    v_mfma_f32_16x16x32_bf16 v[68:71], v[172:175], v[152:155], v[68:71]
    ds_read_b64_tr_b16 v[138:139], v210 offset:57856
    s_cbranch_vccz Lskip36
    s_add_u32 s20, s15, 1152
    s_add_u32 m0, s22, 0
    s_and_b32 s20, s20, 0x780
    buffer_load_dwordx4 v184, s[4:7], s20 offen lds
    s_add_u32 m0, s22, 1024
    s_nop 0
    buffer_load_dwordx4 v185, s[4:7], s20 offen lds
    s_add_u32 m0, s22, 2048
    s_nop 0
    buffer_load_dwordx4 v186, s[4:7], s20 offen lds
    s_add_u32 m0, s22, 3072
    s_nop 0
    buffer_load_dwordx4 v187, s[4:7], s20 offen lds
Lskip36:
    v_mfma_f32_16x16x32_bf16 v[92:95], v[172:175], v[156:159], v[92:95]
    ds_read_b64_tr_b16 v[140:141], v211 offset:57344
    v_mfma_f32_16x16x32_bf16 v[88:91], v[168:171], v[156:159], v[88:91]
    ds_read_b64_tr_b16 v[142:143], v211 offset:57856
    v_mfma_f32_16x16x32_bf16 v[84:87], v[164:167], v[156:159], v[84:87]
    ds_read_b128 v[112:115], v208 offset:12288
    v_mfma_f32_16x16x32_bf16 v[80:83], v[160:163], v[156:159], v[80:83]
    ds_read_b128 v[116:119], v208 offset:14336
    v_mfma_f32_16x16x32_bf16 v[96:99], v[156:159], v[176:179], v[96:99]
    v_mfma_f32_16x16x32_bf16 v[100:103], v[156:159], v[180:183], v[100:103]
    v_mfma_f32_16x16x32_bf16 v[76:79], v[152:155], v[180:183], v[76:79]
    v_mfma_f32_16x16x32_bf16 v[72:75], v[152:155], v[176:179], v[72:75]
    v_mfma_f32_16x16x32_bf16 v[48:51], v[148:151], v[176:179], v[48:51]
    v_mfma_f32_16x16x32_bf16 v[52:55], v[148:151], v[180:183], v[52:55]
    v_mfma_f32_16x16x32_bf16 v[28:31], v[144:147], v[180:183], v[28:31]
    v_mfma_f32_16x16x32_bf16 v[24:27], v[144:147], v[176:179], v[24:27]
    s_waitcnt lgkmcnt(0)
    v_mfma_f32_16x16x32_bf16 v[8:11], v[120:123], v[104:107], v[8:11]
    ds_read_b128 v[144:147], v209 offset:8192
    v_mfma_f32_16x16x32_bf16 v[12:15], v[124:127], v[104:107], v[12:15]
    ds_read_b64_tr_b16 v[160:161], v210 offset:0
    s_cbranch_vccz Lskip37
    s_add_u32 s21, s14, 18
    s_and_b32 s21, s21, 31
    s_add_u32 m0, s23, 36864
    s_mul_i32 s21, s21, 196608
    buffer_load_dwordx4 v212, s[8:11], s21 offen lds
    s_add_u32 m0, s23, 37888
    s_nop 0
    buffer_load_dwordx4 v213, s[8:11], s21 offen lds
    s_add_u32 m0, s23, 38912
    s_nop 0
    buffer_load_dwordx4 v214, s[8:11], s21 offen lds
Lskip37:
    v_mfma_f32_16x16x32_bf16 v[16:19], v[128:131], v[104:107], v[16:19]
    ds_read_b64_tr_b16 v[162:163], v210 offset:512
    v_mfma_f32_16x16x32_bf16 v[20:23], v[132:135], v[104:107], v[20:23]
    ds_read_b64_tr_b16 v[164:165], v211 offset:0
    v_mfma_f32_16x16x32_bf16 v[44:47], v[132:135], v[108:111], v[44:47]
    ds_read_b64_tr_b16 v[166:167], v211 offset:512
    v_mfma_f32_16x16x32_bf16 v[40:43], v[128:131], v[108:111], v[40:43]
    ds_read_b64_tr_b16 v[168:169], v210 offset:4096
    v_mfma_f32_16x16x32_bf16 v[36:39], v[124:127], v[108:111], v[36:39]
    ds_read_b64_tr_b16 v[170:171], v210 offset:4608
    v_mfma_f32_16x16x32_bf16 v[32:35], v[120:123], v[108:111], v[32:35]
    ds_read_b128 v[148:151], v209 offset:10240
    v_mfma_f32_16x16x32_bf16 v[56:59], v[120:123], v[112:115], v[56:59]
    ds_read_b64_tr_b16 v[172:173], v211 offset:4096
    v_mfma_f32_16x16x32_bf16 v[60:63], v[124:127], v[112:115], v[60:63]
    ds_read_b64_tr_b16 v[174:175], v211 offset:4608
    v_mfma_f32_16x16x32_bf16 v[64:67], v[128:131], v[112:115], v[64:67]
    ds_read_b64_tr_b16 v[176:177], v210 offset:8192
    v_mfma_f32_16x16x32_bf16 v[68:71], v[132:135], v[112:115], v[68:71]
    ds_read_b64_tr_b16 v[178:179], v210 offset:8704
    s_cbranch_vccz Lskip38
    s_add_u32 s20, s15, 1152
    s_add_u32 m0, s22, 4096
    s_and_b32 s20, s20, 0x780
    buffer_load_dwordx4 v188, s[4:7], s20 offen lds
    s_add_u32 m0, s22, 5120
    s_nop 0
    buffer_load_dwordx4 v189, s[4:7], s20 offen lds
    s_add_u32 m0, s22, 6144
    s_nop 0
    buffer_load_dwordx4 v190, s[4:7], s20 offen lds
    s_add_u32 m0, s22, 7168
    s_nop 0
    buffer_load_dwordx4 v191, s[4:7], s20 offen lds
Lskip38:
    v_mfma_f32_16x16x32_bf16 v[92:95], v[132:135], v[116:119], v[92:95]
    ds_read_b64_tr_b16 v[180:181], v211 offset:8192
    v_mfma_f32_16x16x32_bf16 v[88:91], v[128:131], v[116:119], v[88:91]
    ds_read_b64_tr_b16 v[182:183], v211 offset:8704
    v_mfma_f32_16x16x32_bf16 v[84:87], v[124:127], v[116:119], v[84:87]
    ds_read_b128 v[152:155], v209 offset:12288
    v_mfma_f32_16x16x32_bf16 v[80:83], v[120:123], v[116:119], v[80:83]
    ds_read_b128 v[156:159], v209 offset:14336
    v_mfma_f32_16x16x32_bf16 v[96:99], v[116:119], v[136:139], v[96:99]
    v_mfma_f32_16x16x32_bf16 v[100:103], v[116:119], v[140:143], v[100:103]
    v_mfma_f32_16x16x32_bf16 v[76:79], v[112:115], v[140:143], v[76:79]
    v_mfma_f32_16x16x32_bf16 v[72:75], v[112:115], v[136:139], v[72:75]
    v_mfma_f32_16x16x32_bf16 v[48:51], v[108:111], v[136:139], v[48:51]
    v_mfma_f32_16x16x32_bf16 v[52:55], v[108:111], v[140:143], v[52:55]
    v_mfma_f32_16x16x32_bf16 v[28:31], v[104:107], v[140:143], v[28:31]
    v_mfma_f32_16x16x32_bf16 v[24:27], v[104:107], v[136:139], v[24:27]
    s_waitcnt vmcnt(11) lgkmcnt(0)
    s_barrier
    v_mfma_f32_16x16x32_bf16 v[8:11], v[160:163], v[144:147], v[8:11]
    ds_read_b128 v[104:107], v208 offset:16384
    v_mfma_f32_16x16x32_bf16 v[12:15], v[164:167], v[144:147], v[12:15]
    ds_read_b64_tr_b16 v[120:121], v210 offset:12288
    s_cbranch_vccz Lskip39
    s_add_u32 s21, s14, 19
    s_and_b32 s21, s21, 31
    s_add_u32 m0, s23, 49152
    s_mul_i32 s21, s21, 196608
    buffer_load_dwordx4 v212, s[8:11], s21 offen lds
    s_add_u32 m0, s23, 50176
    s_nop 0
    buffer_load_dwordx4 v213, s[8:11], s21 offen lds
    s_add_u32 m0, s23, 51200
    s_nop 0
    buffer_load_dwordx4 v214, s[8:11], s21 offen lds
Lskip39:
    v_mfma_f32_16x16x32_bf16 v[16:19], v[168:171], v[144:147], v[16:19]
    ds_read_b64_tr_b16 v[122:123], v210 offset:12800
    v_mfma_f32_16x16x32_bf16 v[20:23], v[172:175], v[144:147], v[20:23]
    ds_read_b64_tr_b16 v[124:125], v211 offset:12288
    v_mfma_f32_16x16x32_bf16 v[44:47], v[172:175], v[148:151], v[44:47]
    ds_read_b64_tr_b16 v[126:127], v211 offset:12800
    v_mfma_f32_16x16x32_bf16 v[40:43], v[168:171], v[148:151], v[40:43]
    ds_read_b64_tr_b16 v[128:129], v210 offset:16384
    v_mfma_f32_16x16x32_bf16 v[36:39], v[164:167], v[148:151], v[36:39]
    ds_read_b64_tr_b16 v[130:131], v210 offset:16896
    v_mfma_f32_16x16x32_bf16 v[32:35], v[160:163], v[148:151], v[32:35]
    ds_read_b128 v[108:111], v208 offset:18432
    v_mfma_f32_16x16x32_bf16 v[56:59], v[160:163], v[152:155], v[56:59]
    ds_read_b64_tr_b16 v[132:133], v211 offset:16384
    v_mfma_f32_16x16x32_bf16 v[60:63], v[164:167], v[152:155], v[60:63]
    ds_read_b64_tr_b16 v[134:135], v211 offset:16896
    v_mfma_f32_16x16x32_bf16 v[64:67], v[168:171], v[152:155], v[64:67]
    ds_read_b64_tr_b16 v[136:137], v210 offset:20480
    v_mfma_f32_16x16x32_bf16 v[68:71], v[172:175], v[152:155], v[68:71]
    ds_read_b64_tr_b16 v[138:139], v210 offset:20992
    s_cbranch_vccz Lskip40
    s_add_u32 s20, s15, 1280
    s_add_u32 m0, s22, 8192
    s_and_b32 s20, s20, 0x780
    buffer_load_dwordx4 v184, s[4:7], s20 offen lds
    s_add_u32 m0, s22, 9216
    s_nop 0
    buffer_load_dwordx4 v185, s[4:7], s20 offen lds
    s_add_u32 m0, s22, 10240
    s_nop 0
    buffer_load_dwordx4 v186, s[4:7], s20 offen lds
    s_add_u32 m0, s22, 11264
    s_nop 0
    buffer_load_dwordx4 v187, s[4:7], s20 offen lds
Lskip40:
    v_mfma_f32_16x16x32_bf16 v[92:95], v[172:175], v[156:159], v[92:95]
    ds_read_b64_tr_b16 v[140:141], v211 offset:20480
    v_mfma_f32_16x16x32_bf16 v[88:91], v[168:171], v[156:159], v[88:91]
    ds_read_b64_tr_b16 v[142:143], v211 offset:20992
    v_mfma_f32_16x16x32_bf16 v[84:87], v[164:167], v[156:159], v[84:87]
    ds_read_b128 v[112:115], v208 offset:20480
    v_mfma_f32_16x16x32_bf16 v[80:83], v[160:163], v[156:159], v[80:83]
    ds_read_b128 v[116:119], v208 offset:22528
    v_mfma_f32_16x16x32_bf16 v[96:99], v[156:159], v[176:179], v[96:99]
    v_mfma_f32_16x16x32_bf16 v[100:103], v[156:159], v[180:183], v[100:103]
    v_mfma_f32_16x16x32_bf16 v[76:79], v[152:155], v[180:183], v[76:79]
    v_mfma_f32_16x16x32_bf16 v[72:75], v[152:155], v[176:179], v[72:75]
    v_mfma_f32_16x16x32_bf16 v[48:51], v[148:151], v[176:179], v[48:51]
    v_mfma_f32_16x16x32_bf16 v[52:55], v[148:151], v[180:183], v[52:55]
    v_mfma_f32_16x16x32_bf16 v[28:31], v[144:147], v[180:183], v[28:31]
    v_mfma_f32_16x16x32_bf16 v[24:27], v[144:147], v[176:179], v[24:27]
    s_waitcnt lgkmcnt(0)
    v_mfma_f32_16x16x32_bf16 v[8:11], v[120:123], v[104:107], v[8:11]
    ds_read_b128 v[144:147], v209 offset:16384
    v_mfma_f32_16x16x32_bf16 v[12:15], v[124:127], v[104:107], v[12:15]
    ds_read_b64_tr_b16 v[160:161], v210 offset:24576
    s_add_u32 s13, s12, 768
    s_and_b32 s13, s13, 1023
    s_mov_b64 exec, 7
    s_mul_i32 s13, s13, 6144
    buffer_load_dword v223, v218, s[56:59], s13 offen
    s_mov_b64 exec, -1
    v_mfma_f32_16x16x32_bf16 v[16:19], v[128:131], v[104:107], v[16:19]
    ds_read_b64_tr_b16 v[162:163], v210 offset:25088
    v_mfma_f32_16x16x32_bf16 v[20:23], v[132:135], v[104:107], v[20:23]
    ds_read_b64_tr_b16 v[164:165], v211 offset:24576
    v_mfma_f32_16x16x32_bf16 v[44:47], v[132:135], v[108:111], v[44:47]
    ds_read_b64_tr_b16 v[166:167], v211 offset:25088
    v_mfma_f32_16x16x32_bf16 v[40:43], v[128:131], v[108:111], v[40:43]
    ds_read_b64_tr_b16 v[168:169], v210 offset:28672
    v_mfma_f32_16x16x32_bf16 v[36:39], v[124:127], v[108:111], v[36:39]
    ds_read_b64_tr_b16 v[170:171], v210 offset:29184
    v_mfma_f32_16x16x32_bf16 v[32:35], v[120:123], v[108:111], v[32:35]
    ds_read_b128 v[148:151], v209 offset:18432
    v_mfma_f32_16x16x32_bf16 v[56:59], v[120:123], v[112:115], v[56:59]
    ds_read_b64_tr_b16 v[172:173], v211 offset:28672
    v_mfma_f32_16x16x32_bf16 v[60:63], v[124:127], v[112:115], v[60:63]
    ds_read_b64_tr_b16 v[174:175], v211 offset:29184
    v_mfma_f32_16x16x32_bf16 v[64:67], v[128:131], v[112:115], v[64:67]
    ds_read_b64_tr_b16 v[176:177], v210 offset:32768
    v_mfma_f32_16x16x32_bf16 v[68:71], v[132:135], v[112:115], v[68:71]
    ds_read_b64_tr_b16 v[178:179], v210 offset:33280
    s_cbranch_vccz Lskip41
    s_add_u32 s21, s14, 20
    s_and_b32 s21, s21, 31
    s_add_u32 m0, s23, 0
    s_mul_i32 s21, s21, 196608
    buffer_load_dwordx4 v212, s[8:11], s21 offen lds
    s_add_u32 m0, s23, 1024
    s_nop 0
    buffer_load_dwordx4 v213, s[8:11], s21 offen lds
    s_add_u32 m0, s23, 2048
    s_nop 0
    buffer_load_dwordx4 v214, s[8:11], s21 offen lds
Lskip41:
    v_mfma_f32_16x16x32_bf16 v[92:95], v[132:135], v[116:119], v[92:95]
    ds_read_b64_tr_b16 v[180:181], v211 offset:32768
    v_mfma_f32_16x16x32_bf16 v[88:91], v[128:131], v[116:119], v[88:91]
    ds_read_b64_tr_b16 v[182:183], v211 offset:33280
    v_mfma_f32_16x16x32_bf16 v[84:87], v[124:127], v[116:119], v[84:87]
    ds_read_b128 v[152:155], v209 offset:20480
    v_mfma_f32_16x16x32_bf16 v[80:83], v[120:123], v[116:119], v[80:83]
    ds_read_b128 v[156:159], v209 offset:22528
    v_mfma_f32_16x16x32_bf16 v[96:99], v[116:119], v[136:139], v[96:99]
    v_mfma_f32_16x16x32_bf16 v[100:103], v[116:119], v[140:143], v[100:103]
    v_mfma_f32_16x16x32_bf16 v[76:79], v[112:115], v[140:143], v[76:79]
    v_mfma_f32_16x16x32_bf16 v[72:75], v[112:115], v[136:139], v[72:75]
    v_mfma_f32_16x16x32_bf16 v[48:51], v[108:111], v[136:139], v[48:51]
    v_mfma_f32_16x16x32_bf16 v[52:55], v[108:111], v[140:143], v[52:55]
    s_cbranch_vccz Lskip42
    s_add_u32 s20, s15, 1280
    s_add_u32 m0, s22, 12288
    s_and_b32 s20, s20, 0x780
    buffer_load_dwordx4 v188, s[4:7], s20 offen lds
    s_add_u32 m0, s22, 13312
    s_nop 0
    buffer_load_dwordx4 v189, s[4:7], s20 offen lds
    s_add_u32 m0, s22, 14336
    s_nop 0
    buffer_load_dwordx4 v190, s[4:7], s20 offen lds
    s_add_u32 m0, s22, 15360
    s_nop 0
    buffer_load_dwordx4 v191, s[4:7], s20 offen lds
Lskip42:
    v_mfma_f32_16x16x32_bf16 v[28:31], v[104:107], v[140:143], v[28:31]
    v_mfma_f32_16x16x32_bf16 v[24:27], v[104:107], v[136:139], v[24:27]
    s_waitcnt vmcnt(12) lgkmcnt(0)
    s_barrier
    v_mfma_f32_16x16x32_bf16 v[8:11], v[160:163], v[144:147], v[8:11]
    ds_read_b128 v[104:107], v208 offset:0
    v_mfma_f32_16x16x32_bf16 v[12:15], v[164:167], v[144:147], v[12:15]
    ds_read_b64_tr_b16 v[120:121], v210 offset:36864
    s_cbranch_vccz Lskip43
    s_add_u32 s21, s14, 21
    s_and_b32 s21, s21, 31
    s_add_u32 m0, s23, 12288
    s_mul_i32 s21, s21, 196608
    buffer_load_dwordx4 v212, s[8:11], s21 offen lds
    s_add_u32 m0, s23, 13312
    s_nop 0
    buffer_load_dwordx4 v213, s[8:11], s21 offen lds
    s_add_u32 m0, s23, 14336
    s_nop 0
    buffer_load_dwordx4 v214, s[8:11], s21 offen lds
Lskip43:
    v_mfma_f32_16x16x32_bf16 v[16:19], v[168:171], v[144:147], v[16:19]
    ds_read_b64_tr_b16 v[122:123], v210 offset:37376
    v_mfma_f32_16x16x32_bf16 v[20:23], v[172:175], v[144:147], v[20:23]
    ds_read_b64_tr_b16 v[124:125], v211 offset:36864
    v_mfma_f32_16x16x32_bf16 v[44:47], v[172:175], v[148:151], v[44:47]
    ds_read_b64_tr_b16 v[126:127], v211 offset:37376
    v_mfma_f32_16x16x32_bf16 v[40:43], v[168:171], v[148:151], v[40:43]
    ds_read_b64_tr_b16 v[128:129], v210 offset:40960
    v_mfma_f32_16x16x32_bf16 v[36:39], v[164:167], v[148:151], v[36:39]
    ds_read_b64_tr_b16 v[130:131], v210 offset:41472
    v_mfma_f32_16x16x32_bf16 v[32:35], v[160:163], v[148:151], v[32:35]
    ds_read_b128 v[108:111], v208 offset:2048
    v_mfma_f32_16x16x32_bf16 v[56:59], v[160:163], v[152:155], v[56:59]
    ds_read_b64_tr_b16 v[132:133], v211 offset:40960
    v_mfma_f32_16x16x32_bf16 v[60:63], v[164:167], v[152:155], v[60:63]
    ds_read_b64_tr_b16 v[134:135], v211 offset:41472
    v_mfma_f32_16x16x32_bf16 v[64:67], v[168:171], v[152:155], v[64:67]
    ds_read_b64_tr_b16 v[136:137], v210 offset:45056
    v_mfma_f32_16x16x32_bf16 v[68:71], v[172:175], v[152:155], v[68:71]
    ds_read_b64_tr_b16 v[138:139], v210 offset:45568
    s_cbranch_vccz Lskip44
    s_add_u32 s20, s15, 1408
    s_add_u32 m0, s22, 16384
    s_and_b32 s20, s20, 0x780
    buffer_load_dwordx4 v184, s[4:7], s20 offen lds
    s_add_u32 m0, s22, 17408
    s_nop 0
    buffer_load_dwordx4 v185, s[4:7], s20 offen lds
    s_add_u32 m0, s22, 18432
    s_nop 0
    buffer_load_dwordx4 v186, s[4:7], s20 offen lds
    s_add_u32 m0, s22, 19456
    s_nop 0
    buffer_load_dwordx4 v187, s[4:7], s20 offen lds
Lskip44:
    v_mfma_f32_16x16x32_bf16 v[92:95], v[172:175], v[156:159], v[92:95]
    ds_read_b64_tr_b16 v[140:141], v211 offset:45056
    v_mfma_f32_16x16x32_bf16 v[88:91], v[168:171], v[156:159], v[88:91]
    ds_read_b64_tr_b16 v[142:143], v211 offset:45568
    v_mfma_f32_16x16x32_bf16 v[84:87], v[164:167], v[156:159], v[84:87]
    ds_read_b128 v[112:115], v208 offset:4096
    v_mfma_f32_16x16x32_bf16 v[80:83], v[160:163], v[156:159], v[80:83]
    ds_read_b128 v[116:119], v208 offset:6144
    v_mfma_f32_16x16x32_bf16 v[96:99], v[156:159], v[176:179], v[96:99]
    v_mfma_f32_16x16x32_bf16 v[100:103], v[156:159], v[180:183], v[100:103]
    v_mfma_f32_16x16x32_bf16 v[76:79], v[152:155], v[180:183], v[76:79]
    v_mfma_f32_16x16x32_bf16 v[72:75], v[152:155], v[176:179], v[72:75]
    v_mfma_f32_16x16x32_bf16 v[48:51], v[148:151], v[176:179], v[48:51]
    v_mfma_f32_16x16x32_bf16 v[52:55], v[148:151], v[180:183], v[52:55]
    v_mfma_f32_16x16x32_bf16 v[28:31], v[144:147], v[180:183], v[28:31]
    v_mfma_f32_16x16x32_bf16 v[24:27], v[144:147], v[176:179], v[24:27]
    s_waitcnt lgkmcnt(0)
    v_mfma_f32_16x16x32_bf16 v[8:11], v[120:123], v[104:107], v[8:11]
    ds_read_b128 v[144:147], v209 offset:0
    v_mov_b32 v224, 0
    v_mfma_f32_16x16x32_bf16 v[12:15], v[124:127], v[104:107], v[12:15]
    ds_read_b64_tr_b16 v[160:161], v210 offset:49152
    s_cbranch_vccz Lskip45
    s_add_u32 s21, s14, 22
    s_and_b32 s21, s21, 31
    s_add_u32 m0, s23, 24576
    s_mul_i32 s21, s21, 196608
    buffer_load_dwordx4 v212, s[8:11], s21 offen lds
    s_add_u32 m0, s23, 25600
    s_nop 0
    buffer_load_dwordx4 v213, s[8:11], s21 offen lds
    s_add_u32 m0, s23, 26624
    s_nop 0
    buffer_load_dwordx4 v214, s[8:11], s21 offen lds
Lskip45:
    v_mov_b32 v225, 0
    v_mfma_f32_16x16x32_bf16 v[16:19], v[128:131], v[104:107], v[16:19]
    ds_read_b64_tr_b16 v[162:163], v210 offset:49664
    v_mov_b32 v226, 0
    v_mfma_f32_16x16x32_bf16 v[20:23], v[132:135], v[104:107], v[20:23]
    ds_read_b64_tr_b16 v[164:165], v211 offset:49152
    v_mov_b32 v227, 0
    v_mfma_f32_16x16x32_bf16 v[44:47], v[132:135], v[108:111], v[44:47]
    ds_read_b64_tr_b16 v[166:167], v211 offset:49664
    v_mov_b32 v228, 0
    v_mfma_f32_16x16x32_bf16 v[40:43], v[128:131], v[108:111], v[40:43]
    ds_read_b64_tr_b16 v[168:169], v210 offset:53248
    v_mov_b32 v229, 0
    v_mfma_f32_16x16x32_bf16 v[36:39], v[124:127], v[108:111], v[36:39]
    ds_read_b64_tr_b16 v[170:171], v210 offset:53760
    v_mov_b32 v230, 0
    v_mfma_f32_16x16x32_bf16 v[32:35], v[120:123], v[108:111], v[32:35]
    ds_read_b128 v[148:151], v209 offset:2048
    v_mov_b32 v231, 0
    v_mfma_f32_16x16x32_bf16 v[56:59], v[120:123], v[112:115], v[56:59]
    ds_read_b64_tr_b16 v[172:173], v211 offset:53248
    v_mov_b32 v232, 0
    v_mfma_f32_16x16x32_bf16 v[60:63], v[124:127], v[112:115], v[60:63]
    ds_read_b64_tr_b16 v[174:175], v211 offset:53760
    v_mov_b32 v233, 0
    v_mfma_f32_16x16x32_bf16 v[64:67], v[128:131], v[112:115], v[64:67]
    ds_read_b64_tr_b16 v[176:177], v210 offset:57344
    v_mov_b32 v234, 0
    v_mfma_f32_16x16x32_bf16 v[68:71], v[132:135], v[112:115], v[68:71]
    ds_read_b64_tr_b16 v[178:179], v210 offset:57856
    s_cbranch_vccz Lskip46
    s_add_u32 s20, s15, 1408
    s_add_u32 m0, s22, 20480
    s_and_b32 s20, s20, 0x780
    buffer_load_dwordx4 v188, s[4:7], s20 offen lds
    s_add_u32 m0, s22, 21504
    s_nop 0
    buffer_load_dwordx4 v189, s[4:7], s20 offen lds
    s_add_u32 m0, s22, 22528
    s_nop 0
    buffer_load_dwordx4 v190, s[4:7], s20 offen lds
    s_add_u32 m0, s22, 23552
    s_nop 0
    buffer_load_dwordx4 v191, s[4:7], s20 offen lds
Lskip46:
    v_mov_b32 v235, 0
    v_mfma_f32_16x16x32_bf16 v[92:95], v[132:135], v[116:119], v[92:95]
    ds_read_b64_tr_b16 v[180:181], v211 offset:57344
    v_mov_b32 v236, 0
    v_mfma_f32_16x16x32_bf16 v[88:91], v[128:131], v[116:119], v[88:91]
    ds_read_b64_tr_b16 v[182:183], v211 offset:57856
    v_mov_b32 v237, 0
    v_mfma_f32_16x16x32_bf16 v[84:87], v[124:127], v[116:119], v[84:87]
    ds_read_b128 v[152:155], v209 offset:4096
    v_mov_b32 v238, 0
    v_mfma_f32_16x16x32_bf16 v[80:83], v[120:123], v[116:119], v[80:83]
    ds_read_b128 v[156:159], v209 offset:6144
    v_mov_b32 v239, 0
    v_mfma_f32_16x16x32_bf16 v[96:99], v[116:119], v[136:139], v[96:99]
    v_mov_b32 v240, 0
    v_mfma_f32_16x16x32_bf16 v[100:103], v[116:119], v[140:143], v[100:103]
    v_mov_b32 v241, 0
    v_mfma_f32_16x16x32_bf16 v[76:79], v[112:115], v[140:143], v[76:79]
    v_mov_b32 v242, 0
    v_mfma_f32_16x16x32_bf16 v[72:75], v[112:115], v[136:139], v[72:75]
    v_mov_b32 v243, 0
    v_mfma_f32_16x16x32_bf16 v[48:51], v[108:111], v[136:139], v[48:51]
    v_mov_b32 v244, 0
    v_mfma_f32_16x16x32_bf16 v[52:55], v[108:111], v[140:143], v[52:55]
    v_mov_b32 v245, 0
    v_mfma_f32_16x16x32_bf16 v[28:31], v[104:107], v[140:143], v[28:31]
    v_mov_b32 v246, 0
    v_mfma_f32_16x16x32_bf16 v[24:27], v[104:107], v[136:139], v[24:27]
    v_mov_b32 v247, 0
    s_waitcnt vmcnt(11) lgkmcnt(0)
    s_barrier
    v_mfma_f32_16x16x32_bf16 v[8:11], v[160:163], v[144:147], v[8:11]
    ds_read_b128 v[104:107], v208 offset:8192
    v_mov_b32 v248, 0
    v_mfma_f32_16x16x32_bf16 v[12:15], v[164:167], v[144:147], v[12:15]
    ds_read_b64_tr_b16 v[120:121], v210 offset:0
    s_cbranch_vccz Lskip47
    s_add_u32 s21, s14, 23
    s_and_b32 s21, s21, 31
    s_add_u32 m0, s23, 36864
    s_mul_i32 s21, s21, 196608
    buffer_load_dwordx4 v212, s[8:11], s21 offen lds
    s_add_u32 m0, s23, 37888
    s_nop 0
    buffer_load_dwordx4 v213, s[8:11], s21 offen lds
    s_add_u32 m0, s23, 38912
    s_nop 0
    buffer_load_dwordx4 v214, s[8:11], s21 offen lds
Lskip47:
    v_mov_b32 v249, 0
    v_mfma_f32_16x16x32_bf16 v[16:19], v[168:171], v[144:147], v[16:19]
    ds_read_b64_tr_b16 v[122:123], v210 offset:512
    v_mov_b32 v250, 0
    v_mfma_f32_16x16x32_bf16 v[20:23], v[172:175], v[144:147], v[20:23]
    ds_read_b64_tr_b16 v[124:125], v211 offset:0
    v_mov_b32 v251, 0
    v_mfma_f32_16x16x32_bf16 v[44:47], v[172:175], v[148:151], v[44:47]
    ds_read_b64_tr_b16 v[126:127], v211 offset:512
    v_mov_b32 v252, 0
    v_mfma_f32_16x16x32_bf16 v[40:43], v[168:171], v[148:151], v[40:43]
    ds_read_b64_tr_b16 v[128:129], v210 offset:4096
    v_mov_b32 v253, 0
    v_mfma_f32_16x16x32_bf16 v[36:39], v[164:167], v[148:151], v[36:39]
    ds_read_b64_tr_b16 v[130:131], v210 offset:4608
    v_mov_b32 v254, 0
    v_mfma_f32_16x16x32_bf16 v[32:35], v[160:163], v[148:151], v[32:35]
    ds_read_b128 v[108:111], v208 offset:10240
    v_mov_b32 v255, 0
    v_mfma_f32_16x16x32_bf16 v[56:59], v[160:163], v[152:155], v[56:59]
    ds_read_b64_tr_b16 v[132:133], v211 offset:4096
    v_lshlrev_b32 v198, 4, v1
    v_mfma_f32_16x16x32_bf16 v[60:63], v[164:167], v[152:155], v[60:63]
    ds_read_b64_tr_b16 v[134:135], v211 offset:4608
    v_and_b32 v2, 7, v1
    v_mfma_f32_16x16x32_bf16 v[64:67], v[168:171], v[152:155], v[64:67]
    ds_read_b64_tr_b16 v[136:137], v210 offset:8192
    v_lshlrev_b32 v202, 3, v2
    v_mfma_f32_16x16x32_bf16 v[68:71], v[172:175], v[152:155], v[68:71]
    ds_read_b64_tr_b16 v[138:139], v210 offset:8704
    s_cbranch_vccz Lskip48
    s_add_u32 s20, s15, 1536
    s_add_u32 m0, s22, 0
    s_and_b32 s20, s20, 0x780
    buffer_load_dwordx4 v184, s[4:7], s20 offen lds
    s_add_u32 m0, s22, 1024
    s_nop 0
    buffer_load_dwordx4 v185, s[4:7], s20 offen lds
    s_add_u32 m0, s22, 2048
    s_nop 0
    buffer_load_dwordx4 v186, s[4:7], s20 offen lds
    s_add_u32 m0, s22, 3072
    s_nop 0
    buffer_load_dwordx4 v187, s[4:7], s20 offen lds
Lskip48:
    s_lshr_b32 s26, s16, 2
    v_mfma_f32_16x16x32_bf16 v[92:95], v[172:175], v[156:159], v[92:95]
    ds_read_b64_tr_b16 v[140:141], v211 offset:8192
    s_lshl_b32 s26, s26, 14
    v_mfma_f32_16x16x32_bf16 v[88:91], v[168:171], v[156:159], v[88:91]
    ds_read_b64_tr_b16 v[142:143], v211 offset:8704
    v_add_u32 v197, s26, v198
    v_mfma_f32_16x16x32_bf16 v[84:87], v[164:167], v[156:159], v[84:87]
    ds_read_b128 v[112:115], v208 offset:12288
    v_mov_b32 v196, 0xdddddddd
    v_mfma_f32_16x16x32_bf16 v[80:83], v[160:163], v[156:159], v[80:83]
    ds_read_b128 v[116:119], v208 offset:14336
    v_and_b32 v2, 7, v1
    v_mfma_f32_16x16x32_bf16 v[96:99], v[156:159], v[176:179], v[96:99]
    v_mov_b32 v3, 0x3f803f80
    v_mfma_f32_16x16x32_bf16 v[100:103], v[156:159], v[180:183], v[100:103]
    v_cmp_eq_u32 s[28:29], 0, v2
    v_mfma_f32_16x16x32_bf16 v[76:79], v[152:155], v[180:183], v[76:79]
    v_cmp_eq_u32 s[30:31], 4, v2
    v_mfma_f32_16x16x32_bf16 v[72:75], v[152:155], v[176:179], v[72:75]
    v_cndmask_b32 v192, 0, v3, s[28:29]
    v_mfma_f32_16x16x32_bf16 v[48:51], v[148:151], v[176:179], v[48:51]
    v_cndmask_b32 v193, 0, v3, s[28:29]
    v_mfma_f32_16x16x32_bf16 v[52:55], v[148:151], v[180:183], v[52:55]
    v_cndmask_b32 v194, 0, v3, s[30:31]
    v_mfma_f32_16x16x32_bf16 v[28:31], v[144:147], v[180:183], v[28:31]
    v_cndmask_b32 v195, 0, v3, s[30:31]
    v_mfma_f32_16x16x32_bf16 v[24:27], v[144:147], v[176:179], v[24:27]
    s_waitcnt lgkmcnt(0)
    v_mfma_f32_16x16x32_bf16 v[8:11], v[120:123], v[104:107], v[8:11]
    ds_read_b128 v[144:147], v209 offset:8192
    v_and_b32 v2, 15, v1
    v_mfma_f32_16x16x32_bf16 v[12:15], v[124:127], v[104:107], v[12:15]
    ds_read_b64_tr_b16 v[160:161], v210 offset:12288
    s_cbranch_vccz Lskip49
    s_add_u32 s21, s14, 24
    s_and_b32 s21, s21, 31
    s_add_u32 m0, s23, 49152
    s_mul_i32 s21, s21, 196608
    buffer_load_dwordx4 v212, s[8:11], s21 offen lds
    s_add_u32 m0, s23, 50176
    s_nop 0
    buffer_load_dwordx4 v213, s[8:11], s21 offen lds
    s_add_u32 m0, s23, 51200
    s_nop 0
    buffer_load_dwordx4 v214, s[8:11], s21 offen lds
Lskip49:
    v_lshrrev_b32 v4, 4, v1
    v_mfma_f32_16x16x32_bf16 v[16:19], v[128:131], v[104:107], v[16:19]
    ds_read_b64_tr_b16 v[162:163], v210 offset:12800
    v_lshlrev_b32 v4, 9, v4
    v_mfma_f32_16x16x32_bf16 v[20:23], v[132:135], v[104:107], v[20:23]
    ds_read_b64_tr_b16 v[164:165], v211 offset:12288
    v_lshl_add_u32 v205, v2, 4, v4
    v_mfma_f32_16x16x32_bf16 v[44:47], v[132:135], v[108:111], v[44:47]
    ds_read_b64_tr_b16 v[166:167], v211 offset:12800
    v_bfe_u32 v2, v1, 2, 1
    v_mfma_f32_16x16x32_bf16 v[40:43], v[128:131], v[108:111], v[40:43]
    ds_read_b64_tr_b16 v[168:169], v210 offset:16384
    v_bfe_u32 v3, v1, 3, 2
    v_mfma_f32_16x16x32_bf16 v[36:39], v[124:127], v[108:111], v[36:39]
    ds_read_b64_tr_b16 v[170:171], v210 offset:16896
    v_and_b32 v4, 35, v1
    v_mfma_f32_16x16x32_bf16 v[32:35], v[120:123], v[108:111], v[32:35]
    ds_read_b128 v[148:151], v209 offset:10240
    v_lshl_add_u32 v4, v2, 4, v4
    v_mfma_f32_16x16x32_bf16 v[56:59], v[120:123], v[112:115], v[56:59]
    ds_read_b64_tr_b16 v[172:173], v211 offset:16384
    v_lshl_add_u32 v4, v3, 2, v4
    v_mfma_f32_16x16x32_bf16 v[60:63], v[124:127], v[112:115], v[60:63]
    ds_read_b64_tr_b16 v[174:175], v211 offset:16896
    v_lshlrev_b32 v206, 4, v4
    v_mfma_f32_16x16x32_bf16 v[64:67], v[128:131], v[112:115], v[64:67]
    ds_read_b64_tr_b16 v[176:177], v210 offset:20480
    v_sub_u32 v2, v197, v198
    v_mfma_f32_16x16x32_bf16 v[68:71], v[132:135], v[112:115], v[68:71]
    ds_read_b64_tr_b16 v[178:179], v210 offset:20992
    s_cbranch_vccz Lskip50
    s_add_u32 s20, s15, 1536
    s_add_u32 m0, s22, 4096
    s_and_b32 s20, s20, 0x780
    buffer_load_dwordx4 v188, s[4:7], s20 offen lds
    s_add_u32 m0, s22, 5120
    s_nop 0
    buffer_load_dwordx4 v189, s[4:7], s20 offen lds
    s_add_u32 m0, s22, 6144
    s_nop 0
    buffer_load_dwordx4 v190, s[4:7], s20 offen lds
    s_add_u32 m0, s22, 7168
    s_nop 0
    buffer_load_dwordx4 v191, s[4:7], s20 offen lds
Lskip50:
    v_add_u32 v204, v2, v206
    v_mfma_f32_16x16x32_bf16 v[92:95], v[132:135], v[116:119], v[92:95]
    ds_read_b64_tr_b16 v[180:181], v211 offset:20480
    s_and_b32 s26, s16, 2
    v_mfma_f32_16x16x32_bf16 v[88:91], v[128:131], v[116:119], v[88:91]
    ds_read_b64_tr_b16 v[182:183], v211 offset:20992
    s_lshl_b32 s26, s26, 14
    v_mfma_f32_16x16x32_bf16 v[84:87], v[124:127], v[116:119], v[84:87]
    ds_read_b128 v[152:155], v209 offset:12288
    s_and_b32 s27, s16, 1
    v_mfma_f32_16x16x32_bf16 v[80:83], v[120:123], v[116:119], v[80:83]
    ds_read_b128 v[156:159], v209 offset:14336
    s_lshl_b32 s27, s27, 13
    v_mfma_f32_16x16x32_bf16 v[96:99], v[116:119], v[136:139], v[96:99]
    s_add_u32 s26, s26, s27
    v_mfma_f32_16x16x32_bf16 v[100:103], v[116:119], v[140:143], v[100:103]
    s_lshr_b32 s27, s16, 2
    v_mfma_f32_16x16x32_bf16 v[76:79], v[112:115], v[140:143], v[76:79]
    s_lshl_b32 s27, s27, 14
    v_mfma_f32_16x16x32_bf16 v[72:75], v[112:115], v[136:139], v[72:75]
    s_add_u32 s26, s26, s27
    v_mfma_f32_16x16x32_bf16 v[48:51], v[108:111], v[136:139], v[48:51]
    v_add_u32 v207, s26, v205
    v_mfma_f32_16x16x32_bf16 v[52:55], v[108:111], v[140:143], v[52:55]
    v_mfma_f32_16x16x32_bf16 v[28:31], v[104:107], v[140:143], v[28:31]
    v_mfma_f32_16x16x32_bf16 v[24:27], v[104:107], v[136:139], v[24:27]
    s_waitcnt vmcnt(11) lgkmcnt(0)
    s_barrier
    v_mfma_f32_16x16x32_bf16 v[8:11], v[160:163], v[144:147], v[8:11]
    ds_read_b128 v[104:107], v208 offset:16384
    v_lshrrev_b32 v2, 3, v1
    v_mfma_f32_16x16x32_bf16 v[12:15], v[164:167], v[144:147], v[12:15]
    ds_read_b64_tr_b16 v[120:121], v210 offset:24576
    s_cbranch_vccz Lskip51
    s_add_u32 s21, s14, 25
    s_and_b32 s21, s21, 31
    s_add_u32 m0, s23, 0
    s_mul_i32 s21, s21, 196608
    buffer_load_dwordx4 v212, s[8:11], s21 offen lds
    s_add_u32 m0, s23, 1024
    s_nop 0
    buffer_load_dwordx4 v213, s[8:11], s21 offen lds
    s_add_u32 m0, s23, 2048
    s_nop 0
    buffer_load_dwordx4 v214, s[8:11], s21 offen lds
Lskip51:
    v_and_b32 v3, 7, v1
    v_mfma_f32_16x16x32_bf16 v[16:19], v[168:171], v[144:147], v[16:19]
    ds_read_b64_tr_b16 v[122:123], v210 offset:25088
    v_lshrrev_b32 v4, 4, v1
    v_mfma_f32_16x16x32_bf16 v[20:23], v[172:175], v[144:147], v[20:23]
    ds_read_b64_tr_b16 v[124:125], v211 offset:24576
    v_lshlrev_b32 v4, 1, v4
    v_mfma_f32_16x16x32_bf16 v[44:47], v[172:175], v[148:151], v[44:47]
    ds_read_b64_tr_b16 v[126:127], v211 offset:25088
    v_xor_b32 v4, v3, v4
    v_mfma_f32_16x16x32_bf16 v[40:43], v[168:171], v[148:151], v[40:43]
    ds_read_b64_tr_b16 v[128:129], v210 offset:28672
    v_lshlrev_b32 v4, 4, v4
    v_mfma_f32_16x16x32_bf16 v[36:39], v[164:167], v[148:151], v[36:39]
    ds_read_b64_tr_b16 v[130:131], v210 offset:29184
    v_lshl_add_u32 v199, v2, 11, v4
    v_mfma_f32_16x16x32_bf16 v[32:35], v[160:163], v[148:151], v[32:35]
    ds_read_b128 v[108:111], v208 offset:18432
    s_cmp_eq_u32 s17, 0
    s_cselect_b32 s26, s36, s42
    s_cselect_b32 s27, s37, s43
    v_mfma_f32_16x16x32_bf16 v[56:59], v[160:163], v[152:155], v[56:59]
    ds_read_b64_tr_b16 v[132:133], v211 offset:28672
    s_lshl_b32 s30, s19, 7
    v_mfma_f32_16x16x32_bf16 v[60:63], v[164:167], v[152:155], v[60:63]
    ds_read_b64_tr_b16 v[134:135], v211 offset:29184
    s_sub_u32 s31, 2097152, s30
    v_mfma_f32_16x16x32_bf16 v[64:67], v[168:171], v[152:155], v[64:67]
    ds_read_b64_tr_b16 v[136:137], v210 offset:32768
    s_add_u32 s52, s26, s30
    s_addc_u32 s53, s27, 0
    v_mfma_f32_16x16x32_bf16 v[68:71], v[172:175], v[152:155], v[68:71]
    ds_read_b64_tr_b16 v[138:139], v210 offset:33280
    s_cbranch_vccz Lskip52
    s_add_u32 s20, s15, 1664
    s_add_u32 m0, s22, 8192
    s_and_b32 s20, s20, 0x780
    buffer_load_dwordx4 v184, s[4:7], s20 offen lds
    s_add_u32 m0, s22, 9216
    s_nop 0
    buffer_load_dwordx4 v185, s[4:7], s20 offen lds
    s_add_u32 m0, s22, 10240
    s_nop 0
    buffer_load_dwordx4 v186, s[4:7], s20 offen lds
    s_add_u32 m0, s22, 11264
    s_nop 0
    buffer_load_dwordx4 v187, s[4:7], s20 offen lds
Lskip52:
    s_and_b32 s53, s53, 0xffff
    v_mfma_f32_16x16x32_bf16 v[92:95], v[172:175], v[156:159], v[92:95]
    ds_read_b64_tr_b16 v[140:141], v211 offset:32768
    s_mov_b32 s54, s31
    v_mfma_f32_16x16x32_bf16 v[88:91], v[168:171], v[156:159], v[88:91]
    ds_read_b64_tr_b16 v[142:143], v211 offset:33280
    s_mov_b32 s55, 0x00020000
    v_mfma_f32_16x16x32_bf16 v[84:87], v[164:167], v[156:159], v[84:87]
    ds_read_b128 v[112:115], v208 offset:20480
    s_mov_b32 s92, s46
    v_mfma_f32_16x16x32_bf16 v[80:83], v[160:163], v[156:159], v[80:83]
    ds_read_b128 v[116:119], v208 offset:22528
    s_and_b32 s93, s47, 0xffff
    v_mfma_f32_16x16x32_bf16 v[96:99], v[156:159], v[176:179], v[96:99]
    s_mov_b32 s94, 256
    v_mfma_f32_16x16x32_bf16 v[100:103], v[156:159], v[180:183], v[100:103]
    s_mov_b32 s95, 0x00020000
    v_mfma_f32_16x16x32_bf16 v[76:79], v[152:155], v[180:183], v[76:79]
    v_mfma_f32_16x16x32_bf16 v[72:75], v[152:155], v[176:179], v[72:75]
    v_mfma_f32_16x16x32_bf16 v[48:51], v[148:151], v[176:179], v[48:51]
    v_mfma_f32_16x16x32_bf16 v[52:55], v[148:151], v[180:183], v[52:55]
    v_mfma_f32_16x16x32_bf16 v[28:31], v[144:147], v[180:183], v[28:31]
    v_mfma_f32_16x16x32_bf16 v[24:27], v[144:147], v[176:179], v[24:27]
    s_waitcnt lgkmcnt(0)
    v_mfma_f32_16x16x32_bf16 v[8:11], v[120:123], v[104:107], v[8:11]
    ds_read_b128 v[144:147], v209 offset:16384
    s_lshl_b32 s28, s17, 4
    v_mfma_f32_16x16x32_bf16 v[12:15], v[124:127], v[104:107], v[12:15]
    ds_read_b64_tr_b16 v[160:161], v210 offset:36864
    s_cbranch_vccz Lskip53
    s_add_u32 s21, s14, 26
    s_and_b32 s21, s21, 31
    s_add_u32 m0, s23, 12288
    s_mul_i32 s21, s21, 196608
    buffer_load_dwordx4 v212, s[8:11], s21 offen lds
    s_add_u32 m0, s23, 13312
    s_nop 0
    buffer_load_dwordx4 v213, s[8:11], s21 offen lds
    s_add_u32 m0, s23, 14336
    s_nop 0
    buffer_load_dwordx4 v214, s[8:11], s21 offen lds
Lskip53:
    s_add_u32 s28, s28, s19
    v_mfma_f32_16x16x32_bf16 v[16:19], v[128:131], v[104:107], v[16:19]
    ds_read_b64_tr_b16 v[162:163], v210 offset:37376
    s_lshl_b32 s28, s28, 10
    v_mfma_f32_16x16x32_bf16 v[20:23], v[132:135], v[104:107], v[20:23]
    ds_read_b64_tr_b16 v[164:165], v211 offset:36864
    s_add_u32 s30, s28, 33554432
    v_mfma_f32_16x16x32_bf16 v[44:47], v[132:135], v[108:111], v[44:47]
    ds_read_b64_tr_b16 v[166:167], v211 offset:37376
    s_lshl_b32 s28, s17, 3
    v_mfma_f32_16x16x32_bf16 v[40:43], v[128:131], v[108:111], v[40:43]
    ds_read_b64_tr_b16 v[168:169], v210 offset:40960
    s_add_u32 s28, s28, s18
    v_mfma_f32_16x16x32_bf16 v[36:39], v[124:127], v[108:111], v[36:39]
    ds_read_b64_tr_b16 v[170:171], v210 offset:41472
    s_lshl_b32 s28, s28, 11
    v_mfma_f32_16x16x32_bf16 v[32:35], v[120:123], v[108:111], v[32:35]
    ds_read_b128 v[148:151], v209 offset:18432
    s_add_u32 s31, s28, 34603008
    v_mfma_f32_16x16x32_bf16 v[56:59], v[120:123], v[112:115], v[56:59]
    ds_read_b64_tr_b16 v[172:173], v211 offset:40960
    s_mov_b32 s76, s48
    v_mfma_f32_16x16x32_bf16 v[60:63], v[124:127], v[112:115], v[60:63]
    ds_read_b64_tr_b16 v[174:175], v211 offset:41472
    s_and_b32 s77, s49, 0xffff
    v_mfma_f32_16x16x32_bf16 v[64:67], v[128:131], v[112:115], v[64:67]
    ds_read_b64_tr_b16 v[176:177], v210 offset:45056
    s_mov_b32 s78, 35651584
    v_mfma_f32_16x16x32_bf16 v[68:71], v[132:135], v[112:115], v[68:71]
    ds_read_b64_tr_b16 v[178:179], v210 offset:45568
    s_cbranch_vccz Lskip54
    s_add_u32 s20, s15, 1664
    s_add_u32 m0, s22, 12288
    s_and_b32 s20, s20, 0x780
    buffer_load_dwordx4 v188, s[4:7], s20 offen lds
    s_add_u32 m0, s22, 13312
    s_nop 0
    buffer_load_dwordx4 v189, s[4:7], s20 offen lds
    s_add_u32 m0, s22, 14336
    s_nop 0
    buffer_load_dwordx4 v190, s[4:7], s20 offen lds
    s_add_u32 m0, s22, 15360
    s_nop 0
    buffer_load_dwordx4 v191, s[4:7], s20 offen lds
Lskip54:
    s_mov_b32 s79, 0x00020000
    v_mfma_f32_16x16x32_bf16 v[92:95], v[132:135], v[116:119], v[92:95]
    ds_read_b64_tr_b16 v[180:181], v211 offset:45056
    v_lshlrev_b32 v2, 7, v1
    v_mfma_f32_16x16x32_bf16 v[88:91], v[128:131], v[116:119], v[88:91]
    ds_read_b64_tr_b16 v[182:183], v211 offset:45568
    s_cbranch_vccnz Lskip1
    s_mov_b64 exec, 0xff
    buffer_load_dword v223, v2, s[76:79], s30 offen sc1
    s_mov_b64 exec, 0xffff
    buffer_load_dword v223, v2, s[76:79], s31 offen sc1
    s_mov_b64 exec, -1
Lskip1:
    v_mfma_f32_16x16x32_bf16 v[84:87], v[124:127], v[116:119], v[84:87]
    ds_read_b128 v[152:155], v209 offset:20480
    v_mfma_f32_16x16x32_bf16 v[80:83], v[120:123], v[116:119], v[80:83]
    ds_read_b128 v[156:159], v209 offset:22528
    v_mfma_f32_16x16x32_bf16 v[96:99], v[116:119], v[136:139], v[96:99]
    v_mfma_f32_16x16x32_bf16 v[100:103], v[116:119], v[140:143], v[100:103]
    v_mfma_f32_16x16x32_bf16 v[76:79], v[112:115], v[140:143], v[76:79]
    v_mfma_f32_16x16x32_bf16 v[72:75], v[112:115], v[136:139], v[72:75]
    v_mfma_f32_16x16x32_bf16 v[48:51], v[108:111], v[136:139], v[48:51]
    v_mfma_f32_16x16x32_bf16 v[52:55], v[108:111], v[140:143], v[52:55]
    v_mfma_f32_16x16x32_bf16 v[28:31], v[104:107], v[140:143], v[28:31]
    v_mfma_f32_16x16x32_bf16 v[24:27], v[104:107], v[136:139], v[24:27]
    s_waitcnt vmcnt(11) lgkmcnt(0)
    s_barrier
    v_mfma_f32_16x16x32_bf16 v[8:11], v[160:163], v[144:147], v[8:11]
    ds_read_b128 v[104:107], v208 offset:0
    s_lshl_b32 s28, s17, 3
    v_mfma_f32_16x16x32_bf16 v[12:15], v[164:167], v[144:147], v[12:15]
    ds_read_b64_tr_b16 v[120:121], v210 offset:49152
    s_cbranch_vccz Lskip55
    s_add_u32 s21, s14, 27
    s_and_b32 s21, s21, 31
    s_add_u32 m0, s23, 24576
    s_mul_i32 s21, s21, 196608
    buffer_load_dwordx4 v212, s[8:11], s21 offen lds
    s_add_u32 m0, s23, 25600
    s_nop 0
    buffer_load_dwordx4 v213, s[8:11], s21 offen lds
    s_add_u32 m0, s23, 26624
    s_nop 0
    buffer_load_dwordx4 v214, s[8:11], s21 offen lds
Lskip55:
    s_add_u32 s28, s28, s18
    v_mfma_f32_16x16x32_bf16 v[16:19], v[168:171], v[144:147], v[16:19]
    ds_read_b64_tr_b16 v[122:123], v210 offset:49664
    s_lshl_b32 s28, s28, 11
    v_mfma_f32_16x16x32_bf16 v[20:23], v[172:175], v[144:147], v[20:23]
    ds_read_b64_tr_b16 v[124:125], v211 offset:49152
    s_add_u32 s30, s28, 34603008
    v_mfma_f32_16x16x32_bf16 v[44:47], v[172:175], v[148:151], v[44:47]
    ds_read_b64_tr_b16 v[126:127], v211 offset:49664
    s_add_u32 s76, s48, s30
    s_addc_u32 s77, s49, 0
    v_mfma_f32_16x16x32_bf16 v[40:43], v[168:171], v[148:151], v[40:43]
    ds_read_b64_tr_b16 v[128:129], v210 offset:53248
    s_and_b32 s77, s77, 0xffff
    v_mfma_f32_16x16x32_bf16 v[36:39], v[164:167], v[148:151], v[36:39]
    ds_read_b64_tr_b16 v[130:131], v210 offset:53760
    s_mov_b32 s78, 2048
    v_mfma_f32_16x16x32_bf16 v[32:35], v[160:163], v[148:151], v[32:35]
    ds_read_b128 v[108:111], v208 offset:2048
    s_mov_b32 s79, 0x00020000
    v_mfma_f32_16x16x32_bf16 v[56:59], v[160:163], v[152:155], v[56:59]
    ds_read_b64_tr_b16 v[132:133], v211 offset:53248
    s_lshl_b32 s28, s17, 22
    v_mfma_f32_16x16x32_bf16 v[60:63], v[164:167], v[152:155], v[60:63]
    ds_read_b64_tr_b16 v[134:135], v211 offset:53760
    s_lshl_b32 s29, s18, 19
    v_mfma_f32_16x16x32_bf16 v[64:67], v[168:171], v[152:155], v[64:67]
    ds_read_b64_tr_b16 v[136:137], v210 offset:57344
    s_add_u32 s30, s28, s29
    v_mfma_f32_16x16x32_bf16 v[68:71], v[172:175], v[152:155], v[68:71]
    ds_read_b64_tr_b16 v[138:139], v210 offset:57856
    s_cbranch_vccz Lskip56
    s_add_u32 s20, s15, 1792
    s_add_u32 m0, s22, 16384
    s_and_b32 s20, s20, 0x780
    buffer_load_dwordx4 v184, s[4:7], s20 offen lds
    s_add_u32 m0, s22, 17408
    s_nop 0
    buffer_load_dwordx4 v185, s[4:7], s20 offen lds
    s_add_u32 m0, s22, 18432
    s_nop 0
    buffer_load_dwordx4 v186, s[4:7], s20 offen lds
    s_add_u32 m0, s22, 19456
    s_nop 0
    buffer_load_dwordx4 v187, s[4:7], s20 offen lds
Lskip56:
    s_lshl_b32 s29, s16, 16
    v_mfma_f32_16x16x32_bf16 v[92:95], v[172:175], v[156:159], v[92:95]
    ds_read_b64_tr_b16 v[140:141], v211 offset:57344
    s_add_u32 s30, s30, s29
    v_mfma_f32_16x16x32_bf16 v[88:91], v[168:171], v[156:159], v[88:91]
    ds_read_b64_tr_b16 v[142:143], v211 offset:57856
    s_add_u32 s30, s30, 25165824
    v_mfma_f32_16x16x32_bf16 v[84:87], v[164:167], v[156:159], v[84:87]
    ds_read_b128 v[112:115], v208 offset:4096
    s_add_u32 s32, s48, s30
    s_addc_u32 s33, s49, 0
    v_mfma_f32_16x16x32_bf16 v[80:83], v[160:163], v[156:159], v[80:83]
    ds_read_b128 v[116:119], v208 offset:6144
    s_and_b32 s33, s33, 0xffff
    v_mfma_f32_16x16x32_bf16 v[96:99], v[156:159], v[176:179], v[96:99]
    s_mov_b32 s34, 65536
    v_mfma_f32_16x16x32_bf16 v[100:103], v[156:159], v[180:183], v[100:103]
    s_mov_b32 s35, 0x00020000
    v_mfma_f32_16x16x32_bf16 v[76:79], v[152:155], v[180:183], v[76:79]
    v_mfma_f32_16x16x32_bf16 v[72:75], v[152:155], v[176:179], v[72:75]
    v_mfma_f32_16x16x32_bf16 v[48:51], v[148:151], v[176:179], v[48:51]
    v_mfma_f32_16x16x32_bf16 v[52:55], v[148:151], v[180:183], v[52:55]
    v_mfma_f32_16x16x32_bf16 v[28:31], v[144:147], v[180:183], v[28:31]
    v_mfma_f32_16x16x32_bf16 v[24:27], v[144:147], v[176:179], v[24:27]
    s_waitcnt lgkmcnt(0)
    v_mfma_f32_16x16x32_bf16 v[8:11], v[120:123], v[104:107], v[8:11]
    ds_read_b128 v[144:147], v209 offset:0
    s_lshl_b32 s28, s18, 20
    v_mfma_f32_16x16x32_bf16 v[12:15], v[124:127], v[104:107], v[12:15]
    ds_read_b64_tr_b16 v[160:161], v210 offset:0
    s_cbranch_vccz Lskip57
    s_add_u32 s21, s14, 28
    s_and_b32 s21, s21, 31
    s_add_u32 m0, s23, 36864
    s_mul_i32 s21, s21, 196608
    buffer_load_dwordx4 v212, s[8:11], s21 offen lds
    s_add_u32 m0, s23, 37888
    s_nop 0
    buffer_load_dwordx4 v213, s[8:11], s21 offen lds
    s_add_u32 m0, s23, 38912
    s_nop 0
    buffer_load_dwordx4 v214, s[8:11], s21 offen lds
Lskip57:
    s_lshl_b32 s29, s16, 17
    v_mfma_f32_16x16x32_bf16 v[16:19], v[128:131], v[104:107], v[16:19]
    ds_read_b64_tr_b16 v[162:163], v210 offset:512
    s_add_u32 s30, s28, s29
    v_mfma_f32_16x16x32_bf16 v[20:23], v[132:135], v[104:107], v[20:23]
    ds_read_b64_tr_b16 v[164:165], v211 offset:0
    s_lshl_b32 s29, s17, 11
    v_mfma_f32_16x16x32_bf16 v[44:47], v[132:135], v[108:111], v[44:47]
    ds_read_b64_tr_b16 v[166:167], v211 offset:512
    s_add_u32 s30, s30, s29
    v_mfma_f32_16x16x32_bf16 v[40:43], v[128:131], v[108:111], v[40:43]
    ds_read_b64_tr_b16 v[168:169], v210 offset:4096
    s_lshl_b32 s29, s19, 7
    v_mfma_f32_16x16x32_bf16 v[36:39], v[124:127], v[108:111], v[36:39]
    ds_read_b64_tr_b16 v[170:171], v210 offset:4608
    s_add_u32 s30, s30, s29
    v_mfma_f32_16x16x32_bf16 v[32:35], v[120:123], v[108:111], v[32:35]
    ds_read_b128 v[148:151], v209 offset:2048
    s_sub_u32 s31, 8388608, s30
    v_mfma_f32_16x16x32_bf16 v[56:59], v[120:123], v[112:115], v[56:59]
    ds_read_b64_tr_b16 v[172:173], v211 offset:4096
    s_add_u32 s36, s44, s30
    s_addc_u32 s37, s45, 0
    v_mfma_f32_16x16x32_bf16 v[60:63], v[124:127], v[112:115], v[60:63]
    ds_read_b64_tr_b16 v[174:175], v211 offset:4608
    s_and_b32 s37, s37, 0xffff
    v_mfma_f32_16x16x32_bf16 v[64:67], v[128:131], v[112:115], v[64:67]
    ds_read_b64_tr_b16 v[176:177], v210 offset:8192
    s_mov_b32 s38, s31
    v_mfma_f32_16x16x32_bf16 v[68:71], v[132:135], v[112:115], v[68:71]
    ds_read_b64_tr_b16 v[178:179], v210 offset:8704
    s_cbranch_vccz Lskip58
    s_add_u32 s20, s15, 1792
    s_add_u32 m0, s22, 20480
    s_and_b32 s20, s20, 0x780
    buffer_load_dwordx4 v188, s[4:7], s20 offen lds
    s_add_u32 m0, s22, 21504
    s_nop 0
    buffer_load_dwordx4 v189, s[4:7], s20 offen lds
    s_add_u32 m0, s22, 22528
    s_nop 0
    buffer_load_dwordx4 v190, s[4:7], s20 offen lds
    s_add_u32 m0, s22, 23552
    s_nop 0
    buffer_load_dwordx4 v191, s[4:7], s20 offen lds
Lskip58:
    s_mov_b32 s39, 0x00020000
    v_mfma_f32_16x16x32_bf16 v[92:95], v[132:135], v[116:119], v[92:95]
    ds_read_b64_tr_b16 v[180:181], v211 offset:8192
    s_and_b32 s26, s19, 8
    v_mfma_f32_16x16x32_bf16 v[88:91], v[128:131], v[116:119], v[88:91]
    ds_read_b64_tr_b16 v[182:183], v211 offset:8704
    s_lshl_b32 s27, s26, 11
    v_mfma_f32_16x16x32_bf16 v[84:87], v[124:127], v[116:119], v[84:87]
    ds_read_b128 v[152:155], v209 offset:4096
    v_add_u32 v216, s27, v198
    v_mfma_f32_16x16x32_bf16 v[80:83], v[120:123], v[116:119], v[80:83]
    ds_read_b128 v[156:159], v209 offset:6144
    v_add_u32 v217, 32768, v216
    v_mfma_f32_16x16x32_bf16 v[96:99], v[116:119], v[136:139], v[96:99]
    v_xor_b32 v218, 16384, v216
    v_mfma_f32_16x16x32_bf16 v[100:103], v[116:119], v[140:143], v[100:103]
    v_xor_b32 v219, 16384, v217
    v_mfma_f32_16x16x32_bf16 v[76:79], v[112:115], v[140:143], v[76:79]
    s_lshl_b32 s26, s26, 4
    v_mfma_f32_16x16x32_bf16 v[72:75], v[112:115], v[136:139], v[72:75]
    s_lshr_b32 s27, s16, 1
    v_mfma_f32_16x16x32_bf16 v[48:51], v[108:111], v[136:139], v[48:51]
    s_lshl_b32 s27, s27, 9
    v_mfma_f32_16x16x32_bf16 v[52:55], v[108:111], v[140:143], v[52:55]
    s_add_u32 s40, s26, s27
    v_mfma_f32_16x16x32_bf16 v[28:31], v[104:107], v[140:143], v[28:31]
    v_mfma_f32_16x16x32_bf16 v[24:27], v[104:107], v[136:139], v[24:27]
    s_waitcnt vmcnt(11) lgkmcnt(0)
    s_barrier
    v_mfma_f32_16x16x32_bf16 v[8:11], v[160:163], v[144:147], v[8:11]
    ds_read_b128 v[104:107], v208 offset:8192
    s_add_u32 s26, s19, 0
    v_mfma_f32_16x16x32_bf16 v[12:15], v[164:167], v[144:147], v[12:15]
    ds_read_b64_tr_b16 v[120:121], v210 offset:12288
    s_cbranch_vccz Lskip59
    s_add_u32 s21, s14, 29
    s_and_b32 s21, s21, 31
    s_add_u32 m0, s23, 49152
    s_mul_i32 s21, s21, 196608
    buffer_load_dwordx4 v212, s[8:11], s21 offen lds
    s_add_u32 m0, s23, 50176
    s_nop 0
    buffer_load_dwordx4 v213, s[8:11], s21 offen lds
    s_add_u32 m0, s23, 51200
    s_nop 0
    buffer_load_dwordx4 v214, s[8:11], s21 offen lds
Lskip59:
    s_and_b32 s26, s26, 7
    v_mfma_f32_16x16x32_bf16 v[16:19], v[168:171], v[144:147], v[16:19]
    ds_read_b64_tr_b16 v[122:123], v210 offset:12800
    s_lshl_b32 s64, s26, 11
    v_mfma_f32_16x16x32_bf16 v[20:23], v[172:175], v[144:147], v[20:23]
    ds_read_b64_tr_b16 v[124:125], v211 offset:12288
    s_add_u32 s26, s19, 1
    v_mfma_f32_16x16x32_bf16 v[44:47], v[172:175], v[148:151], v[44:47]
    ds_read_b64_tr_b16 v[126:127], v211 offset:12800
    s_and_b32 s26, s26, 7
    v_mfma_f32_16x16x32_bf16 v[40:43], v[168:171], v[148:151], v[40:43]
    ds_read_b64_tr_b16 v[128:129], v210 offset:16384
    s_lshl_b32 s65, s26, 11
    v_mfma_f32_16x16x32_bf16 v[36:39], v[164:167], v[148:151], v[36:39]
    ds_read_b64_tr_b16 v[130:131], v210 offset:16896
    s_add_u32 s26, s19, 2
    v_mfma_f32_16x16x32_bf16 v[32:35], v[160:163], v[148:151], v[32:35]
    ds_read_b128 v[108:111], v208 offset:10240
    s_and_b32 s26, s26, 7
    v_mfma_f32_16x16x32_bf16 v[56:59], v[160:163], v[152:155], v[56:59]
    ds_read_b64_tr_b16 v[132:133], v211 offset:16384
    s_lshl_b32 s66, s26, 11
    v_mfma_f32_16x16x32_bf16 v[60:63], v[164:167], v[152:155], v[60:63]
    ds_read_b64_tr_b16 v[134:135], v211 offset:16896
    s_add_u32 s26, s19, 3
    v_mfma_f32_16x16x32_bf16 v[64:67], v[168:171], v[152:155], v[64:67]
    ds_read_b64_tr_b16 v[136:137], v210 offset:20480
    s_and_b32 s26, s26, 7
    v_mfma_f32_16x16x32_bf16 v[68:71], v[172:175], v[152:155], v[68:71]
    ds_read_b64_tr_b16 v[138:139], v210 offset:20992
    s_cbranch_vccz Lskip60
    s_add_u32 s20, s15, 1920
    s_add_u32 m0, s22, 0
    s_and_b32 s20, s20, 0x780
    buffer_load_dwordx4 v184, s[4:7], s20 offen lds
    s_add_u32 m0, s22, 1024
    s_nop 0
    buffer_load_dwordx4 v185, s[4:7], s20 offen lds
    s_add_u32 m0, s22, 2048
    s_nop 0
    buffer_load_dwordx4 v186, s[4:7], s20 offen lds
    s_add_u32 m0, s22, 3072
    s_nop 0
    buffer_load_dwordx4 v187, s[4:7], s20 offen lds
Lskip60:
    s_lshl_b32 s67, s26, 11
    v_mfma_f32_16x16x32_bf16 v[92:95], v[172:175], v[156:159], v[92:95]
    ds_read_b64_tr_b16 v[140:141], v211 offset:20480
    s_add_u32 s26, s19, 4
    v_mfma_f32_16x16x32_bf16 v[88:91], v[168:171], v[156:159], v[88:91]
    ds_read_b64_tr_b16 v[142:143], v211 offset:20992
    s_and_b32 s26, s26, 7
    v_mfma_f32_16x16x32_bf16 v[84:87], v[164:167], v[156:159], v[84:87]
    ds_read_b128 v[112:115], v208 offset:12288
    s_lshl_b32 s68, s26, 11
    v_mfma_f32_16x16x32_bf16 v[80:83], v[160:163], v[156:159], v[80:83]
    ds_read_b128 v[116:119], v208 offset:14336
    s_add_u32 s26, s19, 5
    v_mfma_f32_16x16x32_bf16 v[96:99], v[156:159], v[176:179], v[96:99]
    s_and_b32 s26, s26, 7
    v_mfma_f32_16x16x32_bf16 v[100:103], v[156:159], v[180:183], v[100:103]
    s_lshl_b32 s69, s26, 11
    v_mfma_f32_16x16x32_bf16 v[76:79], v[152:155], v[180:183], v[76:79]
    s_add_u32 s26, s19, 6
    v_mfma_f32_16x16x32_bf16 v[72:75], v[152:155], v[176:179], v[72:75]
    s_and_b32 s26, s26, 7
    v_mfma_f32_16x16x32_bf16 v[48:51], v[148:151], v[176:179], v[48:51]
    s_lshl_b32 s70, s26, 11
    v_mfma_f32_16x16x32_bf16 v[52:55], v[148:151], v[180:183], v[52:55]
    s_add_u32 s26, s19, 7
    v_mfma_f32_16x16x32_bf16 v[28:31], v[144:147], v[180:183], v[28:31]
    s_and_b32 s26, s26, 7
    v_mfma_f32_16x16x32_bf16 v[24:27], v[144:147], v[176:179], v[24:27]
    s_lshl_b32 s71, s26, 11
    s_waitcnt lgkmcnt(0)
    v_mfma_f32_16x16x32_bf16 v[8:11], v[120:123], v[104:107], v[8:11]
    ds_read_b128 v[144:147], v209 offset:8192
    s_and_b32 s26, s16, 3
    v_mfma_f32_16x16x32_bf16 v[12:15], v[124:127], v[104:107], v[12:15]
    ds_read_b64_tr_b16 v[160:161], v210 offset:24576
    s_cbranch_vccz Lskip61
    s_add_u32 s21, s14, 30
    s_and_b32 s21, s21, 31
    s_add_u32 m0, s23, 0
    s_mul_i32 s21, s21, 196608
    buffer_load_dwordx4 v212, s[8:11], s21 offen lds
    s_add_u32 m0, s23, 1024
    s_nop 0
    buffer_load_dwordx4 v213, s[8:11], s21 offen lds
    s_add_u32 m0, s23, 2048
    s_nop 0
    buffer_load_dwordx4 v214, s[8:11], s21 offen lds
Lskip61:
    s_lshl_b32 s26, s26, 6
    v_mfma_f32_16x16x32_bf16 v[16:19], v[128:131], v[104:107], v[16:19]
    ds_read_b64_tr_b16 v[162:163], v210 offset:25088
    s_lshr_b32 s27, s16, 2
    v_mfma_f32_16x16x32_bf16 v[20:23], v[132:135], v[104:107], v[20:23]
    ds_read_b64_tr_b16 v[164:165], v211 offset:24576
    s_lshl_b32 s27, s27, 5
    v_mfma_f32_16x16x32_bf16 v[44:47], v[132:135], v[108:111], v[44:47]
    ds_read_b64_tr_b16 v[166:167], v211 offset:25088
    s_add_u32 s26, s26, s27
    v_mfma_f32_16x16x32_bf16 v[40:43], v[128:131], v[108:111], v[40:43]
    ds_read_b64_tr_b16 v[168:169], v210 offset:28672
    s_and_b32 s27, s19, 8
    v_mfma_f32_16x16x32_bf16 v[36:39], v[124:127], v[108:111], v[36:39]
    ds_read_b64_tr_b16 v[170:171], v210 offset:29184
    s_add_u32 s27, s27, s19
    v_mfma_f32_16x16x32_bf16 v[32:35], v[120:123], v[108:111], v[32:35]
    ds_read_b128 v[148:151], v209 offset:10240
    s_add_u32 s26, s26, s27
    v_mfma_f32_16x16x32_bf16 v[56:59], v[120:123], v[112:115], v[56:59]
    ds_read_b64_tr_b16 v[172:173], v211 offset:28672
    s_lshl_b32 s26, s26, 3
    v_mfma_f32_16x16x32_bf16 v[60:63], v[124:127], v[112:115], v[60:63]
    ds_read_b64_tr_b16 v[174:175], v211 offset:29184
    v_mov_b32 v220, s26
    v_mfma_f32_16x16x32_bf16 v[64:67], v[128:131], v[112:115], v[64:67]
    ds_read_b64_tr_b16 v[176:177], v210 offset:32768
    v_and_b32 v4, 15, v1
    v_mfma_f32_16x16x32_bf16 v[68:71], v[132:135], v[112:115], v[68:71]
    ds_read_b64_tr_b16 v[178:179], v210 offset:33280
    s_cbranch_vccz Lskip62
    s_add_u32 s20, s15, 1920
    s_add_u32 m0, s22, 4096
    s_and_b32 s20, s20, 0x780
    buffer_load_dwordx4 v188, s[4:7], s20 offen lds
    s_add_u32 m0, s22, 5120
    s_nop 0
    buffer_load_dwordx4 v189, s[4:7], s20 offen lds
    s_add_u32 m0, s22, 6144
    s_nop 0
    buffer_load_dwordx4 v190, s[4:7], s20 offen lds
    s_add_u32 m0, s22, 7168
    s_nop 0
    buffer_load_dwordx4 v191, s[4:7], s20 offen lds
Lskip62:
    v_lshlrev_b32 v4, 4, v4
    v_mfma_f32_16x16x32_bf16 v[92:95], v[132:135], v[116:119], v[92:95]
    ds_read_b64_tr_b16 v[180:181], v211 offset:32768
    v_bfe_u32 v5, v1, 4, 1
    v_mfma_f32_16x16x32_bf16 v[88:91], v[128:131], v[116:119], v[88:91]
    ds_read_b64_tr_b16 v[182:183], v211 offset:33280
    v_lshl_add_u32 v4, v5, 15, v4
    v_mfma_f32_16x16x32_bf16 v[84:87], v[124:127], v[116:119], v[84:87]
    ds_read_b128 v[152:155], v209 offset:12288
    v_lshrrev_b32 v5, 5, v1
    v_mfma_f32_16x16x32_bf16 v[80:83], v[120:123], v[116:119], v[80:83]
    ds_read_b128 v[156:159], v209 offset:14336
    v_lshl_add_u32 v6, v5, 8, v4
    v_mfma_f32_16x16x32_bf16 v[96:99], v[116:119], v[136:139], v[96:99]
    v_mfma_f32_16x16x32_bf16 v[100:103], v[116:119], v[140:143], v[100:103]
    v_mfma_f32_16x16x32_bf16 v[76:79], v[112:115], v[140:143], v[76:79]
    v_mfma_f32_16x16x32_bf16 v[72:75], v[112:115], v[136:139], v[72:75]
    v_mfma_f32_16x16x32_bf16 v[48:51], v[108:111], v[136:139], v[48:51]
    v_mfma_f32_16x16x32_bf16 v[52:55], v[108:111], v[140:143], v[52:55]
    v_mfma_f32_16x16x32_bf16 v[28:31], v[104:107], v[140:143], v[28:31]
    v_mfma_f32_16x16x32_bf16 v[24:27], v[104:107], v[136:139], v[24:27]
    s_waitcnt vmcnt(11) lgkmcnt(0)
    s_barrier
    v_mfma_f32_16x16x32_bf16 v[8:11], v[160:163], v[144:147], v[8:11]
    ds_read_b128 v[104:107], v208 offset:16384
    v_mov_b32 v184, 0
    v_mfma_f32_16x16x32_bf16 v[12:15], v[164:167], v[144:147], v[12:15]
    ds_read_b64_tr_b16 v[120:121], v210 offset:36864
    s_cbranch_vccz Lskip63
    s_add_u32 s21, s14, 31
    s_and_b32 s21, s21, 31
    s_add_u32 m0, s23, 12288
    s_mul_i32 s21, s21, 196608
    buffer_load_dwordx4 v212, s[8:11], s21 offen lds
    s_add_u32 m0, s23, 13312
    s_nop 0
    buffer_load_dwordx4 v213, s[8:11], s21 offen lds
    s_add_u32 m0, s23, 14336
    s_nop 0
    buffer_load_dwordx4 v214, s[8:11], s21 offen lds
Lskip63:
    v_mov_b32 v185, 0
    v_mfma_f32_16x16x32_bf16 v[16:19], v[168:171], v[144:147], v[16:19]
    ds_read_b64_tr_b16 v[122:123], v210 offset:37376
    v_mov_b32 v186, 0
    v_mfma_f32_16x16x32_bf16 v[20:23], v[172:175], v[144:147], v[20:23]
    ds_read_b64_tr_b16 v[124:125], v211 offset:36864
    v_mov_b32 v187, 0
    v_mfma_f32_16x16x32_bf16 v[44:47], v[172:175], v[148:151], v[44:47]
    ds_read_b64_tr_b16 v[126:127], v211 offset:37376
    v_mov_b32 v188, 0
    v_mfma_f32_16x16x32_bf16 v[40:43], v[168:171], v[148:151], v[40:43]
    ds_read_b64_tr_b16 v[128:129], v210 offset:40960
    v_mov_b32 v189, 0
    v_mfma_f32_16x16x32_bf16 v[36:39], v[164:167], v[148:151], v[36:39]
    ds_read_b64_tr_b16 v[130:131], v210 offset:41472
    v_mov_b32 v190, 0
    v_mfma_f32_16x16x32_bf16 v[32:35], v[160:163], v[148:151], v[32:35]
    ds_read_b128 v[108:111], v208 offset:18432
    v_mov_b32 v191, 0
    v_mfma_f32_16x16x32_bf16 v[56:59], v[160:163], v[152:155], v[56:59]
    ds_read_b64_tr_b16 v[132:133], v211 offset:40960
    s_lshl_b32 s26, s17, 5
    v_mfma_f32_16x16x32_bf16 v[60:63], v[164:167], v[152:155], v[60:63]
    ds_read_b64_tr_b16 v[134:135], v211 offset:41472
    s_lshl_b32 s27, s19, 1
    v_mfma_f32_16x16x32_bf16 v[64:67], v[168:171], v[152:155], v[64:67]
    ds_read_b64_tr_b16 v[136:137], v210 offset:45056
    s_add_u32 s26, s26, s27
    v_mfma_f32_16x16x32_bf16 v[68:71], v[172:175], v[152:155], v[68:71]
    ds_read_b64_tr_b16 v[138:139], v210 offset:45568
    s_and_b32 s28, s16, 3
    v_mfma_f32_16x16x32_bf16 v[92:95], v[172:175], v[156:159], v[92:95]
    ds_read_b64_tr_b16 v[140:141], v211 offset:45056
    s_lshl_b32 s29, s28, 12
    v_mfma_f32_16x16x32_bf16 v[88:91], v[168:171], v[156:159], v[88:91]
    ds_read_b64_tr_b16 v[142:143], v211 offset:45568
    s_lshl_b32 s30, s26, 18
    v_mfma_f32_16x16x32_bf16 v[84:87], v[164:167], v[156:159], v[84:87]
    ds_read_b128 v[112:115], v208 offset:20480
    s_add_u32 s31, s30, s29
    v_mfma_f32_16x16x32_bf16 v[80:83], v[160:163], v[156:159], v[80:83]
    ds_read_b128 v[116:119], v208 offset:22528
    s_sub_u32 s50, 524288, s29
    v_mfma_f32_16x16x32_bf16 v[96:99], v[156:159], v[176:179], v[96:99]
    s_add_u32 s4, s48, s31
    s_addc_u32 s5, s49, 0
    v_mfma_f32_16x16x32_bf16 v[100:103], v[156:159], v[180:183], v[100:103]
    s_and_b32 s5, s5, 0xffff
    v_mfma_f32_16x16x32_bf16 v[76:79], v[152:155], v[180:183], v[76:79]
    s_mov_b32 s6, s50
    v_mfma_f32_16x16x32_bf16 v[72:75], v[152:155], v[176:179], v[72:75]
    s_mov_b32 s7, 0x00020000
    v_mfma_f32_16x16x32_bf16 v[48:51], v[148:151], v[176:179], v[48:51]
    s_lshr_b32 s27, s16, 2
    v_mfma_f32_16x16x32_bf16 v[52:55], v[148:151], v[180:183], v[52:55]
    s_add_u32 s26, s26, s27
    v_mfma_f32_16x16x32_bf16 v[28:31], v[144:147], v[180:183], v[28:31]
    s_lshl_b32 s30, s26, 18
    v_mfma_f32_16x16x32_bf16 v[24:27], v[144:147], v[176:179], v[24:27]
    s_waitcnt lgkmcnt(0)
    v_mfma_f32_16x16x32_bf16 v[8:11], v[120:123], v[104:107], v[8:11]
    ds_read_b128 v[144:147], v209 offset:16384
    buffer_load_dwordx2 v[222:223], v221, s[92:95], 0 offen sc1
    v_mfma_f32_16x16x32_bf16 v[12:15], v[124:127], v[104:107], v[12:15]
    ds_read_b64_tr_b16 v[160:161], v210 offset:49152
    s_mov_b32 s20, -1
    v_mfma_f32_16x16x32_bf16 v[16:19], v[128:131], v[104:107], v[16:19]
    ds_read_b64_tr_b16 v[162:163], v210 offset:49664
    s_lshl_b32 s21, s16, 14
    v_mfma_f32_16x16x32_bf16 v[20:23], v[132:135], v[104:107], v[20:23]
    ds_read_b64_tr_b16 v[164:165], v211 offset:49152
    s_lshl_b32 s27, s16, 10
    v_mfma_f32_16x16x32_bf16 v[44:47], v[132:135], v[108:111], v[44:47]
    ds_read_b64_tr_b16 v[166:167], v211 offset:49664
    s_add_u32 s89, s27, 65536
    v_mfma_f32_16x16x32_bf16 v[40:43], v[128:131], v[108:111], v[40:43]
    ds_read_b64_tr_b16 v[168:169], v210 offset:53248
    s_lshl_b32 s85, s16, 12
    v_mfma_f32_16x16x32_bf16 v[36:39], v[124:127], v[108:111], v[36:39]
    ds_read_b64_tr_b16 v[170:171], v210 offset:53760
    s_mov_b32 s84, 16384
    v_mfma_f32_16x16x32_bf16 v[32:35], v[120:123], v[108:111], v[32:35]
    ds_read_b128 v[148:151], v209 offset:18432
    s_lshl_b32 s23, s18, 15
    v_mfma_f32_16x16x32_bf16 v[56:59], v[120:123], v[112:115], v[56:59]
    ds_read_b64_tr_b16 v[172:173], v211 offset:53248
    s_lshr_b32 s51, s16, 1
    v_mfma_f32_16x16x32_bf16 v[60:63], v[124:127], v[112:115], v[60:63]
    ds_read_b64_tr_b16 v[174:175], v211 offset:53760
    s_mov_b32 s41, 0
    v_mfma_f32_16x16x32_bf16 v[64:67], v[128:131], v[112:115], v[64:67]
    ds_read_b64_tr_b16 v[176:177], v210 offset:57344
    v_mfma_f32_16x16x32_bf16 v[68:71], v[132:135], v[112:115], v[68:71]
    ds_read_b64_tr_b16 v[178:179], v210 offset:57856
    v_mfma_f32_16x16x32_bf16 v[92:95], v[132:135], v[116:119], v[92:95]
    ds_read_b64_tr_b16 v[180:181], v211 offset:57344
    v_mfma_f32_16x16x32_bf16 v[88:91], v[128:131], v[116:119], v[88:91]
    ds_read_b64_tr_b16 v[182:183], v211 offset:57856
    v_mfma_f32_16x16x32_bf16 v[84:87], v[124:127], v[116:119], v[84:87]
    ds_read_b128 v[152:155], v209 offset:20480
    v_mfma_f32_16x16x32_bf16 v[80:83], v[120:123], v[116:119], v[80:83]
    ds_read_b128 v[156:159], v209 offset:22528
    v_mfma_f32_16x16x32_bf16 v[96:99], v[116:119], v[136:139], v[96:99]
    v_mfma_f32_16x16x32_bf16 v[100:103], v[116:119], v[140:143], v[100:103]
    v_mfma_f32_16x16x32_bf16 v[76:79], v[112:115], v[140:143], v[76:79]
    v_mfma_f32_16x16x32_bf16 v[72:75], v[112:115], v[136:139], v[72:75]
    v_mfma_f32_16x16x32_bf16 v[48:51], v[108:111], v[136:139], v[48:51]
    v_mfma_f32_16x16x32_bf16 v[52:55], v[108:111], v[140:143], v[52:55]
    v_mfma_f32_16x16x32_bf16 v[28:31], v[104:107], v[140:143], v[28:31]
    v_mfma_f32_16x16x32_bf16 v[24:27], v[104:107], v[136:139], v[24:27]
    s_waitcnt vmcnt(1) lgkmcnt(0)
    s_barrier
    v_mfma_f32_16x16x32_bf16 v[8:11], v[160:163], v[144:147], v[8:11]
    ds_read_b128 v[104:107], v208 offset:0
    s_lshl_b32 s27, s18, 3
    v_mfma_f32_16x16x32_bf16 v[12:15], v[164:167], v[144:147], v[12:15]
    ds_read_b64_tr_b16 v[120:121], v210 offset:0
    s_lshl_b32 s28, s28, 1
    v_mfma_f32_16x16x32_bf16 v[16:19], v[168:171], v[144:147], v[16:19]
    ds_read_b64_tr_b16 v[122:123], v210 offset:512
    s_add_u32 s27, s27, s28
    v_mfma_f32_16x16x32_bf16 v[20:23], v[172:175], v[144:147], v[20:23]
    ds_read_b64_tr_b16 v[124:125], v211 offset:0
    s_lshl_b32 s29, s27, 12
    v_mfma_f32_16x16x32_bf16 v[44:47], v[172:175], v[148:151], v[44:47]
    ds_read_b64_tr_b16 v[126:127], v211 offset:512
    s_add_u32 s31, s30, s29
    v_mfma_f32_16x16x32_bf16 v[40:43], v[168:171], v[148:151], v[40:43]
    ds_read_b64_tr_b16 v[128:129], v210 offset:4096
    s_add_u32 s56, s48, s31
    s_addc_u32 s57, s49, 0
    v_mfma_f32_16x16x32_bf16 v[36:39], v[164:167], v[148:151], v[36:39]
    ds_read_b64_tr_b16 v[130:131], v210 offset:4608
    s_and_b32 s57, s57, 0xffff
    v_mfma_f32_16x16x32_bf16 v[32:35], v[160:163], v[148:151], v[32:35]
    ds_read_b128 v[108:111], v208 offset:2048
    s_mov_b32 s58, 8192
    v_mfma_f32_16x16x32_bf16 v[56:59], v[160:163], v[152:155], v[56:59]
    ds_read_b64_tr_b16 v[132:133], v211 offset:4096
    s_mov_b32 s59, 0x00020000
    v_mfma_f32_16x16x32_bf16 v[60:63], v[164:167], v[152:155], v[60:63]
    ds_read_b64_tr_b16 v[134:135], v211 offset:4608
    s_mov_b32 s50, 4096
    v_mfma_f32_16x16x32_bf16 v[64:67], v[168:171], v[152:155], v[64:67]
    ds_read_b64_tr_b16 v[136:137], v210 offset:8192
    s_lshl_b32 s28, s17, 22
    v_mfma_f32_16x16x32_bf16 v[68:71], v[172:175], v[152:155], v[68:71]
    ds_read_b64_tr_b16 v[138:139], v210 offset:8704
    s_lshl_b32 s29, s27, 16
    v_mfma_f32_16x16x32_bf16 v[92:95], v[172:175], v[156:159], v[92:95]
    ds_read_b64_tr_b16 v[140:141], v211 offset:8192
    s_add_u32 s31, s28, s29
    v_mfma_f32_16x16x32_bf16 v[88:91], v[168:171], v[156:159], v[88:91]
    ds_read_b64_tr_b16 v[142:143], v211 offset:8704
    s_and_b32 s28, s26, 31
    v_mfma_f32_16x16x32_bf16 v[84:87], v[164:167], v[156:159], v[84:87]
    ds_read_b128 v[112:115], v208 offset:4096
    s_lshl_b32 s28, s28, 10
    v_mfma_f32_16x16x32_bf16 v[80:83], v[160:163], v[156:159], v[80:83]
    ds_read_b128 v[116:119], v208 offset:6144
    s_add_u32 s31, s31, s28
    v_mfma_f32_16x16x32_bf16 v[96:99], v[156:159], v[176:179], v[96:99]
    s_add_u32 s31, s31, 25165824
    v_mfma_f32_16x16x32_bf16 v[100:103], v[156:159], v[180:183], v[100:103]
    s_add_u32 s12, s48, s31
    s_addc_u32 s13, s49, 0
    v_mfma_f32_16x16x32_bf16 v[76:79], v[152:155], v[180:183], v[76:79]
    s_and_b32 s13, s13, 0xffff
    v_mfma_f32_16x16x32_bf16 v[72:75], v[152:155], v[176:179], v[72:75]
    s_mov_b32 s14, 131072
    v_mfma_f32_16x16x32_bf16 v[48:51], v[148:151], v[176:179], v[48:51]
    s_mov_b32 s15, 0x00020000
    v_mfma_f32_16x16x32_bf16 v[52:55], v[148:151], v[180:183], v[52:55]
    v_mfma_f32_16x16x32_bf16 v[28:31], v[144:147], v[180:183], v[28:31]
    v_mfma_f32_16x16x32_bf16 v[24:27], v[144:147], v[176:179], v[24:27]
    s_waitcnt lgkmcnt(0)
    v_mfma_f32_16x16x32_bf16 v[8:11], v[120:123], v[104:107], v[8:11]
    ds_read_b128 v[144:147], v209 offset:0
    s_lshl_b32 s28, s17, 4
    v_mfma_f32_16x16x32_bf16 v[12:15], v[124:127], v[104:107], v[12:15]
    ds_read_b64_tr_b16 v[160:161], v210 offset:12288
    s_add_u32 s28, s28, s19
    v_mfma_f32_16x16x32_bf16 v[16:19], v[128:131], v[104:107], v[16:19]
    ds_read_b64_tr_b16 v[162:163], v210 offset:12800
    s_lshl_b32 s28, s28, 10
    v_mfma_f32_16x16x32_bf16 v[20:23], v[132:135], v[104:107], v[20:23]
    ds_read_b64_tr_b16 v[164:165], v211 offset:12288
    s_add_u32 s31, s28, 33554432
    v_mfma_f32_16x16x32_bf16 v[44:47], v[132:135], v[108:111], v[44:47]
    ds_read_b64_tr_b16 v[166:167], v211 offset:12800
    s_add_u32 s8, s48, s31
    s_addc_u32 s9, s49, 0
    v_mfma_f32_16x16x32_bf16 v[40:43], v[128:131], v[108:111], v[40:43]
    ds_read_b64_tr_b16 v[168:169], v210 offset:16384
    s_and_b32 s9, s9, 0xffff
    v_mfma_f32_16x16x32_bf16 v[36:39], v[124:127], v[108:111], v[36:39]
    ds_read_b64_tr_b16 v[170:171], v210 offset:16896
    s_mov_b32 s10, 1024
    v_mfma_f32_16x16x32_bf16 v[32:35], v[120:123], v[108:111], v[32:35]
    ds_read_b128 v[148:151], v209 offset:2048
    s_mov_b32 s11, 0x00020000
    v_mfma_f32_16x16x32_bf16 v[56:59], v[120:123], v[112:115], v[56:59]
    ds_read_b64_tr_b16 v[172:173], v211 offset:16384
    s_bitcmp0_b32 s16, 1
    s_cselect_b64 vcc, -1, 0
    v_mfma_f32_16x16x32_bf16 v[60:63], v[124:127], v[112:115], v[60:63]
    ds_read_b64_tr_b16 v[174:175], v211 offset:16896
    s_mov_b32 s26, 1048744942
    v_mfma_f32_16x16x32_bf16 v[64:67], v[128:131], v[112:115], v[64:67]
    ds_read_b64_tr_b16 v[176:177], v210 offset:20480
    s_mov_b32 s27, 1048744942
    v_mfma_f32_16x16x32_bf16 v[68:71], v[132:135], v[112:115], v[68:71]
    ds_read_b64_tr_b16 v[178:179], v210 offset:20992
    v_lshrrev_b32 v4, 4, v1
    v_mfma_f32_16x16x32_bf16 v[92:95], v[132:135], v[116:119], v[92:95]
    ds_read_b64_tr_b16 v[180:181], v211 offset:20480
    v_bfe_u32 v2, v1, 2, 2
    v_mfma_f32_16x16x32_bf16 v[88:91], v[128:131], v[116:119], v[88:91]
    ds_read_b64_tr_b16 v[182:183], v211 offset:20992
    v_and_b32 v3, 3, v1
    v_mfma_f32_16x16x32_bf16 v[84:87], v[124:127], v[116:119], v[84:87]
    ds_read_b128 v[152:155], v209 offset:4096
    v_and_b32 v5, 1, v4
    v_mfma_f32_16x16x32_bf16 v[80:83], v[120:123], v[116:119], v[80:83]
    ds_read_b128 v[156:159], v209 offset:6144
    v_lshrrev_b32 v4, 1, v4
    v_mfma_f32_16x16x32_bf16 v[96:99], v[116:119], v[136:139], v[96:99]
    v_lshl_add_u32 v7, v5, 2, v2
    v_mfma_f32_16x16x32_bf16 v[100:103], v[116:119], v[140:143], v[100:103]
    v_lshl_add_u32 v4, v4, 4, v7
    v_mfma_f32_16x16x32_bf16 v[76:79], v[112:115], v[140:143], v[76:79]
    v_lshrrev_b32 v7, 1, v7
    v_mfma_f32_16x16x32_bf16 v[72:75], v[112:115], v[136:139], v[72:75]
    v_lshlrev_b32 v7, 5, v7
    v_mfma_f32_16x16x32_bf16 v[48:51], v[108:111], v[136:139], v[48:51]
    v_lshl_add_u32 v7, v3, 3, v7
    v_mfma_f32_16x16x32_bf16 v[52:55], v[108:111], v[140:143], v[52:55]
    v_lshl_add_u32 v7, v4, 7, v7
    v_mfma_f32_16x16x32_bf16 v[28:31], v[104:107], v[140:143], v[28:31]
    v_add_u32 v212, 65536, v7
    v_xor_b32 v213, 32, v212
    v_mfma_f32_16x16x32_bf16 v[24:27], v[104:107], v[136:139], v[24:27]
    v_xor_b32 v214, 64, v212
    v_xor_b32 v215, 96, v212
    s_waitcnt vmcnt(0) lgkmcnt(0)
    s_barrier
Lgemm_end:
    v_mfma_f32_16x16x32_bf16 v[80:83], v[160:163], v[156:159], v[80:83]
    v_mfma_f32_16x16x32_bf16 v[84:87], v[164:167], v[156:159], v[84:87]
    v_mfma_f32_16x16x32_bf16 v[24:27], v[144:147], v[176:179], v[24:27]
    v_mfma_f32_16x16x32_bf16 v[48:51], v[148:151], v[176:179], v[48:51]
    v_mfma_f32_16x16x32_bf16 v[28:31], v[144:147], v[180:183], v[28:31]
    v_mfma_f32_16x16x32_bf16 v[52:55], v[148:151], v[180:183], v[52:55]
    v_mfma_f32_16x16x32_bf16 v[72:75], v[152:155], v[176:179], v[72:75]
    v_mfma_f32_16x16x32_bf16 v[96:99], v[156:159], v[176:179], v[96:99]
    v_mfma_f32_16x16x32_bf16 v[76:79], v[152:155], v[180:183], v[76:79]
    v_mfma_f32_16x16x32_bf16 v[100:103], v[156:159], v[180:183], v[100:103]
    v_mfma_f32_16x16x32_bf16 v[88:91], v[168:171], v[156:159], v[88:91]
    v_mul_f32 v80, s26, v80
    v_mul_f32 v81, s26, v81
    v_mul_f32 v82, s26, v82
    v_mul_f32 v83, s26, v83
    v_mul_f32 v84, s26, v84
    v_mul_f32 v85, s26, v85
    v_mul_f32 v86, s26, v86
    v_mul_f32 v87, s26, v87
    v_cvt_pk_bf16_f32 v116, v80, v81
    v_cvt_pk_bf16_f32 v117, v82, v83
    v_cvt_pk_bf16_f32 v118, v84, v85
    v_cvt_pk_bf16_f32 v119, v86, v87
    v_mfma_f32_16x16x32_bf16 v[92:95], v[172:175], v[156:159], v[92:95]
    v_mfma_f32_16x16x32_bf16 v[64:67], v[168:171], v[152:155], v[64:67]
    v_cvt_pk_bf16_f32 v80, v24, v25
    v_cvt_pk_bf16_f32 v81, v26, v27
    v_cvt_pk_bf16_f32 v82, v48, v49
    v_cvt_pk_bf16_f32 v83, v50, v51
    ds_write_b128 v207, v[80:83] offset:2048
    v_mfma_f32_16x16x32_bf16 v[68:71], v[172:175], v[152:155], v[68:71]
    v_mfma_f32_16x16x32_bf16 v[16:19], v[168:171], v[144:147], v[16:19]
    v_cvt_pk_bf16_f32 v84, v28, v29
    v_cvt_pk_bf16_f32 v85, v30, v31
    v_cvt_pk_bf16_f32 v86, v52, v53
    v_cvt_pk_bf16_f32 v87, v54, v55
    ds_write_b128 v207, v[84:87] offset:2304
    s_cbranch_vccz Lskip64
    buffer_store_dwordx4 v[80:83], v205, s[56:59], 0 offen offset:2048 sc1
    buffer_store_dwordx4 v[84:87], v205, s[56:59], 0 offen offset:2304 sc1
Lskip64:
    v_mfma_f32_16x16x32_bf16 v[20:23], v[172:175], v[144:147], v[20:23]
    v_mfma_f32_16x16x32_bf16 v[40:43], v[168:171], v[148:151], v[40:43]
    v_cvt_pk_bf16_f32 v72, v72, v73
    v_cvt_pk_bf16_f32 v73, v74, v75
    v_cvt_pk_bf16_f32 v74, v96, v97
    v_cvt_pk_bf16_f32 v75, v98, v99
    ds_write_b128 v207, v[72:75] offset:6144
    v_mfma_f32_16x16x32_bf16 v[44:47], v[172:175], v[148:151], v[44:47]
    v_mfma_f32_16x16x32_bf16 v[8:11], v[160:163], v[144:147], v[8:11]
    v_cvt_pk_bf16_f32 v76, v76, v77
    v_cvt_pk_bf16_f32 v77, v78, v79
    v_cvt_pk_bf16_f32 v78, v100, v101
    v_cvt_pk_bf16_f32 v79, v102, v103
    ds_write_b128 v207, v[76:79] offset:6400
    s_cbranch_vccz Lskip65
    buffer_store_dwordx4 v[72:75], v205, s[56:59], s50 offen offset:2048 sc1
    buffer_store_dwordx4 v[76:79], v205, s[56:59], s50 offen offset:2304 sc1
Lskip65:
    v_mfma_f32_16x16x32_bf16 v[12:15], v[164:167], v[144:147], v[12:15]
    v_mfma_f32_16x16x32_bf16 v[32:35], v[160:163], v[148:151], v[32:35]
    v_cvt_pk_bf16_f32 v88, v88, v89
    v_cvt_pk_bf16_f32 v89, v90, v91
    v_cvt_pk_bf16_f32 v90, v92, v93
    v_cvt_pk_bf16_f32 v91, v94, v95
    ds_write_b128 v207, v[88:91] offset:4352
    v_mfma_f32_16x16x32_bf16 v[36:39], v[164:167], v[148:151], v[36:39]
    v_mfma_f32_16x16x32_bf16 v[56:59], v[160:163], v[152:155], v[56:59]
    v_cvt_pk_bf16_f32 v92, v64, v65
    v_cvt_pk_bf16_f32 v93, v66, v67
    v_cvt_pk_bf16_f32 v94, v68, v69
    v_cvt_pk_bf16_f32 v95, v70, v71
    ds_write_b128 v207, v[92:95] offset:4096
    v_mfma_f32_16x16x32_bf16 v[60:63], v[164:167], v[152:155], v[60:63]
    v_cvt_pk_bf16_f32 v96, v16, v17
    v_cvt_pk_bf16_f32 v97, v18, v19
    v_cvt_pk_bf16_f32 v98, v20, v21
    v_cvt_pk_bf16_f32 v99, v22, v23
    ds_write_b128 v207, v[96:99] offset:0
    v_cvt_pk_bf16_f32 v100, v40, v41
    v_cvt_pk_bf16_f32 v101, v42, v43
    v_cvt_pk_bf16_f32 v102, v44, v45
    v_cvt_pk_bf16_f32 v103, v46, v47
    ds_write_b128 v207, v[100:103] offset:256
    s_cmp_lt_u32 s16, 4
    s_setprio 1
    s_cbranch_scc0 Lyng0
    s_setprio 2
Lyng0:
    s_waitcnt lgkmcnt(0)
    s_barrier
    ds_read_b128 v[152:155], v204 offset:0
    ds_read_b128 v[156:159], v204 offset:1024
    ds_read_b128 v[168:171], v197 offset:2048
    ds_read_b128 v[172:175], v197 offset:3072
    s_cbranch_vccz Lskip66
    buffer_store_dwordx4 v[88:91], v205, s[56:59], s50 offen offset:256 sc1
    buffer_store_dwordx4 v[92:95], v205, s[56:59], s50 offen offset:0 sc1
Lskip66:
    v_mul_f32 v8, s26, v8
    v_mul_f32 v9, s26, v9
    v_mul_f32 v10, s26, v10
    v_mul_f32 v11, s26, v11
    v_mul_f32 v12, s26, v12
    v_mul_f32 v13, s26, v13
    v_mul_f32 v14, s26, v14
    v_mul_f32 v15, s26, v15
    v_cvt_pk_bf16_f32 v104, v8, v9
    v_cvt_pk_bf16_f32 v105, v10, v11
    v_cvt_pk_bf16_f32 v106, v12, v13
    v_cvt_pk_bf16_f32 v107, v14, v15
    s_cbranch_vccz Lskip67
    buffer_store_dwordx4 v[96:99], v205, s[56:59], 0 offen offset:0 sc1
    buffer_store_dwordx4 v[100:103], v205, s[56:59], 0 offen offset:256 sc1
Lskip67:
    v_mul_f32 v32, s26, v32
    v_mul_f32 v33, s26, v33
    v_mul_f32 v34, s26, v34
    v_mul_f32 v35, s26, v35
    v_mul_f32 v36, s26, v36
    v_mul_f32 v37, s26, v37
    v_mul_f32 v38, s26, v38
    v_mul_f32 v39, s26, v39
    v_cvt_pk_bf16_f32 v108, v32, v33
    v_cvt_pk_bf16_f32 v109, v34, v35
    v_cvt_pk_bf16_f32 v110, v36, v37
    v_cvt_pk_bf16_f32 v111, v38, v39
    v_mul_f32 v56, s26, v56
    v_mul_f32 v57, s26, v57
    v_mul_f32 v58, s26, v58
    v_mul_f32 v59, s26, v59
    v_mul_f32 v60, s26, v60
    v_mul_f32 v61, s26, v61
    v_mul_f32 v62, s26, v62
    v_mul_f32 v63, s26, v63
    v_cvt_pk_bf16_f32 v112, v56, v57
    v_cvt_pk_bf16_f32 v113, v58, v59
    v_cvt_pk_bf16_f32 v114, v60, v61
    v_cvt_pk_bf16_f32 v115, v62, v63
    s_nop 1
    v_permlane16_swap_b32 v104, v108
    v_permlane16_swap_b32 v105, v109
    v_permlane16_swap_b32 v106, v110
    v_permlane16_swap_b32 v107, v111
    v_permlane16_swap_b32 v112, v116
    v_permlane16_swap_b32 v113, v117
    v_permlane16_swap_b32 v114, v118
    v_permlane16_swap_b32 v115, v119
    v_permlane32_swap_b32 v104, v108
    v_permlane32_swap_b32 v105, v109
    v_permlane32_swap_b32 v106, v110
    v_permlane32_swap_b32 v107, v111
    v_permlane32_swap_b32 v112, v116
    v_permlane32_swap_b32 v113, v117
    v_permlane32_swap_b32 v114, v118
    v_permlane32_swap_b32 v115, v119
    s_waitcnt lgkmcnt(2)
    v_mfma_f32_32x32x16_bf16 v[8:23], v[152:155], v[104:107], 0
    v_mfma_f32_32x32x16_bf16 v[8:23], v[156:159], v[108:111], v[8:23]
    v_mfma_f32_32x32x16_bf16 v[24:39], v[152:155], v[112:115], 0
    v_mfma_f32_32x32x16_bf16 v[24:39], v[156:159], v[116:119], v[24:39]
    v_readfirstlane_b32 s80, v222
    v_readfirstlane_b32 s81, v223
    s_lshl_b32 s26, s18, 4
    s_add_u32 s26, s26, s16
    s_lshl_b32 s28, s26, 3
    s_nop 3
    s_cmp_eq_u32 s80, 0
    s_cbranch_scc1 Lnonce_spin
Lnonce_ok:
    v_mov_b32 v221, s28
    s_nop 0
    v_max3_f32 v2, v8, v9, v10
    v_max3_f32 v2, v2, v11, v12
    v_max3_f32 v2, v2, v13, v14
    v_max3_f32 v2, v2, v15, v16
    v_max3_f32 v2, v2, v17, v18
    v_max3_f32 v2, v2, v19, v20
    v_max3_f32 v2, v2, v21, v22
    v_max_f32 v2, v2, v23
    v_mov_b32 v3, v2
    s_nop 1
    v_permlane32_swap_b32 v2, v3
    s_nop 0
    v_max_f32 v2, v2, v3
    v_max3_f32 v4, v24, v25, v26
    v_max3_f32 v4, v4, v27, v28
    v_max3_f32 v4, v4, v29, v30
    v_max3_f32 v4, v4, v31, v32
    v_max3_f32 v4, v4, v33, v34
    v_max3_f32 v4, v4, v35, v36
    v_max3_f32 v4, v4, v37, v38
    v_max_f32 v4, v4, v39
    v_mov_b32 v5, v4
    s_nop 1
    v_permlane32_swap_b32 v4, v5
    s_nop 0
    v_max_f32 v4, v4, v5
    v_add_f32 v2, 0x41980000, v2
    v_add_f32 v4, 0x41980000, v4
    v_sub_f32 v120, 0, v2
    v_sub_f32 v121, 0, v2
    v_sub_f32 v122, 0, v2
    v_sub_f32 v123, 0, v2
    v_sub_f32 v124, 0, v2
    v_sub_f32 v125, 0, v2
    v_sub_f32 v126, 0, v2
    v_sub_f32 v127, 0, v2
    v_sub_f32 v128, 0, v2
    v_sub_f32 v129, 0, v2
    v_sub_f32 v130, 0, v2
    v_sub_f32 v131, 0, v2
    v_sub_f32 v132, 0, v2
    v_sub_f32 v133, 0, v2
    v_sub_f32 v134, 0, v2
    v_sub_f32 v135, 0, v2
    v_sub_f32 v136, 0, v4
    v_sub_f32 v137, 0, v4
    v_mfma_f32_32x32x16_bf16 v[8:23], v[152:155], v[104:107], v[120:135]
    v_mfma_f32_32x32x16_bf16 v[8:23], v[156:159], v[108:111], v[8:23]
    v_sub_f32 v138, 0, v4
    v_sub_f32 v139, 0, v4
    v_sub_f32 v140, 0, v4
    v_sub_f32 v141, 0, v4
    v_sub_f32 v142, 0, v4
    v_sub_f32 v143, 0, v4
    v_sub_f32 v144, 0, v4
    v_sub_f32 v145, 0, v4
    v_sub_f32 v146, 0, v4
    v_sub_f32 v147, 0, v4
    v_sub_f32 v148, 0, v4
    v_sub_f32 v149, 0, v4
    v_sub_f32 v150, 0, v4
    v_sub_f32 v151, 0, v4
    s_nop 1
    v_mfma_f32_32x32x16_bf16 v[24:39], v[152:155], v[112:115], v[136:151]
    v_exp_f32 v8, v8
    v_exp_f32 v9, v9
    v_exp_f32 v10, v10
    ds_read_b128 v[160:163], v204 offset:4096
    v_exp_f32 v11, v11
    v_exp_f32 v12, v12
    v_mfma_f32_32x32x16_bf16 v[24:39], v[156:159], v[116:119], v[24:39]
    v_exp_f32 v13, v13
    v_exp_f32 v14, v14
    v_exp_f32 v15, v15
    v_exp_f32 v16, v16
    v_exp_f32 v17, v17
    v_exp_f32 v18, v18
    ds_read_b128 v[164:167], v204 offset:5120
    v_exp_f32 v19, v19
    v_exp_f32 v20, v20
    s_waitcnt lgkmcnt(1)
    v_exp_f32 v21, v21
    v_exp_f32 v22, v22
    v_exp_f32 v23, v23
    v_mfma_f32_32x32x16_bf16 v[40:55], v[160:163], v[104:107], v[120:135]
    s_waitcnt lgkmcnt(0)
    v_exp_f32 v24, v24
    v_exp_f32 v25, v25
    v_exp_f32 v26, v26
    v_smfmac_f32_16x16x64_bf16 v[184:187], v[192:195], v[8:15], v196
    ds_read_b128 v[176:179], v197 offset:6144
    v_exp_f32 v27, v27
    v_exp_f32 v28, v28
    v_mfma_f32_32x32x16_bf16 v[40:55], v[164:167], v[108:111], v[40:55]
    v_exp_f32 v29, v29
    v_exp_f32 v30, v30
    v_exp_f32 v31, v31
    v_smfmac_f32_32x32x32_bf16 v[224:239], v[168:171], v[8:15], v196
    s_cbranch_vccnz Lskip68
    buffer_store_dwordx4 v[80:83], v205, s[56:59], 0 offen offset:2048 sc1
    buffer_store_dwordx4 v[84:87], v205, s[56:59], 0 offen offset:2304 sc1
Lskip68:
    v_exp_f32 v32, v32
    v_exp_f32 v33, v33
    v_exp_f32 v34, v34
    v_smfmac_f32_16x16x64_bf16 v[184:187], v[192:195], v[16:23], v196
    ds_read_b128 v[180:183], v197 offset:7168
    v_exp_f32 v35, v35
    v_exp_f32 v36, v36
    v_smfmac_f32_32x32x32_bf16 v[224:239], v[172:175], v[16:23], v196
    v_exp_f32 v37, v37
    v_exp_f32 v38, v38
    v_exp_f32 v39, v39
    v_mfma_f32_32x32x16_bf16 v[56:71], v[160:163], v[112:115], v[136:151]
    v_exp_f32 v40, v40
    v_exp_f32 v41, v41
    v_exp_f32 v42, v42
    v_smfmac_f32_16x16x64_bf16 v[188:191], v[192:195], v[24:31], v196
    ds_read_b128 v[152:155], v204 offset:8192
    v_exp_f32 v43, v43
    v_exp_f32 v44, v44
    v_mfma_f32_32x32x16_bf16 v[56:71], v[164:167], v[116:119], v[56:71]
    v_exp_f32 v45, v45
    v_exp_f32 v46, v46
    v_exp_f32 v47, v47
    v_smfmac_f32_32x32x32_bf16 v[240:255], v[168:171], v[24:31], v196
    s_cbranch_vccnz Lskip69
    buffer_store_dwordx4 v[72:75], v205, s[56:59], s50 offen offset:2048 sc1
    buffer_store_dwordx4 v[76:79], v205, s[56:59], s50 offen offset:2304 sc1
Lskip69:
    v_exp_f32 v48, v48
    v_exp_f32 v49, v49
    v_exp_f32 v50, v50
    v_smfmac_f32_16x16x64_bf16 v[188:191], v[192:195], v[32:39], v196
    ds_read_b128 v[156:159], v204 offset:9216
    v_exp_f32 v51, v51
    v_exp_f32 v52, v52
    v_smfmac_f32_32x32x32_bf16 v[240:255], v[172:175], v[32:39], v196
    s_waitcnt lgkmcnt(1)
    v_exp_f32 v53, v53
    v_exp_f32 v54, v54
    v_exp_f32 v55, v55
    v_mfma_f32_32x32x16_bf16 v[8:23], v[152:155], v[104:107], v[120:135]
    s_waitcnt lgkmcnt(0)
    v_exp_f32 v56, v56
    v_exp_f32 v57, v57
    v_exp_f32 v58, v58
    v_smfmac_f32_16x16x64_bf16 v[184:187], v[192:195], v[40:47], v196
    ds_read_b128 v[168:171], v197 offset:10240
    v_exp_f32 v59, v59
    v_exp_f32 v60, v60
    v_mfma_f32_32x32x16_bf16 v[8:23], v[156:159], v[108:111], v[8:23]
    v_exp_f32 v61, v61
    v_exp_f32 v62, v62
    v_exp_f32 v63, v63
    v_smfmac_f32_32x32x32_bf16 v[224:239], v[176:179], v[40:47], v196
    s_cbranch_vccnz Lskip70
    buffer_store_dwordx4 v[88:91], v205, s[56:59], s50 offen offset:256 sc1
    buffer_store_dwordx4 v[92:95], v205, s[56:59], s50 offen offset:0 sc1
Lskip70:
    v_exp_f32 v64, v64
    v_exp_f32 v65, v65
    v_exp_f32 v66, v66
    v_smfmac_f32_16x16x64_bf16 v[184:187], v[192:195], v[48:55], v196
    ds_read_b128 v[172:175], v197 offset:11264
    v_exp_f32 v67, v67
    v_exp_f32 v68, v68
    v_smfmac_f32_32x32x32_bf16 v[224:239], v[180:183], v[48:55], v196
    v_exp_f32 v69, v69
    v_exp_f32 v70, v70
    v_exp_f32 v71, v71
    v_mfma_f32_32x32x16_bf16 v[24:39], v[152:155], v[112:115], v[136:151]
    v_exp_f32 v8, v8
    v_exp_f32 v9, v9
    v_exp_f32 v10, v10
    v_smfmac_f32_16x16x64_bf16 v[188:191], v[192:195], v[56:63], v196
    ds_read_b128 v[160:163], v204 offset:12288
    v_exp_f32 v11, v11
    v_exp_f32 v12, v12
    v_mfma_f32_32x32x16_bf16 v[24:39], v[156:159], v[116:119], v[24:39]
    v_exp_f32 v13, v13
    v_exp_f32 v14, v14
    v_exp_f32 v15, v15
    v_smfmac_f32_32x32x32_bf16 v[240:255], v[176:179], v[56:63], v196
    s_cbranch_vccnz Lskip71
    buffer_store_dwordx4 v[96:99], v205, s[56:59], 0 offen offset:0 sc1
    buffer_store_dwordx4 v[100:103], v205, s[56:59], 0 offen offset:256 sc1
Lskip71:
    v_exp_f32 v16, v16
    v_exp_f32 v17, v17
    v_exp_f32 v18, v18
    v_smfmac_f32_16x16x64_bf16 v[188:191], v[192:195], v[64:71], v196
    ds_read_b128 v[164:167], v204 offset:13312
    v_exp_f32 v19, v19
    v_exp_f32 v20, v20
    v_smfmac_f32_32x32x32_bf16 v[240:255], v[180:183], v[64:71], v196
    s_waitcnt lgkmcnt(1)
    v_exp_f32 v21, v21
    v_exp_f32 v22, v22
    v_exp_f32 v23, v23
    v_mfma_f32_32x32x16_bf16 v[40:55], v[160:163], v[104:107], v[120:135]
    s_waitcnt lgkmcnt(0)
    v_exp_f32 v24, v24
    v_exp_f32 v25, v25
    v_exp_f32 v26, v26
    v_smfmac_f32_16x16x64_bf16 v[184:187], v[192:195], v[8:15], v196
    ds_read_b128 v[176:179], v197 offset:14336
    v_exp_f32 v27, v27
    v_exp_f32 v28, v28
    v_mfma_f32_32x32x16_bf16 v[40:55], v[164:167], v[108:111], v[40:55]
    v_exp_f32 v29, v29
    v_exp_f32 v30, v30
    v_exp_f32 v31, v31
    v_smfmac_f32_32x32x32_bf16 v[224:239], v[168:171], v[8:15], v196
    v_exp_f32 v32, v32
    v_exp_f32 v33, v33
    v_exp_f32 v34, v34
    v_smfmac_f32_16x16x64_bf16 v[184:187], v[192:195], v[16:23], v196
    ds_read_b128 v[180:183], v197 offset:15360
    v_exp_f32 v35, v35
    v_exp_f32 v36, v36
    v_smfmac_f32_32x32x32_bf16 v[224:239], v[172:175], v[16:23], v196
    v_exp_f32 v37, v37
    v_exp_f32 v38, v38
    v_exp_f32 v39, v39
    s_waitcnt lgkmcnt(0)
    s_barrier
    s_cmp_lt_u32 s16, 4
    s_cselect_b64 vcc, -1, 0
    s_and_b32 s26, s16, 6
    s_cmp_eq_u32 s26, 2
    s_cbranch_scc1 Lpub1
    s_waitcnt vmcnt(0)
    s_mov_b64 exec, 1
    buffer_store_dwordx2 v[222:223], v221, s[8:11], 0 offen sc1
    s_mov_b64 exec, -1
Lpub1:
    v_mfma_f32_32x32x16_bf16 v[56:71], v[160:163], v[112:115], v[136:151]
    v_xor_b32 v197, 32768, v197
    v_xor_b32 v204, 32768, v204
    v_exp_f32 v40, v40
    v_exp_f32 v41, v41
    v_exp_f32 v42, v42
    v_smfmac_f32_16x16x64_bf16 v[188:191], v[192:195], v[24:31], v196
    ds_read_b128 v[152:155], v204 offset:0
    v_exp_f32 v43, v43
    v_exp_f32 v44, v44
    v_mfma_f32_32x32x16_bf16 v[56:71], v[164:167], v[116:119], v[56:71]
    v_exp_f32 v45, v45
    v_exp_f32 v46, v46
    v_exp_f32 v47, v47
    v_smfmac_f32_32x32x32_bf16 v[240:255], v[168:171], v[24:31], v196
    v_exp_f32 v48, v48
    v_exp_f32 v49, v49
    v_exp_f32 v50, v50
    v_smfmac_f32_16x16x64_bf16 v[188:191], v[192:195], v[32:39], v196
    ds_read_b128 v[156:159], v204 offset:1024
    v_exp_f32 v51, v51
    v_exp_f32 v52, v52
    v_smfmac_f32_32x32x32_bf16 v[240:255], v[172:175], v[32:39], v196
    s_waitcnt lgkmcnt(1)
    v_exp_f32 v53, v53
    v_exp_f32 v54, v54
    v_exp_f32 v55, v55
    v_mfma_f32_32x32x16_bf16 v[8:23], v[152:155], v[104:107], v[120:135]
    s_waitcnt lgkmcnt(0)
    v_exp_f32 v56, v56
    v_exp_f32 v57, v57
    v_exp_f32 v58, v58
    v_smfmac_f32_16x16x64_bf16 v[184:187], v[192:195], v[40:47], v196
    ds_read_b128 v[168:171], v197 offset:2048
    v_exp_f32 v59, v59
    v_exp_f32 v60, v60
    v_mfma_f32_32x32x16_bf16 v[8:23], v[156:159], v[108:111], v[8:23]
    v_exp_f32 v61, v61
    v_exp_f32 v62, v62
    v_exp_f32 v63, v63
    v_smfmac_f32_32x32x32_bf16 v[224:239], v[176:179], v[40:47], v196
    v_exp_f32 v64, v64
    v_exp_f32 v65, v65
    v_exp_f32 v66, v66
    v_smfmac_f32_16x16x64_bf16 v[184:187], v[192:195], v[48:55], v196
    ds_read_b128 v[172:175], v197 offset:3072
    v_exp_f32 v67, v67
    v_exp_f32 v68, v68
    v_smfmac_f32_32x32x32_bf16 v[224:239], v[180:183], v[48:55], v196
    v_exp_f32 v69, v69
    v_exp_f32 v70, v70
    v_exp_f32 v71, v71
    v_mfma_f32_32x32x16_bf16 v[24:39], v[152:155], v[112:115], v[136:151]
    v_exp_f32 v8, v8
    v_exp_f32 v9, v9
    v_exp_f32 v10, v10
    v_smfmac_f32_16x16x64_bf16 v[188:191], v[192:195], v[56:63], v196
    ds_read_b128 v[160:163], v204 offset:4096
    v_exp_f32 v11, v11
    v_exp_f32 v12, v12
    v_mfma_f32_32x32x16_bf16 v[24:39], v[156:159], v[116:119], v[24:39]
    v_exp_f32 v13, v13
    v_exp_f32 v14, v14
    v_exp_f32 v15, v15
    v_smfmac_f32_32x32x32_bf16 v[240:255], v[176:179], v[56:63], v196
    v_exp_f32 v16, v16
    v_exp_f32 v17, v17
    v_exp_f32 v18, v18
    v_smfmac_f32_16x16x64_bf16 v[188:191], v[192:195], v[64:71], v196
    ds_read_b128 v[164:167], v204 offset:5120
    v_exp_f32 v19, v19
    v_exp_f32 v20, v20
    v_smfmac_f32_32x32x32_bf16 v[240:255], v[180:183], v[64:71], v196
    s_waitcnt lgkmcnt(1)
    v_exp_f32 v21, v21
    v_exp_f32 v22, v22
    v_exp_f32 v23, v23
    v_mfma_f32_32x32x16_bf16 v[40:55], v[160:163], v[104:107], v[120:135]
    s_waitcnt lgkmcnt(0)
    v_exp_f32 v24, v24
    v_exp_f32 v25, v25
    v_exp_f32 v26, v26
    v_smfmac_f32_16x16x64_bf16 v[184:187], v[192:195], v[8:15], v196
    ds_read_b128 v[176:179], v197 offset:6144
    v_exp_f32 v27, v27
    v_exp_f32 v28, v28
    v_mfma_f32_32x32x16_bf16 v[40:55], v[164:167], v[108:111], v[40:55]
    v_exp_f32 v29, v29
    v_exp_f32 v30, v30
    v_exp_f32 v31, v31
    v_smfmac_f32_32x32x32_bf16 v[224:239], v[168:171], v[8:15], v196
    v_exp_f32 v32, v32
    v_exp_f32 v33, v33
    v_exp_f32 v34, v34
    v_smfmac_f32_16x16x64_bf16 v[184:187], v[192:195], v[16:23], v196
    ds_read_b128 v[180:183], v197 offset:7168
    v_exp_f32 v35, v35
    v_exp_f32 v36, v36
    v_smfmac_f32_32x32x32_bf16 v[224:239], v[172:175], v[16:23], v196
    s_and_b32 s26, s16, 6
    s_cmp_eq_u32 s26, 2
    s_cbranch_scc0 Lpub2
    s_waitcnt vmcnt(0)
    s_mov_b64 exec, 1
    buffer_store_dwordx2 v[222:223], v221, s[8:11], 0 offen sc1
    s_mov_b64 exec, -1
Lpub2:
    v_exp_f32 v37, v37
    v_exp_f32 v38, v38
    v_exp_f32 v39, v39
    s_cbranch_vccz Lskip72
    s_add_u32 s84, s84, 16384
    s_xor_b32 s87, s84, s23
    s_add_u32 s22, s87, 262144
    s_bfe_u32 s26, s87, 0x1000e
    s_lshl_b32 s26, s26, 1
    s_add_u32 s90, s26, s51
    s_lshr_b32 s26, s87, 15
    s_lshl_b32 s24, s26, 7
    s_branch Lspin_c1a
Lspin_c1a_r:
    s_mov_b32 m0, s85
    s_nop 0
    buffer_load_dwordx4 v198, s[4:7], s87 offen offset:0 sc1 lds
    buffer_load_dwordx4 v198, s[4:7], s87 offen offset:1024 sc1 lds
    buffer_load_dwordx4 v198, s[4:7], s87 offen offset:2048 sc1 lds
    buffer_load_dwordx4 v198, s[4:7], s87 offen offset:3072 sc1 lds
    s_add_u32 m0, s85, 16384
    s_nop 0
    buffer_load_dwordx4 v198, s[4:7], s22 offen offset:0 sc1 lds
    buffer_load_dwordx4 v198, s[4:7], s22 offen offset:1024 sc1 lds
    buffer_load_dwordx4 v198, s[4:7], s22 offen offset:2048 sc1 lds
    buffer_load_dwordx4 v198, s[4:7], s22 offen offset:3072 sc1 lds
Lskip72:
    v_mfma_f32_32x32x16_bf16 v[56:71], v[160:163], v[112:115], v[136:151]
    v_exp_f32 v40, v40
    v_exp_f32 v41, v41
    v_exp_f32 v42, v42
    v_smfmac_f32_16x16x64_bf16 v[188:191], v[192:195], v[24:31], v196
    ds_read_b128 v[152:155], v204 offset:8192
    v_exp_f32 v43, v43
    v_exp_f32 v44, v44
    v_mfma_f32_32x32x16_bf16 v[56:71], v[164:167], v[116:119], v[56:71]
    v_exp_f32 v45, v45
    v_exp_f32 v46, v46
    v_exp_f32 v47, v47
    v_smfmac_f32_32x32x32_bf16 v[240:255], v[168:171], v[24:31], v196
    v_exp_f32 v48, v48
    v_exp_f32 v49, v49
    v_exp_f32 v50, v50
    v_smfmac_f32_16x16x64_bf16 v[188:191], v[192:195], v[32:39], v196
    ds_read_b128 v[156:159], v204 offset:9216
    v_exp_f32 v51, v51
    v_exp_f32 v52, v52
    v_smfmac_f32_32x32x32_bf16 v[240:255], v[172:175], v[32:39], v196
    s_waitcnt lgkmcnt(1)
    v_exp_f32 v53, v53
    v_exp_f32 v54, v54
    v_exp_f32 v55, v55
    v_mfma_f32_32x32x16_bf16 v[8:23], v[152:155], v[104:107], v[120:135]
    s_waitcnt lgkmcnt(0)
    v_exp_f32 v56, v56
    v_exp_f32 v57, v57
    v_exp_f32 v58, v58
    v_smfmac_f32_16x16x64_bf16 v[184:187], v[192:195], v[40:47], v196
    ds_read_b128 v[168:171], v197 offset:10240
    v_exp_f32 v59, v59
    v_exp_f32 v60, v60
    v_mfma_f32_32x32x16_bf16 v[8:23], v[156:159], v[108:111], v[8:23]
    v_exp_f32 v61, v61
    v_exp_f32 v62, v62
    v_exp_f32 v63, v63
    v_smfmac_f32_32x32x32_bf16 v[224:239], v[176:179], v[40:47], v196
    v_exp_f32 v64, v64
    v_exp_f32 v65, v65
    v_exp_f32 v66, v66
    v_smfmac_f32_16x16x64_bf16 v[184:187], v[192:195], v[48:55], v196
    ds_read_b128 v[172:175], v197 offset:11264
    v_exp_f32 v67, v67
    v_exp_f32 v68, v68
    v_smfmac_f32_32x32x32_bf16 v[224:239], v[180:183], v[48:55], v196
    v_exp_f32 v69, v69
    v_exp_f32 v70, v70
    v_exp_f32 v71, v71
    v_mfma_f32_32x32x16_bf16 v[24:39], v[152:155], v[112:115], v[136:151]
    v_exp_f32 v8, v8
    v_exp_f32 v9, v9
    v_exp_f32 v10, v10
    v_smfmac_f32_16x16x64_bf16 v[188:191], v[192:195], v[56:63], v196
    ds_read_b128 v[160:163], v204 offset:12288
    v_exp_f32 v11, v11
    v_exp_f32 v12, v12
    v_mfma_f32_32x32x16_bf16 v[24:39], v[156:159], v[116:119], v[24:39]
    v_exp_f32 v13, v13
    v_exp_f32 v14, v14
    v_exp_f32 v15, v15
    v_smfmac_f32_32x32x32_bf16 v[240:255], v[176:179], v[56:63], v196
    v_exp_f32 v16, v16
    v_exp_f32 v17, v17
    v_exp_f32 v18, v18
    v_smfmac_f32_16x16x64_bf16 v[188:191], v[192:195], v[64:71], v196
    ds_read_b128 v[164:167], v204 offset:13312
    v_exp_f32 v19, v19
    v_exp_f32 v20, v20
    v_smfmac_f32_32x32x32_bf16 v[240:255], v[180:183], v[64:71], v196
    s_waitcnt lgkmcnt(1)
    v_exp_f32 v21, v21
    v_exp_f32 v22, v22
    v_exp_f32 v23, v23
    v_mfma_f32_32x32x16_bf16 v[40:55], v[160:163], v[104:107], v[120:135]
    s_waitcnt lgkmcnt(0)
    v_exp_f32 v24, v24
    v_exp_f32 v25, v25
    v_exp_f32 v26, v26
    v_smfmac_f32_16x16x64_bf16 v[184:187], v[192:195], v[8:15], v196
    ds_read_b128 v[176:179], v197 offset:14336
    v_exp_f32 v27, v27
    v_exp_f32 v28, v28
    v_mfma_f32_32x32x16_bf16 v[40:55], v[164:167], v[108:111], v[40:55]
    v_exp_f32 v29, v29
    v_exp_f32 v30, v30
    v_exp_f32 v31, v31
    v_smfmac_f32_32x32x32_bf16 v[224:239], v[168:171], v[8:15], v196
    v_exp_f32 v32, v32
    v_exp_f32 v33, v33
    v_exp_f32 v34, v34
    v_smfmac_f32_16x16x64_bf16 v[184:187], v[192:195], v[16:23], v196
    ds_read_b128 v[180:183], v197 offset:15360
    v_exp_f32 v35, v35
    v_exp_f32 v36, v36
    v_smfmac_f32_32x32x32_bf16 v[224:239], v[172:175], v[16:23], v196
    v_exp_f32 v37, v37
    v_exp_f32 v38, v38
    v_exp_f32 v39, v39
    s_waitcnt vmcnt(0) lgkmcnt(0)
    s_barrier
    v_mfma_f32_32x32x16_bf16 v[56:71], v[160:163], v[112:115], v[136:151]
    v_xor_b32 v197, 32768, v197
    v_xor_b32 v204, 32768, v204
    v_exp_f32 v40, v40
    v_exp_f32 v41, v41
    v_exp_f32 v42, v42
    v_smfmac_f32_16x16x64_bf16 v[188:191], v[192:195], v[24:31], v196
    ds_read_b128 v[152:155], v204 offset:0
    v_exp_f32 v43, v43
    v_exp_f32 v44, v44
    v_mfma_f32_32x32x16_bf16 v[56:71], v[164:167], v[116:119], v[56:71]
    s_cbranch_vccz Lskip73
    v_cmp_eq_u64 s[82:83], s[80:81], v[200:201]
    s_xor_b32 s85, s85, 32768
    s_add_u32 s84, s84, 16384
    s_xor_b32 s87, s84, s23
    s_add_u32 s22, s87, 262144
    s_bfe_u32 s26, s87, 0x1000e
    s_lshl_b32 s26, s26, 1
    s_add_u32 s90, s26, s51
    s_mov_b32 m0, s85
    s_lshr_b32 s26, s82, s90
    s_andn2_b32 s26, 0x11, s26
    s_cbranch_scc1 Lspin_c1
Lspin_c1_r:
    buffer_load_dwordx4 v198, s[4:7], s87 offen offset:0 sc1 lds
    buffer_load_dwordx4 v198, s[4:7], s87 offen offset:1024 sc1 lds
    buffer_load_dwordx4 v198, s[4:7], s87 offen offset:2048 sc1 lds
    buffer_load_dwordx4 v198, s[4:7], s87 offen offset:3072 sc1 lds
Lskip73:
    v_exp_f32 v45, v45
    v_exp_f32 v46, v46
    v_exp_f32 v47, v47
    v_smfmac_f32_32x32x32_bf16 v[240:255], v[168:171], v[24:31], v196
    v_exp_f32 v48, v48
    v_exp_f32 v49, v49
    v_exp_f32 v50, v50
    v_smfmac_f32_16x16x64_bf16 v[188:191], v[192:195], v[32:39], v196
    ds_read_b128 v[156:159], v204 offset:1024
    v_exp_f32 v51, v51
    v_exp_f32 v52, v52
    v_smfmac_f32_32x32x32_bf16 v[240:255], v[172:175], v[32:39], v196
    s_cbranch_vccz Lskip74
    s_add_u32 m0, s85, 16384
    s_nop 0
    buffer_load_dwordx4 v198, s[4:7], s22 offen offset:0 sc1 lds
    buffer_load_dwordx4 v198, s[4:7], s22 offen offset:1024 sc1 lds
    buffer_load_dwordx4 v198, s[4:7], s22 offen offset:2048 sc1 lds
    buffer_load_dwordx4 v198, s[4:7], s22 offen offset:3072 sc1 lds
    s_add_u32 s26, s84, 16384
    s_xor_b32 s26, s26, s23
    s_bfe_u32 s26, s26, 0x3000f
    s_lshl_b32 s24, s26, 7
    buffer_load_dwordx2 v[200:201], v202, s[8:11], s24 offen sc1
Lskip74:
    s_waitcnt lgkmcnt(1)
    v_exp_f32 v53, v53
    v_exp_f32 v54, v54
    v_exp_f32 v55, v55
    v_mfma_f32_32x32x16_bf16 v[8:23], v[152:155], v[104:107], v[120:135]
    s_waitcnt lgkmcnt(0)
    v_exp_f32 v56, v56
    v_exp_f32 v57, v57
    v_exp_f32 v58, v58
    v_smfmac_f32_16x16x64_bf16 v[184:187], v[192:195], v[40:47], v196
    ds_read_b128 v[168:171], v197 offset:2048
    v_exp_f32 v59, v59
    v_exp_f32 v60, v60
    v_mfma_f32_32x32x16_bf16 v[8:23], v[156:159], v[108:111], v[8:23]
    v_exp_f32 v61, v61
    v_exp_f32 v62, v62
    v_exp_f32 v63, v63
    v_smfmac_f32_32x32x32_bf16 v[224:239], v[176:179], v[40:47], v196
    v_exp_f32 v64, v64
    v_exp_f32 v65, v65
    v_exp_f32 v66, v66
    v_smfmac_f32_16x16x64_bf16 v[184:187], v[192:195], v[48:55], v196
    ds_read_b128 v[172:175], v197 offset:3072
    v_exp_f32 v67, v67
    v_exp_f32 v68, v68
    v_smfmac_f32_32x32x32_bf16 v[224:239], v[180:183], v[48:55], v196
    v_exp_f32 v69, v69
    v_exp_f32 v70, v70
    v_exp_f32 v71, v71
    s_mov_b32 s86, 11
    s_cbranch_vccz Lattn_y
    .p2align 6
Lattn_loop:
    v_mfma_f32_32x32x16_bf16 v[24:39], v[152:155], v[112:115], v[136:151]
    v_exp_f32 v8, v8
    v_exp_f32 v9, v9
    v_exp_f32 v10, v10
    v_smfmac_f32_16x16x64_bf16 v[188:191], v[192:195], v[56:63], v196
    ds_read_b128 v[160:163], v204 offset:4096
    v_exp_f32 v11, v11
    v_exp_f32 v12, v12
    v_mfma_f32_32x32x16_bf16 v[24:39], v[156:159], v[116:119], v[24:39]
    v_exp_f32 v13, v13
    v_exp_f32 v14, v14
    v_exp_f32 v15, v15
    v_smfmac_f32_32x32x32_bf16 v[240:255], v[176:179], v[56:63], v196
    v_exp_f32 v16, v16
    v_exp_f32 v17, v17
    v_exp_f32 v18, v18
    v_smfmac_f32_16x16x64_bf16 v[188:191], v[192:195], v[64:71], v196
    ds_read_b128 v[164:167], v204 offset:5120
    v_exp_f32 v19, v19
    v_exp_f32 v20, v20
    v_smfmac_f32_32x32x32_bf16 v[240:255], v[180:183], v[64:71], v196
    s_waitcnt lgkmcnt(1)
    v_exp_f32 v21, v21
    v_exp_f32 v22, v22
    v_exp_f32 v23, v23
    v_mfma_f32_32x32x16_bf16 v[40:55], v[160:163], v[104:107], v[120:135]
    s_waitcnt lgkmcnt(0)
    v_exp_f32 v24, v24
    v_exp_f32 v25, v25
    v_exp_f32 v26, v26
    v_smfmac_f32_16x16x64_bf16 v[184:187], v[192:195], v[8:15], v196
    ds_read_b128 v[176:179], v197 offset:6144
    v_exp_f32 v27, v27
    v_exp_f32 v28, v28
    v_mfma_f32_32x32x16_bf16 v[40:55], v[164:167], v[108:111], v[40:55]
    v_exp_f32 v29, v29
    v_exp_f32 v30, v30
    v_exp_f32 v31, v31
    v_smfmac_f32_32x32x32_bf16 v[224:239], v[168:171], v[8:15], v196
    v_exp_f32 v32, v32
    v_exp_f32 v33, v33
    v_exp_f32 v34, v34
    v_smfmac_f32_16x16x64_bf16 v[184:187], v[192:195], v[16:23], v196
    ds_read_b128 v[180:183], v197 offset:7168
    v_exp_f32 v35, v35
    v_exp_f32 v36, v36
    v_smfmac_f32_32x32x32_bf16 v[224:239], v[172:175], v[16:23], v196
    v_exp_f32 v37, v37
    v_exp_f32 v38, v38
    v_exp_f32 v39, v39
    v_mfma_f32_32x32x16_bf16 v[56:71], v[160:163], v[112:115], v[136:151]
    v_exp_f32 v40, v40
    v_exp_f32 v41, v41
    v_exp_f32 v42, v42
    v_smfmac_f32_16x16x64_bf16 v[188:191], v[192:195], v[24:31], v196
    ds_read_b128 v[152:155], v204 offset:8192
    v_exp_f32 v43, v43
    v_exp_f32 v44, v44
    v_mfma_f32_32x32x16_bf16 v[56:71], v[164:167], v[116:119], v[56:71]
    v_exp_f32 v45, v45
    v_exp_f32 v46, v46
    v_exp_f32 v47, v47
    v_smfmac_f32_32x32x32_bf16 v[240:255], v[168:171], v[24:31], v196
    v_exp_f32 v48, v48
    v_exp_f32 v49, v49
    v_exp_f32 v50, v50
    v_smfmac_f32_16x16x64_bf16 v[188:191], v[192:195], v[32:39], v196
    ds_read_b128 v[156:159], v204 offset:9216
    v_exp_f32 v51, v51
    v_exp_f32 v52, v52
    v_smfmac_f32_32x32x32_bf16 v[240:255], v[172:175], v[32:39], v196
    s_waitcnt lgkmcnt(1)
    v_exp_f32 v53, v53
    v_exp_f32 v54, v54
    v_exp_f32 v55, v55
    v_mfma_f32_32x32x16_bf16 v[8:23], v[152:155], v[104:107], v[120:135]
    s_waitcnt lgkmcnt(0)
    v_exp_f32 v56, v56
    v_exp_f32 v57, v57
    v_exp_f32 v58, v58
    v_smfmac_f32_16x16x64_bf16 v[184:187], v[192:195], v[40:47], v196
    ds_read_b128 v[168:171], v197 offset:10240
    v_exp_f32 v59, v59
    v_exp_f32 v60, v60
    v_mfma_f32_32x32x16_bf16 v[8:23], v[156:159], v[108:111], v[8:23]
    v_exp_f32 v61, v61
    v_exp_f32 v62, v62
    v_exp_f32 v63, v63
    v_smfmac_f32_32x32x32_bf16 v[224:239], v[176:179], v[40:47], v196
    v_exp_f32 v64, v64
    v_exp_f32 v65, v65
    v_exp_f32 v66, v66
    v_smfmac_f32_16x16x64_bf16 v[184:187], v[192:195], v[48:55], v196
    ds_read_b128 v[172:175], v197 offset:11264
    v_exp_f32 v67, v67
    v_exp_f32 v68, v68
    v_smfmac_f32_32x32x32_bf16 v[224:239], v[180:183], v[48:55], v196
    v_exp_f32 v69, v69
    v_exp_f32 v70, v70
    v_exp_f32 v71, v71
    v_mfma_f32_32x32x16_bf16 v[24:39], v[152:155], v[112:115], v[136:151]
    v_exp_f32 v8, v8
    v_exp_f32 v9, v9
    v_exp_f32 v10, v10
    v_smfmac_f32_16x16x64_bf16 v[188:191], v[192:195], v[56:63], v196
    ds_read_b128 v[160:163], v204 offset:12288
    v_exp_f32 v11, v11
    v_exp_f32 v12, v12
    v_mfma_f32_32x32x16_bf16 v[24:39], v[156:159], v[116:119], v[24:39]
    v_exp_f32 v13, v13
    v_exp_f32 v14, v14
    v_exp_f32 v15, v15
    v_smfmac_f32_32x32x32_bf16 v[240:255], v[176:179], v[56:63], v196
    v_exp_f32 v16, v16
    v_exp_f32 v17, v17
    v_exp_f32 v18, v18
    v_smfmac_f32_16x16x64_bf16 v[188:191], v[192:195], v[64:71], v196
    ds_read_b128 v[164:167], v204 offset:13312
    v_exp_f32 v19, v19
    v_exp_f32 v20, v20
    v_smfmac_f32_32x32x32_bf16 v[240:255], v[180:183], v[64:71], v196
    s_waitcnt lgkmcnt(1)
    v_exp_f32 v21, v21
    v_exp_f32 v22, v22
    v_exp_f32 v23, v23
    v_mfma_f32_32x32x16_bf16 v[40:55], v[160:163], v[104:107], v[120:135]
    s_waitcnt lgkmcnt(0)
    v_exp_f32 v24, v24
    v_exp_f32 v25, v25
    v_exp_f32 v26, v26
    v_smfmac_f32_16x16x64_bf16 v[184:187], v[192:195], v[8:15], v196
    ds_read_b128 v[176:179], v197 offset:14336
    v_exp_f32 v27, v27
    v_exp_f32 v28, v28
    v_mfma_f32_32x32x16_bf16 v[40:55], v[164:167], v[108:111], v[40:55]
    v_exp_f32 v29, v29
    v_exp_f32 v30, v30
    v_exp_f32 v31, v31
    v_smfmac_f32_32x32x32_bf16 v[224:239], v[168:171], v[8:15], v196
    v_exp_f32 v32, v32
    v_exp_f32 v33, v33
    v_exp_f32 v34, v34
    v_smfmac_f32_16x16x64_bf16 v[184:187], v[192:195], v[16:23], v196
    ds_read_b128 v[180:183], v197 offset:15360
    v_exp_f32 v35, v35
    v_exp_f32 v36, v36
    v_smfmac_f32_32x32x32_bf16 v[224:239], v[172:175], v[16:23], v196
    v_exp_f32 v37, v37
    v_exp_f32 v38, v38
    v_exp_f32 v39, v39
    s_waitcnt vmcnt(0) lgkmcnt(0)
    s_barrier
    v_mfma_f32_32x32x16_bf16 v[56:71], v[160:163], v[112:115], v[136:151]
    v_xor_b32 v197, 32768, v197
    v_xor_b32 v204, 32768, v204
    v_exp_f32 v40, v40
    v_exp_f32 v41, v41
    v_exp_f32 v42, v42
    v_smfmac_f32_16x16x64_bf16 v[188:191], v[192:195], v[24:31], v196
    ds_read_b128 v[152:155], v204 offset:0
    v_exp_f32 v43, v43
    v_exp_f32 v44, v44
    v_mfma_f32_32x32x16_bf16 v[56:71], v[164:167], v[116:119], v[56:71]
    v_cmp_eq_u64 s[82:83], s[80:81], v[200:201]
    s_xor_b32 s85, s85, 32768
    s_add_u32 s84, s84, 16384
    s_xor_b32 s87, s84, s23
    s_add_u32 s22, s87, 262144
    s_bfe_u32 s26, s87, 0x1000e
    s_lshl_b32 s26, s26, 1
    s_add_u32 s90, s26, s51
    s_mov_b32 m0, s85
    s_lshr_b32 s26, s82, s90
    s_andn2_b32 s26, 0x11, s26
    s_cbranch_scc1 Lspin_loop
Lspin_loop_r:
    buffer_load_dwordx4 v198, s[4:7], s87 offen offset:0 sc1 lds
    buffer_load_dwordx4 v198, s[4:7], s87 offen offset:1024 sc1 lds
    buffer_load_dwordx4 v198, s[4:7], s87 offen offset:2048 sc1 lds
    buffer_load_dwordx4 v198, s[4:7], s87 offen offset:3072 sc1 lds
    v_exp_f32 v45, v45
    v_exp_f32 v46, v46
    v_exp_f32 v47, v47
    v_smfmac_f32_32x32x32_bf16 v[240:255], v[168:171], v[24:31], v196
    v_exp_f32 v48, v48
    v_exp_f32 v49, v49
    v_exp_f32 v50, v50
    v_smfmac_f32_16x16x64_bf16 v[188:191], v[192:195], v[32:39], v196
    ds_read_b128 v[156:159], v204 offset:1024
    v_exp_f32 v51, v51
    v_exp_f32 v52, v52
    v_smfmac_f32_32x32x32_bf16 v[240:255], v[172:175], v[32:39], v196
    s_add_u32 m0, s85, 16384
    s_nop 0
    buffer_load_dwordx4 v198, s[4:7], s22 offen offset:0 sc1 lds
    buffer_load_dwordx4 v198, s[4:7], s22 offen offset:1024 sc1 lds
    buffer_load_dwordx4 v198, s[4:7], s22 offen offset:2048 sc1 lds
    buffer_load_dwordx4 v198, s[4:7], s22 offen offset:3072 sc1 lds
    s_add_u32 s26, s84, 16384
    s_xor_b32 s26, s26, s23
    s_bfe_u32 s26, s26, 0x3000f
    s_lshl_b32 s24, s26, 7
    buffer_load_dwordx2 v[200:201], v202, s[8:11], s24 offen sc1
    s_waitcnt lgkmcnt(1)
    v_exp_f32 v53, v53
    v_exp_f32 v54, v54
    v_exp_f32 v55, v55
    v_mfma_f32_32x32x16_bf16 v[8:23], v[152:155], v[104:107], v[120:135]
    s_waitcnt lgkmcnt(0)
    v_exp_f32 v56, v56
    v_exp_f32 v57, v57
    v_exp_f32 v58, v58
    v_smfmac_f32_16x16x64_bf16 v[184:187], v[192:195], v[40:47], v196
    ds_read_b128 v[168:171], v197 offset:2048
    v_exp_f32 v59, v59
    v_exp_f32 v60, v60
    v_mfma_f32_32x32x16_bf16 v[8:23], v[156:159], v[108:111], v[8:23]
    s_cmp_gt_u32 s86, 3
    s_cbranch_scc0 Lnowo
    s_add_u32 s20, s20, 1
    s_add_u32 s26, s20, s19
    s_and_b32 s26, s26, 7
    s_xor_b32 s27, s20, s19
    s_and_b32 s27, s27, 8
    s_or_b32 s26, s26, s27
    s_lshl_b32 s26, s26, 1
    s_lshr_b32 s27, s20, 4
    s_add_u32 s26, s26, s27
    s_lshl_b32 s26, s26, 16
    s_mov_b32 m0, s89
    s_add_u32 s88, s26, s21
    s_add_u32 s89, s89, 4096
    buffer_load_dwordx4 v199, s[52:55], s88 offen lds
    s_add_u32 s20, s20, 1
    s_add_u32 s26, s20, s19
    s_and_b32 s26, s26, 7
    s_xor_b32 s27, s20, s19
    s_and_b32 s27, s27, 8
    s_or_b32 s26, s26, s27
    s_lshl_b32 s26, s26, 1
    s_lshr_b32 s27, s20, 4
    s_add_u32 s26, s26, s27
    s_lshl_b32 s26, s26, 16
    s_mov_b32 m0, s89
    s_add_u32 s88, s26, s21
    s_add_u32 s89, s89, 4096
    buffer_load_dwordx4 v199, s[52:55], s88 offen lds
Lnowo:
    s_cmp_eq_u32 s86, 2
    s_cbranch_scc0 Lnopf2
    s_getpc_b64 s[26:27]
Lpcref2:
    s_lshl_b32 s28, s16, 13
    v_lshlrev_b32 v2, 7, v1
    v_add_u32 v2, s28, v2
    v_min_u32 v2, Lattn_fallback-Lattn_j-4, v2
    s_add_u32 s26, s26, Lattn_j-Lpcref2
    s_addc_u32 s27, s27, 0
    v_mov_b32 v3, s27
    v_add_co_u32 v2, s[28:29], s26, v2
    s_nop 1
    v_addc_co_u32 v3, s[28:29], 0, v3, s[28:29]
    global_load_dword v4, v[2:3], off
Lnopf2:
    s_cmp_eq_u32 s86, 1
    s_cbranch_scc0 Lno15
    s_add_u32 s84, s84, 16384
    s_xor_b32 s87, s84, s23
    s_add_u32 s22, s87, 262144
    s_bfe_u32 s26, s87, 0x1000e
    s_lshl_b32 s26, s26, 1
    s_add_u32 s90, s26, s51
    s_add_u32 m0, s85, 131072
    s_lshr_b32 s26, s82, s90
    s_andn2_b32 s26, 0x11, s26
    s_cbranch_scc1 Lspin_15
Lspin_15_r:
    buffer_load_dwordx4 v198, s[4:7], s87 offen offset:0 sc1 lds
    buffer_load_dwordx4 v198, s[4:7], s87 offen offset:1024 sc1 lds
    buffer_load_dwordx4 v198, s[4:7], s87 offen offset:2048 sc1 lds
    buffer_load_dwordx4 v198, s[4:7], s87 offen offset:3072 sc1 lds
    s_add_u32 m0, s85, 147456
    s_nop 0
    buffer_load_dwordx4 v198, s[4:7], s22 offen offset:0 sc1 lds
    buffer_load_dwordx4 v198, s[4:7], s22 offen offset:1024 sc1 lds
    buffer_load_dwordx4 v198, s[4:7], s22 offen offset:2048 sc1 lds
    buffer_load_dwordx4 v198, s[4:7], s22 offen offset:3072 sc1 lds
Lno15:
    v_exp_f32 v61, v61
    v_exp_f32 v62, v62
    v_exp_f32 v63, v63
    v_smfmac_f32_32x32x32_bf16 v[224:239], v[176:179], v[40:47], v196
    v_exp_f32 v64, v64
    v_exp_f32 v65, v65
    v_exp_f32 v66, v66
    v_smfmac_f32_16x16x64_bf16 v[184:187], v[192:195], v[48:55], v196
    ds_read_b128 v[172:175], v197 offset:3072
    v_exp_f32 v67, v67
    v_exp_f32 v68, v68
    v_smfmac_f32_32x32x32_bf16 v[224:239], v[180:183], v[48:55], v196
    s_sub_u32 s86, s86, 1
    s_cmp_lg_u32 s86, 0
    v_exp_f32 v69, v69
    v_exp_f32 v70, v70
    v_exp_f32 v71, v71
    s_cbranch_scc1 Lattn_loop
    s_branch Lattn_j
Lattn_y:
    .p2align 6
Lattn_loop_y:
    v_mfma_f32_32x32x16_bf16 v[24:39], v[152:155], v[112:115], v[136:151]
    v_exp_f32 v8, v8
    v_exp_f32 v9, v9
    v_exp_f32 v10, v10
    v_smfmac_f32_16x16x64_bf16 v[188:191], v[192:195], v[56:63], v196
    ds_read_b128 v[160:163], v204 offset:4096
    v_exp_f32 v11, v11
    v_exp_f32 v12, v12
    v_mfma_f32_32x32x16_bf16 v[24:39], v[156:159], v[116:119], v[24:39]
    v_exp_f32 v13, v13
    v_exp_f32 v14, v14
    v_exp_f32 v15, v15
    v_smfmac_f32_32x32x32_bf16 v[240:255], v[176:179], v[56:63], v196
    v_exp_f32 v16, v16
    v_exp_f32 v17, v17
    v_exp_f32 v18, v18
    v_smfmac_f32_16x16x64_bf16 v[188:191], v[192:195], v[64:71], v196
    ds_read_b128 v[164:167], v204 offset:5120
    v_exp_f32 v19, v19
    v_exp_f32 v20, v20
    v_smfmac_f32_32x32x32_bf16 v[240:255], v[180:183], v[64:71], v196
    s_waitcnt lgkmcnt(1)
    v_exp_f32 v21, v21
    v_exp_f32 v22, v22
    v_exp_f32 v23, v23
    v_mfma_f32_32x32x16_bf16 v[40:55], v[160:163], v[104:107], v[120:135]
    s_waitcnt lgkmcnt(0)
    v_exp_f32 v24, v24
    v_exp_f32 v25, v25
    v_exp_f32 v26, v26
    v_smfmac_f32_16x16x64_bf16 v[184:187], v[192:195], v[8:15], v196
    ds_read_b128 v[176:179], v197 offset:6144
    v_exp_f32 v27, v27
    v_exp_f32 v28, v28
    v_mfma_f32_32x32x16_bf16 v[40:55], v[164:167], v[108:111], v[40:55]
    v_exp_f32 v29, v29
    v_exp_f32 v30, v30
    v_exp_f32 v31, v31
    v_smfmac_f32_32x32x32_bf16 v[224:239], v[168:171], v[8:15], v196
    v_exp_f32 v32, v32
    v_exp_f32 v33, v33
    v_exp_f32 v34, v34
    v_smfmac_f32_16x16x64_bf16 v[184:187], v[192:195], v[16:23], v196
    ds_read_b128 v[180:183], v197 offset:7168
    v_exp_f32 v35, v35
    v_exp_f32 v36, v36
    v_smfmac_f32_32x32x32_bf16 v[224:239], v[172:175], v[16:23], v196
    v_exp_f32 v37, v37
    v_exp_f32 v38, v38
    v_exp_f32 v39, v39
    v_mfma_f32_32x32x16_bf16 v[56:71], v[160:163], v[112:115], v[136:151]
    v_exp_f32 v40, v40
    v_exp_f32 v41, v41
    v_exp_f32 v42, v42
    v_smfmac_f32_16x16x64_bf16 v[188:191], v[192:195], v[24:31], v196
    ds_read_b128 v[152:155], v204 offset:8192
    v_exp_f32 v43, v43
    v_exp_f32 v44, v44
    v_mfma_f32_32x32x16_bf16 v[56:71], v[164:167], v[116:119], v[56:71]
    v_exp_f32 v45, v45
    v_exp_f32 v46, v46
    v_exp_f32 v47, v47
    v_smfmac_f32_32x32x32_bf16 v[240:255], v[168:171], v[24:31], v196
    v_exp_f32 v48, v48
    v_exp_f32 v49, v49
    v_exp_f32 v50, v50
    v_smfmac_f32_16x16x64_bf16 v[188:191], v[192:195], v[32:39], v196
    ds_read_b128 v[156:159], v204 offset:9216
    v_exp_f32 v51, v51
    v_exp_f32 v52, v52
    v_smfmac_f32_32x32x32_bf16 v[240:255], v[172:175], v[32:39], v196
    s_waitcnt lgkmcnt(1)
    v_exp_f32 v53, v53
    v_exp_f32 v54, v54
    v_exp_f32 v55, v55
    v_mfma_f32_32x32x16_bf16 v[8:23], v[152:155], v[104:107], v[120:135]
    s_waitcnt lgkmcnt(0)
    v_exp_f32 v56, v56
    v_exp_f32 v57, v57
    v_exp_f32 v58, v58
    v_smfmac_f32_16x16x64_bf16 v[184:187], v[192:195], v[40:47], v196
    ds_read_b128 v[168:171], v197 offset:10240
    v_exp_f32 v59, v59
    v_exp_f32 v60, v60
    v_mfma_f32_32x32x16_bf16 v[8:23], v[156:159], v[108:111], v[8:23]
    v_exp_f32 v61, v61
    v_exp_f32 v62, v62
    v_exp_f32 v63, v63
    v_smfmac_f32_32x32x32_bf16 v[224:239], v[176:179], v[40:47], v196
    v_exp_f32 v64, v64
    v_exp_f32 v65, v65
    v_exp_f32 v66, v66
    v_smfmac_f32_16x16x64_bf16 v[184:187], v[192:195], v[48:55], v196
    ds_read_b128 v[172:175], v197 offset:11264
    v_exp_f32 v67, v67
    v_exp_f32 v68, v68
    v_smfmac_f32_32x32x32_bf16 v[224:239], v[180:183], v[48:55], v196
    v_exp_f32 v69, v69
    v_exp_f32 v70, v70
    v_exp_f32 v71, v71
    v_mfma_f32_32x32x16_bf16 v[24:39], v[152:155], v[112:115], v[136:151]
    v_exp_f32 v8, v8
    v_exp_f32 v9, v9
    v_exp_f32 v10, v10
    v_smfmac_f32_16x16x64_bf16 v[188:191], v[192:195], v[56:63], v196
    ds_read_b128 v[160:163], v204 offset:12288
    v_exp_f32 v11, v11
    v_exp_f32 v12, v12
    v_mfma_f32_32x32x16_bf16 v[24:39], v[156:159], v[116:119], v[24:39]
    v_exp_f32 v13, v13
    v_exp_f32 v14, v14
    v_exp_f32 v15, v15
    v_smfmac_f32_32x32x32_bf16 v[240:255], v[176:179], v[56:63], v196
    v_exp_f32 v16, v16
    v_exp_f32 v17, v17
    v_exp_f32 v18, v18
    v_smfmac_f32_16x16x64_bf16 v[188:191], v[192:195], v[64:71], v196
    ds_read_b128 v[164:167], v204 offset:13312
    v_exp_f32 v19, v19
    v_exp_f32 v20, v20
    v_smfmac_f32_32x32x32_bf16 v[240:255], v[180:183], v[64:71], v196
    s_waitcnt lgkmcnt(1)
    v_exp_f32 v21, v21
    v_exp_f32 v22, v22
    v_exp_f32 v23, v23
    v_mfma_f32_32x32x16_bf16 v[40:55], v[160:163], v[104:107], v[120:135]
    s_waitcnt lgkmcnt(0)
    v_exp_f32 v24, v24
    v_exp_f32 v25, v25
    v_exp_f32 v26, v26
    v_smfmac_f32_16x16x64_bf16 v[184:187], v[192:195], v[8:15], v196
    ds_read_b128 v[176:179], v197 offset:14336
    v_exp_f32 v27, v27
    v_exp_f32 v28, v28
    v_mfma_f32_32x32x16_bf16 v[40:55], v[164:167], v[108:111], v[40:55]
    v_exp_f32 v29, v29
    v_exp_f32 v30, v30
    v_exp_f32 v31, v31
    v_smfmac_f32_32x32x32_bf16 v[224:239], v[168:171], v[8:15], v196
    v_exp_f32 v32, v32
    v_exp_f32 v33, v33
    v_exp_f32 v34, v34
    v_smfmac_f32_16x16x64_bf16 v[184:187], v[192:195], v[16:23], v196
    ds_read_b128 v[180:183], v197 offset:15360
    v_exp_f32 v35, v35
    v_exp_f32 v36, v36
    v_smfmac_f32_32x32x32_bf16 v[224:239], v[172:175], v[16:23], v196
    v_exp_f32 v37, v37
    v_exp_f32 v38, v38
    v_exp_f32 v39, v39
    s_waitcnt vmcnt(0) lgkmcnt(0)
    s_barrier
    v_mfma_f32_32x32x16_bf16 v[56:71], v[160:163], v[112:115], v[136:151]
    v_xor_b32 v197, 32768, v197
    v_xor_b32 v204, 32768, v204
    v_exp_f32 v40, v40
    v_exp_f32 v41, v41
    v_exp_f32 v42, v42
    v_smfmac_f32_16x16x64_bf16 v[188:191], v[192:195], v[24:31], v196
    ds_read_b128 v[152:155], v204 offset:0
    v_exp_f32 v43, v43
    v_exp_f32 v44, v44
    v_mfma_f32_32x32x16_bf16 v[56:71], v[164:167], v[116:119], v[56:71]
    v_exp_f32 v45, v45
    v_exp_f32 v46, v46
    v_exp_f32 v47, v47
    v_smfmac_f32_32x32x32_bf16 v[240:255], v[168:171], v[24:31], v196
    v_exp_f32 v48, v48
    v_exp_f32 v49, v49
    v_exp_f32 v50, v50
    v_smfmac_f32_16x16x64_bf16 v[188:191], v[192:195], v[32:39], v196
    ds_read_b128 v[156:159], v204 offset:1024
    v_exp_f32 v51, v51
    v_exp_f32 v52, v52
    v_smfmac_f32_32x32x32_bf16 v[240:255], v[172:175], v[32:39], v196
    s_waitcnt lgkmcnt(1)
    v_exp_f32 v53, v53
    v_exp_f32 v54, v54
    v_exp_f32 v55, v55
    v_mfma_f32_32x32x16_bf16 v[8:23], v[152:155], v[104:107], v[120:135]
    s_waitcnt lgkmcnt(0)
    v_exp_f32 v56, v56
    v_exp_f32 v57, v57
    v_exp_f32 v58, v58
    v_smfmac_f32_16x16x64_bf16 v[184:187], v[192:195], v[40:47], v196
    ds_read_b128 v[168:171], v197 offset:2048
    v_exp_f32 v59, v59
    v_exp_f32 v60, v60
    v_mfma_f32_32x32x16_bf16 v[8:23], v[156:159], v[108:111], v[8:23]
    v_exp_f32 v61, v61
    v_exp_f32 v62, v62
    v_exp_f32 v63, v63
    v_smfmac_f32_32x32x32_bf16 v[224:239], v[176:179], v[40:47], v196
    v_exp_f32 v64, v64
    v_exp_f32 v65, v65
    v_exp_f32 v66, v66
    v_smfmac_f32_16x16x64_bf16 v[184:187], v[192:195], v[48:55], v196
    ds_read_b128 v[172:175], v197 offset:3072
    v_exp_f32 v67, v67
    v_exp_f32 v68, v68
    v_smfmac_f32_32x32x32_bf16 v[224:239], v[180:183], v[48:55], v196
    s_sub_u32 s86, s86, 1
    s_cmp_lg_u32 s86, 0
    v_exp_f32 v69, v69
    v_exp_f32 v70, v70
    v_exp_f32 v71, v71
    s_cbranch_scc1 Lattn_loop_y
Lattn_j:
    v_mfma_f32_32x32x16_bf16 v[24:39], v[152:155], v[112:115], v[136:151]
    v_exp_f32 v8, v8
    v_exp_f32 v9, v9
    v_exp_f32 v10, v10
    v_smfmac_f32_16x16x64_bf16 v[188:191], v[192:195], v[56:63], v196
    ds_read_b128 v[160:163], v204 offset:4096
    v_exp_f32 v11, v11
    v_exp_f32 v12, v12
    v_mfma_f32_32x32x16_bf16 v[24:39], v[156:159], v[116:119], v[24:39]
    v_exp_f32 v13, v13
    v_exp_f32 v14, v14
    v_exp_f32 v15, v15
    v_smfmac_f32_32x32x32_bf16 v[240:255], v[176:179], v[56:63], v196
    v_exp_f32 v16, v16
    v_exp_f32 v17, v17
    v_exp_f32 v18, v18
    v_smfmac_f32_16x16x64_bf16 v[188:191], v[192:195], v[64:71], v196
    ds_read_b128 v[164:167], v204 offset:5120
    v_exp_f32 v19, v19
    v_exp_f32 v20, v20
    v_smfmac_f32_32x32x32_bf16 v[240:255], v[180:183], v[64:71], v196
    s_waitcnt lgkmcnt(1)
    v_exp_f32 v21, v21
    v_exp_f32 v22, v22
    v_exp_f32 v23, v23
    v_mfma_f32_32x32x16_bf16 v[40:55], v[160:163], v[104:107], v[120:135]
    s_waitcnt lgkmcnt(0)
    v_exp_f32 v24, v24
    v_exp_f32 v25, v25
    v_exp_f32 v26, v26
    v_smfmac_f32_16x16x64_bf16 v[184:187], v[192:195], v[8:15], v196
    ds_read_b128 v[176:179], v197 offset:6144
    v_exp_f32 v27, v27
    v_exp_f32 v28, v28
    v_mfma_f32_32x32x16_bf16 v[40:55], v[164:167], v[108:111], v[40:55]
    v_exp_f32 v29, v29
    v_exp_f32 v30, v30
    v_exp_f32 v31, v31
    v_smfmac_f32_32x32x32_bf16 v[224:239], v[168:171], v[8:15], v196
    v_exp_f32 v32, v32
    v_exp_f32 v33, v33
    v_exp_f32 v34, v34
    v_smfmac_f32_16x16x64_bf16 v[184:187], v[192:195], v[16:23], v196
    ds_read_b128 v[180:183], v197 offset:7168
    v_exp_f32 v35, v35
    v_exp_f32 v36, v36
    v_smfmac_f32_32x32x32_bf16 v[224:239], v[172:175], v[16:23], v196
    v_exp_f32 v37, v37
    v_exp_f32 v38, v38
    v_exp_f32 v39, v39
    v_mfma_f32_32x32x16_bf16 v[56:71], v[160:163], v[112:115], v[136:151]
    v_exp_f32 v40, v40
    v_exp_f32 v41, v41
    v_exp_f32 v42, v42
    v_smfmac_f32_16x16x64_bf16 v[188:191], v[192:195], v[24:31], v196
    ds_read_b128 v[152:155], v204 offset:8192
    v_exp_f32 v43, v43
    v_exp_f32 v44, v44
    v_mfma_f32_32x32x16_bf16 v[56:71], v[164:167], v[116:119], v[56:71]
    v_exp_f32 v45, v45
    v_exp_f32 v46, v46
    v_exp_f32 v47, v47
    v_smfmac_f32_32x32x32_bf16 v[240:255], v[168:171], v[24:31], v196
    v_exp_f32 v48, v48
    v_exp_f32 v49, v49
    v_exp_f32 v50, v50
    v_smfmac_f32_16x16x64_bf16 v[188:191], v[192:195], v[32:39], v196
    ds_read_b128 v[156:159], v204 offset:9216
    v_exp_f32 v51, v51
    v_exp_f32 v52, v52
    v_smfmac_f32_32x32x32_bf16 v[240:255], v[172:175], v[32:39], v196
    s_waitcnt lgkmcnt(1)
    v_exp_f32 v53, v53
    v_exp_f32 v54, v54
    v_exp_f32 v55, v55
    v_mfma_f32_32x32x16_bf16 v[8:23], v[152:155], v[104:107], v[120:135]
    s_waitcnt lgkmcnt(0)
    v_exp_f32 v56, v56
    v_exp_f32 v57, v57
    v_exp_f32 v58, v58
    v_smfmac_f32_16x16x64_bf16 v[184:187], v[192:195], v[40:47], v196
    ds_read_b128 v[168:171], v197 offset:10240
    v_exp_f32 v59, v59
    v_exp_f32 v60, v60
    v_mfma_f32_32x32x16_bf16 v[8:23], v[156:159], v[108:111], v[8:23]
    v_exp_f32 v61, v61
    v_exp_f32 v62, v62
    v_exp_f32 v63, v63
    v_smfmac_f32_32x32x32_bf16 v[224:239], v[176:179], v[40:47], v196
    v_exp_f32 v64, v64
    v_exp_f32 v65, v65
    v_exp_f32 v66, v66
    v_smfmac_f32_16x16x64_bf16 v[184:187], v[192:195], v[48:55], v196
    ds_read_b128 v[172:175], v197 offset:11264
    v_exp_f32 v67, v67
    v_exp_f32 v68, v68
    v_smfmac_f32_32x32x32_bf16 v[224:239], v[180:183], v[48:55], v196
    v_exp_f32 v69, v69
    v_exp_f32 v70, v70
    v_exp_f32 v71, v71
    v_mfma_f32_32x32x16_bf16 v[24:39], v[152:155], v[112:115], v[136:151]
    v_exp_f32 v8, v8
    v_exp_f32 v9, v9
    v_exp_f32 v10, v10
    v_smfmac_f32_16x16x64_bf16 v[188:191], v[192:195], v[56:63], v196
    ds_read_b128 v[160:163], v204 offset:12288
    v_exp_f32 v11, v11
    v_exp_f32 v12, v12
    v_mfma_f32_32x32x16_bf16 v[24:39], v[156:159], v[116:119], v[24:39]
    v_exp_f32 v13, v13
    v_exp_f32 v14, v14
    v_exp_f32 v15, v15
    v_smfmac_f32_32x32x32_bf16 v[240:255], v[176:179], v[56:63], v196
    v_exp_f32 v16, v16
    v_exp_f32 v17, v17
    v_exp_f32 v18, v18
    v_smfmac_f32_16x16x64_bf16 v[188:191], v[192:195], v[64:71], v196
    ds_read_b128 v[164:167], v204 offset:13312
    v_exp_f32 v19, v19
    v_exp_f32 v20, v20
    v_smfmac_f32_32x32x32_bf16 v[240:255], v[180:183], v[64:71], v196
    s_waitcnt lgkmcnt(1)
    v_exp_f32 v21, v21
    v_exp_f32 v22, v22
    v_exp_f32 v23, v23
    v_mfma_f32_32x32x16_bf16 v[40:55], v[160:163], v[104:107], v[120:135]
    s_waitcnt lgkmcnt(0)
    v_exp_f32 v24, v24
    v_exp_f32 v25, v25
    v_exp_f32 v26, v26
    v_smfmac_f32_16x16x64_bf16 v[184:187], v[192:195], v[8:15], v196
    ds_read_b128 v[176:179], v197 offset:14336
    v_exp_f32 v27, v27
    v_exp_f32 v28, v28
    v_mfma_f32_32x32x16_bf16 v[40:55], v[164:167], v[108:111], v[40:55]
    v_exp_f32 v29, v29
    v_exp_f32 v30, v30
    v_exp_f32 v31, v31
    v_smfmac_f32_32x32x32_bf16 v[224:239], v[168:171], v[8:15], v196
    v_exp_f32 v32, v32
    v_exp_f32 v33, v33
    v_exp_f32 v34, v34
    v_smfmac_f32_16x16x64_bf16 v[184:187], v[192:195], v[16:23], v196
    ds_read_b128 v[180:183], v197 offset:15360
    v_exp_f32 v35, v35
    v_exp_f32 v36, v36
    v_smfmac_f32_32x32x32_bf16 v[224:239], v[172:175], v[16:23], v196
    v_exp_f32 v37, v37
    v_exp_f32 v38, v38
    v_exp_f32 v39, v39
    s_waitcnt vmcnt(0) lgkmcnt(0)
    s_barrier
    v_mfma_f32_32x32x16_bf16 v[56:71], v[160:163], v[112:115], v[136:151]
    v_xor_b32 v197, 32768, v197
    v_xor_b32 v204, 32768, v204
    v_exp_f32 v40, v40
    v_exp_f32 v41, v41
    v_exp_f32 v42, v42
    v_smfmac_f32_16x16x64_bf16 v[188:191], v[192:195], v[24:31], v196
    ds_read_b128 v[152:155], v204 offset:0
    v_exp_f32 v43, v43
    v_exp_f32 v44, v44
    v_mfma_f32_32x32x16_bf16 v[56:71], v[164:167], v[116:119], v[56:71]
    s_cbranch_vccz Lskip75
    s_lshl_b32 s89, s16, 10
    s_add_u32 s89, s89, 32768
    s_add_u32 s20, s20, 1
    s_add_u32 s26, s20, s19
    s_and_b32 s26, s26, 7
    s_xor_b32 s27, s20, s19
    s_and_b32 s27, s27, 8
    s_or_b32 s26, s26, s27
    s_lshl_b32 s26, s26, 1
    s_lshr_b32 s27, s20, 4
    s_add_u32 s26, s26, s27
    s_lshl_b32 s26, s26, 16
    s_mov_b32 m0, s89
    s_add_u32 s88, s26, s21
    s_add_u32 s89, s89, 4096
    buffer_load_dwordx4 v199, s[52:55], s88 offen lds
    s_add_u32 s20, s20, 1
    s_add_u32 s26, s20, s19
    s_and_b32 s26, s26, 7
    s_xor_b32 s27, s20, s19
    s_and_b32 s27, s27, 8
    s_or_b32 s26, s26, s27
    s_lshl_b32 s26, s26, 1
    s_lshr_b32 s27, s20, 4
    s_add_u32 s26, s26, s27
    s_lshl_b32 s26, s26, 16
    s_mov_b32 m0, s89
    s_add_u32 s88, s26, s21
    s_add_u32 s89, s89, 4096
    buffer_load_dwordx4 v199, s[52:55], s88 offen lds
    s_add_u32 s20, s20, 1
    s_add_u32 s26, s20, s19
    s_and_b32 s26, s26, 7
    s_xor_b32 s27, s20, s19
    s_and_b32 s27, s27, 8
    s_or_b32 s26, s26, s27
    s_lshl_b32 s26, s26, 1
    s_lshr_b32 s27, s20, 4
    s_add_u32 s26, s26, s27
    s_lshl_b32 s26, s26, 16
    s_mov_b32 m0, s89
    s_add_u32 s88, s26, s21
    s_add_u32 s89, s89, 4096
    buffer_load_dwordx4 v199, s[52:55], s88 offen lds
Lskip75:
    v_exp_f32 v45, v45
    v_exp_f32 v46, v46
    v_exp_f32 v47, v47
    v_smfmac_f32_32x32x32_bf16 v[240:255], v[168:171], v[24:31], v196
    v_exp_f32 v48, v48
    v_exp_f32 v49, v49
    v_exp_f32 v50, v50
    v_smfmac_f32_16x16x64_bf16 v[188:191], v[192:195], v[32:39], v196
    ds_read_b128 v[156:159], v204 offset:1024
    v_exp_f32 v51, v51
    v_exp_f32 v52, v52
    v_smfmac_f32_32x32x32_bf16 v[240:255], v[172:175], v[32:39], v196
    s_cbranch_vccz Lskip76
    s_add_u32 s20, s20, 1
    s_add_u32 s26, s20, s19
    s_and_b32 s26, s26, 7
    s_xor_b32 s27, s20, s19
    s_and_b32 s27, s27, 8
    s_or_b32 s26, s26, s27
    s_lshl_b32 s26, s26, 1
    s_lshr_b32 s27, s20, 4
    s_add_u32 s26, s26, s27
    s_lshl_b32 s26, s26, 16
    s_mov_b32 m0, s89
    s_add_u32 s88, s26, s21
    s_add_u32 s89, s89, 4096
    buffer_load_dwordx4 v199, s[52:55], s88 offen lds
    s_add_u32 s20, s20, 1
    s_add_u32 s26, s20, s19
    s_and_b32 s26, s26, 7
    s_xor_b32 s27, s20, s19
    s_and_b32 s27, s27, 8
    s_or_b32 s26, s26, s27
    s_lshl_b32 s26, s26, 1
    s_lshr_b32 s27, s20, 4
    s_add_u32 s26, s26, s27
    s_lshl_b32 s26, s26, 16
    s_mov_b32 m0, s89
    s_add_u32 s88, s26, s21
    s_add_u32 s89, s89, 4096
    buffer_load_dwordx4 v199, s[52:55], s88 offen lds
    s_add_u32 s20, s20, 1
    s_add_u32 s26, s20, s19
    s_and_b32 s26, s26, 7
    s_xor_b32 s27, s20, s19
    s_and_b32 s27, s27, 8
    s_or_b32 s26, s26, s27
    s_lshl_b32 s26, s26, 1
    s_lshr_b32 s27, s20, 4
    s_add_u32 s26, s26, s27
    s_lshl_b32 s26, s26, 16
    s_mov_b32 m0, s89
    s_add_u32 s88, s26, s21
    s_add_u32 s89, s89, 4096
    buffer_load_dwordx4 v199, s[52:55], s88 offen lds
Lskip76:
    s_waitcnt lgkmcnt(1)
    v_exp_f32 v53, v53
    v_exp_f32 v54, v54
    v_exp_f32 v55, v55
    v_mfma_f32_32x32x16_bf16 v[8:23], v[152:155], v[104:107], v[120:135]
    s_waitcnt lgkmcnt(0)
    v_exp_f32 v56, v56
    v_exp_f32 v57, v57
    v_exp_f32 v58, v58
    v_smfmac_f32_16x16x64_bf16 v[184:187], v[192:195], v[40:47], v196
    ds_read_b128 v[168:171], v197 offset:2048
    v_exp_f32 v59, v59
    v_exp_f32 v60, v60
    v_mfma_f32_32x32x16_bf16 v[8:23], v[156:159], v[108:111], v[8:23]
    s_cbranch_vccz Lskip77
    s_add_u32 s20, s20, 1
    s_add_u32 s26, s20, s19
    s_and_b32 s26, s26, 7
    s_xor_b32 s27, s20, s19
    s_and_b32 s27, s27, 8
    s_or_b32 s26, s26, s27
    s_lshl_b32 s26, s26, 1
    s_lshr_b32 s27, s20, 4
    s_add_u32 s26, s26, s27
    s_lshl_b32 s26, s26, 16
    s_mov_b32 m0, s89
    s_add_u32 s88, s26, s21
    s_add_u32 s89, s89, 4096
    buffer_load_dwordx4 v199, s[52:55], s88 offen lds
    s_add_u32 s20, s20, 1
    s_add_u32 s26, s20, s19
    s_and_b32 s26, s26, 7
    s_xor_b32 s27, s20, s19
    s_and_b32 s27, s27, 8
    s_or_b32 s26, s26, s27
    s_lshl_b32 s26, s26, 1
    s_lshr_b32 s27, s20, 4
    s_add_u32 s26, s26, s27
    s_lshl_b32 s26, s26, 16
    s_mov_b32 m0, s89
    s_add_u32 s88, s26, s21
    s_add_u32 s89, s89, 4096
    buffer_load_dwordx4 v199, s[52:55], s88 offen lds
Lskip77:
    v_exp_f32 v61, v61
    v_exp_f32 v62, v62
    v_exp_f32 v63, v63
    v_smfmac_f32_32x32x32_bf16 v[224:239], v[176:179], v[40:47], v196
    v_exp_f32 v64, v64
    v_exp_f32 v65, v65
    v_exp_f32 v66, v66
    v_smfmac_f32_16x16x64_bf16 v[184:187], v[192:195], v[48:55], v196
    ds_read_b128 v[172:175], v197 offset:3072
    v_exp_f32 v67, v67
    v_exp_f32 v68, v68
    v_smfmac_f32_32x32x32_bf16 v[224:239], v[180:183], v[48:55], v196
    v_exp_f32 v69, v69
    v_exp_f32 v70, v70
    v_exp_f32 v71, v71
    v_mfma_f32_32x32x16_bf16 v[24:39], v[152:155], v[112:115], v[136:151]
    v_exp_f32 v8, v8
    v_exp_f32 v9, v9
    v_exp_f32 v10, v10
    v_smfmac_f32_16x16x64_bf16 v[188:191], v[192:195], v[56:63], v196
    ds_read_b128 v[160:163], v204 offset:4096
    v_exp_f32 v11, v11
    v_exp_f32 v12, v12
    v_mfma_f32_32x32x16_bf16 v[24:39], v[156:159], v[116:119], v[24:39]
    s_cbranch_vccz Lskip78
    s_lshl_b32 s28, s16, 1
    s_add_u32 s28, s28, s19
    v_lshrrev_b32 v2, 5, v1
    v_add_u32 v2, s28, v2
    v_and_b32 v2, 7, v2
    s_and_b32 s28, s19, 8
    s_xor_b32 s28, s28, 8
    v_or_b32 v2, s28, v2
    v_lshlrev_b32 v2, 17, v2
    v_and_b32 v3, 31, v1
    v_lshl_add_u32 v2, v3, 11, v2
    s_mov_b32 s28, 65536
    buffer_load_dword v3, v2, s[52:55], s28 offen
Lskip78:
    v_exp_f32 v13, v13
    v_exp_f32 v14, v14
    v_exp_f32 v15, v15
    v_smfmac_f32_32x32x32_bf16 v[240:255], v[176:179], v[56:63], v196
    v_exp_f32 v16, v16
    v_exp_f32 v17, v17
    v_exp_f32 v18, v18
    v_smfmac_f32_16x16x64_bf16 v[188:191], v[192:195], v[64:71], v196
    ds_read_b128 v[164:167], v204 offset:5120
    v_exp_f32 v19, v19
    v_exp_f32 v20, v20
    v_smfmac_f32_32x32x32_bf16 v[240:255], v[180:183], v[64:71], v196
    s_waitcnt lgkmcnt(1)
    v_exp_f32 v21, v21
    v_exp_f32 v22, v22
    v_exp_f32 v23, v23
    v_mfma_f32_32x32x16_bf16 v[40:55], v[160:163], v[104:107], v[120:135]
    s_waitcnt lgkmcnt(0)
    v_exp_f32 v24, v24
    v_exp_f32 v25, v25
    v_exp_f32 v26, v26
    v_smfmac_f32_16x16x64_bf16 v[184:187], v[192:195], v[8:15], v196
    ds_read_b128 v[176:179], v197 offset:6144
    v_exp_f32 v27, v27
    v_exp_f32 v28, v28
    v_mfma_f32_32x32x16_bf16 v[40:55], v[164:167], v[108:111], v[40:55]
    v_exp_f32 v29, v29
    v_exp_f32 v30, v30
    v_exp_f32 v31, v31
    v_smfmac_f32_32x32x32_bf16 v[224:239], v[168:171], v[8:15], v196
    v_exp_f32 v32, v32
    v_exp_f32 v33, v33
    v_exp_f32 v34, v34
    v_smfmac_f32_16x16x64_bf16 v[184:187], v[192:195], v[16:23], v196
    ds_read_b128 v[180:183], v197 offset:7168
    v_exp_f32 v35, v35
    v_exp_f32 v36, v36
    v_smfmac_f32_32x32x32_bf16 v[224:239], v[172:175], v[16:23], v196
    v_exp_f32 v37, v37
    v_exp_f32 v38, v38
    v_exp_f32 v39, v39
    v_mfma_f32_32x32x16_bf16 v[56:71], v[160:163], v[112:115], v[136:151]
    v_exp_f32 v40, v40
    v_exp_f32 v41, v41
    v_exp_f32 v42, v42
    v_smfmac_f32_16x16x64_bf16 v[188:191], v[192:195], v[24:31], v196
    ds_read_b128 v[152:155], v204 offset:8192
    v_exp_f32 v43, v43
    v_exp_f32 v44, v44
    v_mfma_f32_32x32x16_bf16 v[56:71], v[164:167], v[116:119], v[56:71]
    v_exp_f32 v45, v45
    v_exp_f32 v46, v46
    v_exp_f32 v47, v47
    v_smfmac_f32_32x32x32_bf16 v[240:255], v[168:171], v[24:31], v196
    v_exp_f32 v48, v48
    v_exp_f32 v49, v49
    v_exp_f32 v50, v50
    v_smfmac_f32_16x16x64_bf16 v[188:191], v[192:195], v[32:39], v196
    ds_read_b128 v[156:159], v204 offset:9216
    v_exp_f32 v51, v51
    v_exp_f32 v52, v52
    v_smfmac_f32_32x32x32_bf16 v[240:255], v[172:175], v[32:39], v196
    s_waitcnt lgkmcnt(1)
    v_exp_f32 v53, v53
    v_exp_f32 v54, v54
    v_exp_f32 v55, v55
    v_mfma_f32_32x32x16_bf16 v[8:23], v[152:155], v[104:107], v[120:135]
    s_waitcnt lgkmcnt(0)
    v_exp_f32 v56, v56
    v_exp_f32 v57, v57
    v_exp_f32 v58, v58
    v_smfmac_f32_16x16x64_bf16 v[184:187], v[192:195], v[40:47], v196
    ds_read_b128 v[168:171], v197 offset:10240
    v_exp_f32 v59, v59
    v_exp_f32 v60, v60
    v_mfma_f32_32x32x16_bf16 v[8:23], v[156:159], v[108:111], v[8:23]
    v_exp_f32 v61, v61
    v_exp_f32 v62, v62
    v_exp_f32 v63, v63
    v_smfmac_f32_32x32x32_bf16 v[224:239], v[176:179], v[40:47], v196
    v_exp_f32 v64, v64
    v_exp_f32 v65, v65
    v_exp_f32 v66, v66
    v_smfmac_f32_16x16x64_bf16 v[184:187], v[192:195], v[48:55], v196
    ds_read_b128 v[172:175], v197 offset:11264
    v_exp_f32 v67, v67
    v_exp_f32 v68, v68
    v_smfmac_f32_32x32x32_bf16 v[224:239], v[180:183], v[48:55], v196
    v_exp_f32 v69, v69
    v_exp_f32 v70, v70
    v_exp_f32 v71, v71
    v_mfma_f32_32x32x16_bf16 v[24:39], v[152:155], v[112:115], v[136:151]
    v_exp_f32 v8, v8
    v_exp_f32 v9, v9
    v_exp_f32 v10, v10
    v_smfmac_f32_16x16x64_bf16 v[188:191], v[192:195], v[56:63], v196
    ds_read_b128 v[160:163], v204 offset:12288
    v_exp_f32 v11, v11
    v_exp_f32 v12, v12
    v_mfma_f32_32x32x16_bf16 v[24:39], v[156:159], v[116:119], v[24:39]
    v_exp_f32 v13, v13
    v_exp_f32 v14, v14
    v_exp_f32 v15, v15
    v_smfmac_f32_32x32x32_bf16 v[240:255], v[176:179], v[56:63], v196
    v_exp_f32 v16, v16
    v_exp_f32 v17, v17
    v_exp_f32 v18, v18
    v_smfmac_f32_16x16x64_bf16 v[188:191], v[192:195], v[64:71], v196
    ds_read_b128 v[164:167], v204 offset:13312
    v_exp_f32 v19, v19
    v_exp_f32 v20, v20
    v_smfmac_f32_32x32x32_bf16 v[240:255], v[180:183], v[64:71], v196
    s_waitcnt lgkmcnt(1)
    v_exp_f32 v21, v21
    v_exp_f32 v22, v22
    v_exp_f32 v23, v23
    v_mfma_f32_32x32x16_bf16 v[40:55], v[160:163], v[104:107], v[120:135]
    s_waitcnt lgkmcnt(0)
    v_exp_f32 v24, v24
    v_exp_f32 v25, v25
    v_exp_f32 v26, v26
    v_smfmac_f32_16x16x64_bf16 v[184:187], v[192:195], v[8:15], v196
    ds_read_b128 v[176:179], v197 offset:14336
    v_exp_f32 v27, v27
    v_exp_f32 v28, v28
    v_mfma_f32_32x32x16_bf16 v[40:55], v[164:167], v[108:111], v[40:55]
    v_exp_f32 v29, v29
    v_exp_f32 v30, v30
    v_exp_f32 v31, v31
    v_smfmac_f32_32x32x32_bf16 v[224:239], v[168:171], v[8:15], v196
    v_exp_f32 v32, v32
    v_exp_f32 v33, v33
    v_exp_f32 v34, v34
    v_smfmac_f32_16x16x64_bf16 v[184:187], v[192:195], v[16:23], v196
    ds_read_b128 v[180:183], v197 offset:15360
    v_exp_f32 v35, v35
    v_exp_f32 v36, v36
    v_smfmac_f32_32x32x32_bf16 v[224:239], v[172:175], v[16:23], v196
    v_exp_f32 v37, v37
    v_exp_f32 v38, v38
    v_exp_f32 v39, v39
    v_mfma_f32_32x32x16_bf16 v[56:71], v[160:163], v[112:115], v[136:151]
    v_add_u32 v197, 131072, v197
    v_add_u32 v204, 131072, v204
    v_exp_f32 v40, v40
    v_exp_f32 v41, v41
    v_exp_f32 v42, v42
    v_smfmac_f32_16x16x64_bf16 v[188:191], v[192:195], v[24:31], v196
    ds_read_b128 v[152:155], v204 offset:0
    v_exp_f32 v43, v43
    v_exp_f32 v44, v44
    v_mfma_f32_32x32x16_bf16 v[56:71], v[164:167], v[116:119], v[56:71]
    v_exp_f32 v45, v45
    v_exp_f32 v46, v46
    v_exp_f32 v47, v47
    v_smfmac_f32_32x32x32_bf16 v[240:255], v[168:171], v[24:31], v196
    v_exp_f32 v48, v48
    v_exp_f32 v49, v49
    v_exp_f32 v50, v50
    v_smfmac_f32_16x16x64_bf16 v[188:191], v[192:195], v[32:39], v196
    ds_read_b128 v[156:159], v204 offset:1024
    v_exp_f32 v51, v51
    v_exp_f32 v52, v52
    v_smfmac_f32_32x32x32_bf16 v[240:255], v[172:175], v[32:39], v196
    s_waitcnt lgkmcnt(1)
    v_exp_f32 v53, v53
    v_exp_f32 v54, v54
    v_exp_f32 v55, v55
    v_mfma_f32_32x32x16_bf16 v[8:23], v[152:155], v[104:107], v[120:135]
    s_waitcnt lgkmcnt(0)
    v_exp_f32 v56, v56
    v_exp_f32 v57, v57
    v_exp_f32 v58, v58
    v_smfmac_f32_16x16x64_bf16 v[184:187], v[192:195], v[40:47], v196
    ds_read_b128 v[168:171], v197 offset:2048
    v_exp_f32 v59, v59
    v_exp_f32 v60, v60
    v_mfma_f32_32x32x16_bf16 v[8:23], v[156:159], v[108:111], v[8:23]
    v_exp_f32 v61, v61
    v_exp_f32 v62, v62
    v_exp_f32 v63, v63
    v_smfmac_f32_32x32x32_bf16 v[224:239], v[176:179], v[40:47], v196
    v_exp_f32 v64, v64
    v_exp_f32 v65, v65
    v_exp_f32 v66, v66
    v_smfmac_f32_16x16x64_bf16 v[184:187], v[192:195], v[48:55], v196
    ds_read_b128 v[172:175], v197 offset:3072
    v_exp_f32 v67, v67
    v_exp_f32 v68, v68
    v_smfmac_f32_32x32x32_bf16 v[224:239], v[180:183], v[48:55], v196
    v_exp_f32 v69, v69
    v_exp_f32 v70, v70
    v_exp_f32 v71, v71
    v_mfma_f32_32x32x16_bf16 v[24:39], v[152:155], v[112:115], v[136:151]
    v_exp_f32 v8, v8
    v_exp_f32 v9, v9
    v_exp_f32 v10, v10
    v_smfmac_f32_16x16x64_bf16 v[188:191], v[192:195], v[56:63], v196
    ds_read_b128 v[160:163], v204 offset:4096
    v_exp_f32 v11, v11
    v_exp_f32 v12, v12
    v_mfma_f32_32x32x16_bf16 v[24:39], v[156:159], v[116:119], v[24:39]
    v_exp_f32 v13, v13
    v_exp_f32 v14, v14
    v_exp_f32 v15, v15
    v_smfmac_f32_32x32x32_bf16 v[240:255], v[176:179], v[56:63], v196
    v_exp_f32 v16, v16
    v_exp_f32 v17, v17
    v_exp_f32 v18, v18
    v_smfmac_f32_16x16x64_bf16 v[188:191], v[192:195], v[64:71], v196
    ds_read_b128 v[164:167], v204 offset:5120
    v_exp_f32 v19, v19
    v_exp_f32 v20, v20
    v_smfmac_f32_32x32x32_bf16 v[240:255], v[180:183], v[64:71], v196
    s_waitcnt lgkmcnt(1)
    v_exp_f32 v21, v21
    v_exp_f32 v22, v22
    v_exp_f32 v23, v23
    v_mfma_f32_32x32x16_bf16 v[40:55], v[160:163], v[104:107], v[120:135]
    s_waitcnt lgkmcnt(0)
    v_exp_f32 v24, v24
    v_exp_f32 v25, v25
    v_exp_f32 v26, v26
    v_smfmac_f32_16x16x64_bf16 v[184:187], v[192:195], v[8:15], v196
    ds_read_b128 v[176:179], v197 offset:6144
    v_exp_f32 v27, v27
    v_exp_f32 v28, v28
    v_mfma_f32_32x32x16_bf16 v[40:55], v[164:167], v[108:111], v[40:55]
    v_exp_f32 v29, v29
    v_exp_f32 v30, v30
    v_exp_f32 v31, v31
    v_smfmac_f32_32x32x32_bf16 v[224:239], v[168:171], v[8:15], v196
    v_exp_f32 v32, v32
    v_exp_f32 v33, v33
    v_exp_f32 v34, v34
    v_smfmac_f32_16x16x64_bf16 v[184:187], v[192:195], v[16:23], v196
    ds_read_b128 v[180:183], v197 offset:7168
    v_exp_f32 v35, v35
    v_exp_f32 v36, v36
    v_smfmac_f32_32x32x32_bf16 v[224:239], v[172:175], v[16:23], v196
    v_exp_f32 v37, v37
    v_exp_f32 v38, v38
    v_exp_f32 v39, v39
    s_cbranch_vccnz Lskip79
    s_barrier
Lskip79:
    v_mfma_f32_32x32x16_bf16 v[56:71], v[160:163], v[112:115], v[136:151]
    v_exp_f32 v40, v40
    v_exp_f32 v41, v41
    v_exp_f32 v42, v42
    v_smfmac_f32_16x16x64_bf16 v[188:191], v[192:195], v[24:31], v196
    ds_read_b128 v[152:155], v204 offset:8192
    v_exp_f32 v43, v43
    v_exp_f32 v44, v44
    v_mfma_f32_32x32x16_bf16 v[56:71], v[164:167], v[116:119], v[56:71]
    v_exp_f32 v45, v45
    v_exp_f32 v46, v46
    v_exp_f32 v47, v47
    v_smfmac_f32_32x32x32_bf16 v[240:255], v[168:171], v[24:31], v196
    v_exp_f32 v48, v48
    v_exp_f32 v49, v49
    v_exp_f32 v50, v50
    v_smfmac_f32_16x16x64_bf16 v[188:191], v[192:195], v[32:39], v196
    ds_read_b128 v[156:159], v204 offset:9216
    v_exp_f32 v51, v51
    v_exp_f32 v52, v52
    v_smfmac_f32_32x32x32_bf16 v[240:255], v[172:175], v[32:39], v196
    s_waitcnt lgkmcnt(1)
    v_exp_f32 v53, v53
    v_exp_f32 v54, v54
    v_exp_f32 v55, v55
    v_mfma_f32_32x32x16_bf16 v[8:23], v[152:155], v[104:107], v[120:135]
    s_waitcnt lgkmcnt(0)
    v_exp_f32 v56, v56
    v_exp_f32 v57, v57
    v_exp_f32 v58, v58
    v_smfmac_f32_16x16x64_bf16 v[184:187], v[192:195], v[40:47], v196
    ds_read_b128 v[168:171], v197 offset:10240
    v_exp_f32 v59, v59
    v_exp_f32 v60, v60
    v_mfma_f32_32x32x16_bf16 v[8:23], v[156:159], v[108:111], v[8:23]
    v_exp_f32 v61, v61
    v_exp_f32 v62, v62
    v_exp_f32 v63, v63
    v_smfmac_f32_32x32x32_bf16 v[224:239], v[176:179], v[40:47], v196
    v_exp_f32 v64, v64
    v_exp_f32 v65, v65
    v_exp_f32 v66, v66
    v_smfmac_f32_16x16x64_bf16 v[184:187], v[192:195], v[48:55], v196
    ds_read_b128 v[172:175], v197 offset:11264
    v_exp_f32 v67, v67
    v_exp_f32 v68, v68
    v_smfmac_f32_32x32x32_bf16 v[224:239], v[180:183], v[48:55], v196
    v_exp_f32 v69, v69
    v_exp_f32 v70, v70
    v_exp_f32 v71, v71
    v_mfma_f32_32x32x16_bf16 v[24:39], v[152:155], v[112:115], v[136:151]
    v_exp_f32 v8, v8
    v_exp_f32 v9, v9
    v_exp_f32 v10, v10
    v_smfmac_f32_16x16x64_bf16 v[188:191], v[192:195], v[56:63], v196
    ds_read_b128 v[160:163], v204 offset:12288
    v_exp_f32 v11, v11
    v_exp_f32 v12, v12
    v_mfma_f32_32x32x16_bf16 v[24:39], v[156:159], v[116:119], v[24:39]
    s_cbranch_vccnz Lskip80
    s_mov_b32 s24, s40
    buffer_load_dwordx2 v[200:201], v202, s[76:79], s24 offen sc1
Lskip80:
    v_exp_f32 v13, v13
    v_exp_f32 v14, v14
    v_exp_f32 v15, v15
    v_smfmac_f32_32x32x32_bf16 v[240:255], v[176:179], v[56:63], v196
    v_exp_f32 v16, v16
    v_exp_f32 v17, v17
    v_exp_f32 v18, v18
    v_smfmac_f32_16x16x64_bf16 v[188:191], v[192:195], v[64:71], v196
    ds_read_b128 v[164:167], v204 offset:13312
    v_exp_f32 v19, v19
    v_exp_f32 v20, v20
    v_smfmac_f32_32x32x32_bf16 v[240:255], v[180:183], v[64:71], v196
    s_waitcnt lgkmcnt(1)
    v_exp_f32 v21, v21
    v_exp_f32 v22, v22
    v_exp_f32 v23, v23
    v_mfma_f32_32x32x16_bf16 v[40:55], v[160:163], v[104:107], v[120:135]
    s_waitcnt lgkmcnt(0)
    v_exp_f32 v24, v24
    v_exp_f32 v25, v25
    v_exp_f32 v26, v26
    v_smfmac_f32_16x16x64_bf16 v[184:187], v[192:195], v[8:15], v196
    ds_read_b128 v[176:179], v197 offset:14336
    v_exp_f32 v27, v27
    v_exp_f32 v28, v28
    v_mfma_f32_32x32x16_bf16 v[40:55], v[164:167], v[108:111], v[40:55]
    v_exp_f32 v29, v29
    v_exp_f32 v30, v30
    v_exp_f32 v31, v31
    v_smfmac_f32_32x32x32_bf16 v[224:239], v[168:171], v[8:15], v196
    v_exp_f32 v32, v32
    v_exp_f32 v33, v33
    v_exp_f32 v34, v34
    v_smfmac_f32_16x16x64_bf16 v[184:187], v[192:195], v[16:23], v196
    ds_read_b128 v[180:183], v197 offset:15360
    v_exp_f32 v35, v35
    v_exp_f32 v36, v36
    v_smfmac_f32_32x32x32_bf16 v[224:239], v[172:175], v[16:23], v196
    v_exp_f32 v37, v37
    v_exp_f32 v38, v38
    v_exp_f32 v39, v39
    v_mfma_f32_32x32x16_bf16 v[56:71], v[160:163], v[112:115], v[136:151]
    v_exp_f32 v40, v40
    v_exp_f32 v41, v41
    v_exp_f32 v42, v42
    v_smfmac_f32_16x16x64_bf16 v[188:191], v[192:195], v[24:31], v196
    ds_read_b128 v[152:155], v204 offset:0
    v_exp_f32 v43, v43
    v_exp_f32 v44, v44
    v_mfma_f32_32x32x16_bf16 v[56:71], v[164:167], v[116:119], v[56:71]
    s_cbranch_vccnz Lskip81
    s_waitcnt vmcnt(0)
    v_cmp_eq_u64 s[82:83], s[80:81], v[200:201]
    s_nop 0
    s_cmp_lg_u32 s82, -1
    s_cbranch_scc1 Lnoearly
    s_mov_b32 s41, 1
    buffer_load_dwordx4 v[72:75], v216, s[32:35], s64 offen offset:0 sc1
    buffer_load_dwordx4 v[76:79], v217, s[32:35], s64 offen offset:0 sc1
    buffer_load_dwordx4 v[80:83], v216, s[32:35], s65 offen offset:0 sc1
    buffer_load_dwordx4 v[84:87], v217, s[32:35], s65 offen offset:0 sc1
    buffer_load_dwordx4 v[88:91], v216, s[32:35], s66 offen offset:0 sc1
    buffer_load_dwordx4 v[92:95], v217, s[32:35], s66 offen offset:0 sc1
    buffer_load_dwordx4 v[96:99], v216, s[32:35], s67 offen offset:0 sc1
    buffer_load_dwordx4 v[100:103], v217, s[32:35], s67 offen offset:0 sc1
Lnoearly:
Lskip81:
    v_exp_f32 v45, v45
    v_exp_f32 v46, v46
    v_exp_f32 v47, v47
    v_smfmac_f32_32x32x32_bf16 v[240:255], v[168:171], v[24:31], v196
    v_exp_f32 v48, v48
    v_exp_f32 v49, v49
    v_exp_f32 v50, v50
    v_smfmac_f32_16x16x64_bf16 v[188:191], v[192:195], v[32:39], v196
    ds_read_b128 v[156:159], v204 offset:1024
    v_exp_f32 v51, v51
    v_exp_f32 v52, v52
    v_smfmac_f32_32x32x32_bf16 v[240:255], v[172:175], v[32:39], v196
    s_waitcnt lgkmcnt(1)
    v_exp_f32 v53, v53
    v_exp_f32 v54, v54
    v_exp_f32 v55, v55
    v_mfma_f32_32x32x16_bf16 v[8:23], v[152:155], v[104:107], v[120:135]
    s_waitcnt lgkmcnt(0)
    v_exp_f32 v56, v56
    v_exp_f32 v57, v57
    v_exp_f32 v58, v58
    v_smfmac_f32_16x16x64_bf16 v[184:187], v[192:195], v[40:47], v196
    ds_read_b128 v[168:171], v197 offset:2048
    v_exp_f32 v59, v59
    v_exp_f32 v60, v60
    v_mfma_f32_32x32x16_bf16 v[8:23], v[156:159], v[108:111], v[8:23]
    v_exp_f32 v61, v61
    v_exp_f32 v62, v62
    v_exp_f32 v63, v63
    v_smfmac_f32_32x32x32_bf16 v[224:239], v[176:179], v[40:47], v196
    v_exp_f32 v64, v64
    v_exp_f32 v65, v65
    v_exp_f32 v66, v66
    v_smfmac_f32_16x16x64_bf16 v[184:187], v[192:195], v[48:55], v196
    ds_read_b128 v[172:175], v197 offset:3072
    v_exp_f32 v67, v67
    v_exp_f32 v68, v68
    v_smfmac_f32_32x32x32_bf16 v[224:239], v[180:183], v[48:55], v196
    v_exp_f32 v69, v69
    v_exp_f32 v70, v70
    v_exp_f32 v71, v71
    s_nop 1
    v_smfmac_f32_32x32x32_bf16 v[240:255], v[176:179], v[56:63], v196
    v_smfmac_f32_16x16x64_bf16 v[188:191], v[192:195], v[56:63], v196
    v_smfmac_f32_32x32x32_bf16 v[240:255], v[180:183], v[64:71], v196
    v_smfmac_f32_16x16x64_bf16 v[188:191], v[192:195], v[64:71], v196
    s_mov_b32 s26, 0x5d800000
    s_mov_b32 s27, 65536
    s_nop 5
    v_cmp_nge_f32 vcc, s26, v184
    v_cmp_nge_f32 s[28:29], s26, v188
    s_nop 0
    s_or_b64 vcc, vcc, s[28:29]
    s_cbranch_vccnz Lattn_fallback
Lattn_fin:
    v_rcp_f32 v2, v184
    v_rcp_f32 v4, v188
    v_mul_f32 v224, v2, v224
    v_mul_f32 v225, v2, v225
    v_mul_f32 v226, v2, v226
    v_mul_f32 v227, v2, v227
    v_mul_f32 v228, v2, v228
    v_mul_f32 v229, v2, v229
    v_mul_f32 v230, v2, v230
    v_mul_f32 v231, v2, v231
    v_cvt_pk_bf16_f32 v8, v224, v225
    v_cvt_pk_bf16_f32 v9, v226, v227
    v_cvt_pk_bf16_f32 v10, v228, v229
    v_cvt_pk_bf16_f32 v11, v230, v231
    buffer_store_dwordx4 v[8:11], v6, s[12:15], 0 offen offset:0 sc1
    v_mul_f32 v232, v2, v232
    v_mul_f32 v233, v2, v233
    v_mul_f32 v234, v2, v234
    v_mul_f32 v235, v2, v235
    v_mul_f32 v236, v2, v236
    v_mul_f32 v237, v2, v237
    v_mul_f32 v238, v2, v238
    v_mul_f32 v239, v2, v239
    v_cvt_pk_bf16_f32 v12, v232, v233
    v_cvt_pk_bf16_f32 v13, v234, v235
    v_cvt_pk_bf16_f32 v14, v236, v237
    v_cvt_pk_bf16_f32 v15, v238, v239
    buffer_store_dwordx4 v[12:15], v6, s[12:15], 0 offen offset:512 sc1
    v_mul_f32 v240, v4, v240
    v_mul_f32 v241, v4, v241
    v_mul_f32 v242, v4, v242
    v_mul_f32 v243, v4, v243
    v_mul_f32 v244, v4, v244
    v_mul_f32 v245, v4, v245
    v_mul_f32 v246, v4, v246
    v_mul_f32 v247, v4, v247
    v_cvt_pk_bf16_f32 v16, v240, v241
    v_cvt_pk_bf16_f32 v17, v242, v243
    v_cvt_pk_bf16_f32 v18, v244, v245
    v_cvt_pk_bf16_f32 v19, v246, v247
    buffer_store_dwordx4 v[16:19], v6, s[12:15], s27 offen offset:0 sc1
    v_mul_f32 v248, v4, v248
    v_mul_f32 v249, v4, v249
    v_mul_f32 v250, v4, v250
    v_mul_f32 v251, v4, v251
    v_mul_f32 v252, v4, v252
    v_mul_f32 v253, v4, v253
    v_mul_f32 v254, v4, v254
    v_mul_f32 v255, v4, v255
    v_cvt_pk_bf16_f32 v20, v248, v249
    v_cvt_pk_bf16_f32 v21, v250, v251
    v_cvt_pk_bf16_f32 v22, v252, v253
    v_cvt_pk_bf16_f32 v23, v254, v255
    buffer_store_dwordx4 v[20:23], v6, s[12:15], s27 offen offset:512 sc1
    s_mov_b64 s[8:9], s[76:77]
    s_mov_b32 s10, 2048
    s_cmp_lt_u32 s16, 4
    s_cselect_b64 vcc, -1, 0
    s_cbranch_scc0 Lproj_y
    s_waitcnt vmcnt(0)
    s_mov_b64 exec, 1
    buffer_store_dwordx2 v[222:223], v220, s[8:11], 0 offen sc1
    s_mov_b64 exec, -1
    s_barrier
    s_lshl_b32 s89, s16, 10
    s_add_u32 s20, s20, 1
    s_add_u32 s26, s20, s19
    s_and_b32 s26, s26, 7
    s_xor_b32 s27, s20, s19
    s_and_b32 s27, s27, 8
    s_or_b32 s26, s26, s27
    s_lshl_b32 s26, s26, 1
    s_lshr_b32 s27, s20, 4
    s_add_u32 s26, s26, s27
    s_lshl_b32 s26, s26, 16
    s_mov_b32 m0, s89
    s_add_u32 s88, s26, s21
    s_add_u32 s89, s89, 4096
    buffer_load_dwordx4 v199, s[52:55], s88 offen lds
    s_add_u32 s20, s20, 1
    s_add_u32 s26, s20, s19
    s_and_b32 s26, s26, 7
    s_xor_b32 s27, s20, s19
    s_and_b32 s27, s27, 8
    s_or_b32 s26, s26, s27
    s_lshl_b32 s26, s26, 1
    s_lshr_b32 s27, s20, 4
    s_add_u32 s26, s26, s27
    s_lshl_b32 s26, s26, 16
    s_mov_b32 m0, s89
    s_add_u32 s88, s26, s21
    s_add_u32 s89, s89, 4096
    buffer_load_dwordx4 v199, s[52:55], s88 offen lds
    s_add_u32 s20, s20, 1
    s_add_u32 s26, s20, s19
    s_and_b32 s26, s26, 7
    s_xor_b32 s27, s20, s19
    s_and_b32 s27, s27, 8
    s_or_b32 s26, s26, s27
    s_lshl_b32 s26, s26, 1
    s_lshr_b32 s27, s20, 4
    s_add_u32 s26, s26, s27
    s_lshl_b32 s26, s26, 16
    s_mov_b32 m0, s89
    s_add_u32 s88, s26, s21
    s_add_u32 s89, s89, 4096
    buffer_load_dwordx4 v199, s[52:55], s88 offen lds
    s_add_u32 s20, s20, 1
    s_add_u32 s26, s20, s19
    s_and_b32 s26, s26, 7
    s_xor_b32 s27, s20, s19
    s_and_b32 s27, s27, 8
    s_or_b32 s26, s26, s27
    s_lshl_b32 s26, s26, 1
    s_lshr_b32 s27, s20, 4
    s_add_u32 s26, s26, s27
    s_lshl_b32 s26, s26, 16
    s_mov_b32 m0, s89
    s_add_u32 s88, s26, s21
    s_add_u32 s89, s89, 4096
    buffer_load_dwordx4 v199, s[52:55], s88 offen lds
    s_add_u32 s89, s89, 114688
    s_add_u32 s20, s20, 1
    s_add_u32 s26, s20, s19
    s_and_b32 s26, s26, 7
    s_xor_b32 s27, s20, s19
    s_and_b32 s27, s27, 8
    s_or_b32 s26, s26, s27
    s_lshl_b32 s26, s26, 1
    s_lshr_b32 s27, s20, 4
    s_add_u32 s26, s26, s27
    s_lshl_b32 s26, s26, 16
    s_mov_b32 m0, s89
    s_add_u32 s88, s26, s21
    s_add_u32 s89, s89, 4096
    buffer_load_dwordx4 v199, s[52:55], s88 offen lds
    s_add_u32 s20, s20, 1
    s_add_u32 s26, s20, s19
    s_and_b32 s26, s26, 7
    s_xor_b32 s27, s20, s19
    s_and_b32 s27, s27, 8
    s_or_b32 s26, s26, s27
    s_lshl_b32 s26, s26, 1
    s_lshr_b32 s27, s20, 4
    s_add_u32 s26, s26, s27
    s_lshl_b32 s26, s26, 16
    s_mov_b32 m0, s89
    s_add_u32 s88, s26, s21
    s_add_u32 s89, s89, 4096
    buffer_load_dwordx4 v199, s[52:55], s88 offen lds
    s_add_u32 s20, s20, 1
    s_add_u32 s26, s20, s19
    s_and_b32 s26, s26, 7
    s_xor_b32 s27, s20, s19
    s_and_b32 s27, s27, 8
    s_or_b32 s26, s26, s27
    s_lshl_b32 s26, s26, 1
    s_lshr_b32 s27, s20, 4
    s_add_u32 s26, s26, s27
    s_lshl_b32 s26, s26, 16
    s_mov_b32 m0, s89
    s_add_u32 s88, s26, s21
    s_add_u32 s89, s89, 4096
    buffer_load_dwordx4 v199, s[52:55], s88 offen lds
    s_add_u32 s20, s20, 1
    s_add_u32 s26, s20, s19
    s_and_b32 s26, s26, 7
    s_xor_b32 s27, s20, s19
    s_and_b32 s27, s27, 8
    s_or_b32 s26, s26, s27
    s_lshl_b32 s26, s26, 1
    s_lshr_b32 s27, s20, 4
    s_add_u32 s26, s26, s27
    s_lshl_b32 s26, s26, 16
    s_mov_b32 m0, s89
    s_add_u32 s88, s26, s21
    s_add_u32 s89, s89, 4096
    buffer_load_dwordx4 v199, s[52:55], s88 offen lds
    s_waitcnt vmcnt(8)
    s_setprio 0
    s_mov_b32 s82, 0
    s_xor_b32 s24, s40, 0
    s_cmp_lg_u32 s82, -1
    s_cbranch_scc1 Lpollo0
Lpollo0_r:
    buffer_load_dwordx4 v[72:75], v216, s[32:35], s64 offen offset:0 sc1
    buffer_load_dwordx4 v[76:79], v217, s[32:35], s64 offen offset:0 sc1
    buffer_load_dwordx4 v[80:83], v216, s[32:35], s65 offen offset:0 sc1
    buffer_load_dwordx4 v[84:87], v217, s[32:35], s65 offen offset:0 sc1
    buffer_load_dwordx4 v[88:91], v216, s[32:35], s66 offen offset:0 sc1
    buffer_load_dwordx4 v[92:95], v217, s[32:35], s66 offen offset:0 sc1
    buffer_load_dwordx4 v[96:99], v216, s[32:35], s67 offen offset:0 sc1
    buffer_load_dwordx4 v[100:103], v217, s[32:35], s67 offen offset:0 sc1
    buffer_load_dwordx4 v[136:139], v216, s[32:35], s68 offen offset:0 sc1
    buffer_load_dwordx4 v[140:143], v217, s[32:35], s68 offen offset:0 sc1
    buffer_load_dwordx4 v[144:147], v216, s[32:35], s69 offen offset:0 sc1
    buffer_load_dwordx4 v[148:151], v217, s[32:35], s69 offen offset:0 sc1
    s_setprio 0
    ds_read_b64_tr_b16 v[104:105], v212 offset:0
    ds_read_b64_tr_b16 v[106:107], v212 offset:1024
    ds_read_b64_tr_b16 v[108:109], v213 offset:0
    ds_read_b64_tr_b16 v[110:111], v213 offset:1024
    ds_read_b64_tr_b16 v[112:113], v214 offset:0
    ds_read_b64_tr_b16 v[114:115], v214 offset:1024
    ds_read_b64_tr_b16 v[116:117], v215 offset:0
    ds_read_b64_tr_b16 v[118:119], v215 offset:1024
    s_waitcnt vmcnt(10) lgkmcnt(0)
    v_mfma_f32_16x16x32_bf16 v[40:43], v[104:107], v[72:75], 0
    ds_read_b64_tr_b16 v[120:121], v212 offset:4096
    ds_read_b64_tr_b16 v[122:123], v212 offset:5120
    v_mfma_f32_16x16x32_bf16 v[44:47], v[108:111], v[72:75], 0
    ds_read_b64_tr_b16 v[124:125], v213 offset:4096
    ds_read_b64_tr_b16 v[126:127], v213 offset:5120
    v_mfma_f32_16x16x32_bf16 v[48:51], v[112:115], v[72:75], 0
    ds_read_b64_tr_b16 v[128:129], v214 offset:4096
    ds_read_b64_tr_b16 v[130:131], v214 offset:5120
    v_mfma_f32_16x16x32_bf16 v[52:55], v[116:119], v[72:75], 0
    ds_read_b64_tr_b16 v[132:133], v215 offset:4096
    ds_read_b64_tr_b16 v[134:135], v215 offset:5120
    v_mfma_f32_16x16x32_bf16 v[68:71], v[116:119], v[76:79], 0
    buffer_load_dwordx4 v[152:155], v216, s[32:35], s70 offen offset:0 sc1
    v_mfma_f32_16x16x32_bf16 v[64:67], v[112:115], v[76:79], 0
    buffer_load_dwordx4 v[156:159], v217, s[32:35], s70 offen offset:0 sc1
    v_mfma_f32_16x16x32_bf16 v[60:63], v[108:111], v[76:79], 0
    v_mfma_f32_16x16x32_bf16 v[56:59], v[104:107], v[76:79], 0
    s_waitcnt vmcnt(10) lgkmcnt(0)
    v_mfma_f32_16x16x32_bf16 v[40:43], v[120:123], v[80:83], v[40:43]
    ds_read_b64_tr_b16 v[104:105], v212 offset:8192
    ds_read_b64_tr_b16 v[106:107], v212 offset:9216
    v_mfma_f32_16x16x32_bf16 v[44:47], v[124:127], v[80:83], v[44:47]
    ds_read_b64_tr_b16 v[108:109], v213 offset:8192
    ds_read_b64_tr_b16 v[110:111], v213 offset:9216
    v_mfma_f32_16x16x32_bf16 v[48:51], v[128:131], v[80:83], v[48:51]
    ds_read_b64_tr_b16 v[112:113], v214 offset:8192
    ds_read_b64_tr_b16 v[114:115], v214 offset:9216
    v_mfma_f32_16x16x32_bf16 v[52:55], v[132:135], v[80:83], v[52:55]
    ds_read_b64_tr_b16 v[116:117], v215 offset:8192
    ds_read_b64_tr_b16 v[118:119], v215 offset:9216
    v_mfma_f32_16x16x32_bf16 v[68:71], v[132:135], v[84:87], v[68:71]
    buffer_load_dwordx4 v[160:163], v216, s[32:35], s71 offen offset:0 sc1
    v_mfma_f32_16x16x32_bf16 v[64:67], v[128:131], v[84:87], v[64:67]
    buffer_load_dwordx4 v[164:167], v217, s[32:35], s71 offen offset:0 sc1
    v_mfma_f32_16x16x32_bf16 v[60:63], v[124:127], v[84:87], v[60:63]
    v_mfma_f32_16x16x32_bf16 v[56:59], v[120:123], v[84:87], v[56:59]
    s_waitcnt vmcnt(10) lgkmcnt(0)
    v_mfma_f32_16x16x32_bf16 v[40:43], v[104:107], v[88:91], v[40:43]
    ds_read_b64_tr_b16 v[120:121], v212 offset:12288
    ds_read_b64_tr_b16 v[122:123], v212 offset:13312
    v_mfma_f32_16x16x32_bf16 v[44:47], v[108:111], v[88:91], v[44:47]
    ds_read_b64_tr_b16 v[124:125], v213 offset:12288
    ds_read_b64_tr_b16 v[126:127], v213 offset:13312
    v_mfma_f32_16x16x32_bf16 v[48:51], v[112:115], v[88:91], v[48:51]
    ds_read_b64_tr_b16 v[128:129], v214 offset:12288
    ds_read_b64_tr_b16 v[130:131], v214 offset:13312
    v_mfma_f32_16x16x32_bf16 v[52:55], v[116:119], v[88:91], v[52:55]
    ds_read_b64_tr_b16 v[132:133], v215 offset:12288
    ds_read_b64_tr_b16 v[134:135], v215 offset:13312
    v_mfma_f32_16x16x32_bf16 v[68:71], v[116:119], v[92:95], v[68:71]
    s_mov_b32 s82, 0
    s_xor_b32 s24, s40, 128
    s_cmp_lg_u32 s82, -1
    s_cbranch_scc1 Lpollo1
Lpollo1_r:
    buffer_load_dwordx4 v[8:11], v218, s[32:35], s64 offen offset:0 sc1
    v_mfma_f32_16x16x32_bf16 v[64:67], v[112:115], v[92:95], v[64:67]
    buffer_load_dwordx4 v[12:15], v219, s[32:35], s64 offen offset:0 sc1
    v_mfma_f32_16x16x32_bf16 v[60:63], v[108:111], v[92:95], v[60:63]
    v_mfma_f32_16x16x32_bf16 v[56:59], v[104:107], v[92:95], v[56:59]
    s_waitcnt vmcnt(10) lgkmcnt(0)
    v_mfma_f32_16x16x32_bf16 v[40:43], v[120:123], v[96:99], v[40:43]
    ds_read_b64_tr_b16 v[104:105], v212 offset:16384
    ds_read_b64_tr_b16 v[106:107], v212 offset:17408
    v_mfma_f32_16x16x32_bf16 v[44:47], v[124:127], v[96:99], v[44:47]
    ds_read_b64_tr_b16 v[108:109], v213 offset:16384
    ds_read_b64_tr_b16 v[110:111], v213 offset:17408
    v_mfma_f32_16x16x32_bf16 v[48:51], v[128:131], v[96:99], v[48:51]
    ds_read_b64_tr_b16 v[112:113], v214 offset:16384
    ds_read_b64_tr_b16 v[114:115], v214 offset:17408
    v_mfma_f32_16x16x32_bf16 v[52:55], v[132:135], v[96:99], v[52:55]
    ds_read_b64_tr_b16 v[116:117], v215 offset:16384
    ds_read_b64_tr_b16 v[118:119], v215 offset:17408
    v_mfma_f32_16x16x32_bf16 v[68:71], v[132:135], v[100:103], v[68:71]
    buffer_load_dwordx4 v[16:19], v218, s[32:35], s65 offen offset:0 sc1
    v_mfma_f32_16x16x32_bf16 v[64:67], v[128:131], v[100:103], v[64:67]
    buffer_load_dwordx4 v[20:23], v219, s[32:35], s65 offen offset:0 sc1
    v_mfma_f32_16x16x32_bf16 v[60:63], v[124:127], v[100:103], v[60:63]
    v_mfma_f32_16x16x32_bf16 v[56:59], v[120:123], v[100:103], v[56:59]
    s_waitcnt vmcnt(10) lgkmcnt(0)
    v_mfma_f32_16x16x32_bf16 v[40:43], v[104:107], v[136:139], v[40:43]
    ds_read_b64_tr_b16 v[120:121], v212 offset:20480
    ds_read_b64_tr_b16 v[122:123], v212 offset:21504
    v_mfma_f32_16x16x32_bf16 v[44:47], v[108:111], v[136:139], v[44:47]
    ds_read_b64_tr_b16 v[124:125], v213 offset:20480
    ds_read_b64_tr_b16 v[126:127], v213 offset:21504
    v_mfma_f32_16x16x32_bf16 v[48:51], v[112:115], v[136:139], v[48:51]
    ds_read_b64_tr_b16 v[128:129], v214 offset:20480
    ds_read_b64_tr_b16 v[130:131], v214 offset:21504
    v_mfma_f32_16x16x32_bf16 v[52:55], v[116:119], v[136:139], v[52:55]
    ds_read_b64_tr_b16 v[132:133], v215 offset:20480
    ds_read_b64_tr_b16 v[134:135], v215 offset:21504
    v_mfma_f32_16x16x32_bf16 v[68:71], v[116:119], v[140:143], v[68:71]
    buffer_load_dwordx4 v[24:27], v218, s[32:35], s66 offen offset:0 sc1
    v_mfma_f32_16x16x32_bf16 v[64:67], v[112:115], v[140:143], v[64:67]
    buffer_load_dwordx4 v[28:31], v219, s[32:35], s66 offen offset:0 sc1
    v_mfma_f32_16x16x32_bf16 v[60:63], v[108:111], v[140:143], v[60:63]
    v_mfma_f32_16x16x32_bf16 v[56:59], v[104:107], v[140:143], v[56:59]
    s_waitcnt vmcnt(10) lgkmcnt(0)
    v_mfma_f32_16x16x32_bf16 v[40:43], v[120:123], v[144:147], v[40:43]
    ds_read_b64_tr_b16 v[104:105], v212 offset:24576
    ds_read_b64_tr_b16 v[106:107], v212 offset:25600
    v_mfma_f32_16x16x32_bf16 v[44:47], v[124:127], v[144:147], v[44:47]
    ds_read_b64_tr_b16 v[108:109], v213 offset:24576
    ds_read_b64_tr_b16 v[110:111], v213 offset:25600
    v_mfma_f32_16x16x32_bf16 v[48:51], v[128:131], v[144:147], v[48:51]
    ds_read_b64_tr_b16 v[112:113], v214 offset:24576
    ds_read_b64_tr_b16 v[114:115], v214 offset:25600
    v_mfma_f32_16x16x32_bf16 v[52:55], v[132:135], v[144:147], v[52:55]
    ds_read_b64_tr_b16 v[116:117], v215 offset:24576
    ds_read_b64_tr_b16 v[118:119], v215 offset:25600
    v_mfma_f32_16x16x32_bf16 v[68:71], v[132:135], v[148:151], v[68:71]
    buffer_load_dwordx4 v[32:35], v218, s[32:35], s67 offen offset:0 sc1
    v_mfma_f32_16x16x32_bf16 v[64:67], v[128:131], v[148:151], v[64:67]
    buffer_load_dwordx4 v[36:39], v219, s[32:35], s67 offen offset:0 sc1
    v_mfma_f32_16x16x32_bf16 v[60:63], v[124:127], v[148:151], v[60:63]
    v_mfma_f32_16x16x32_bf16 v[56:59], v[120:123], v[148:151], v[56:59]
    s_waitcnt vmcnt(10) lgkmcnt(0)
    v_mfma_f32_16x16x32_bf16 v[40:43], v[104:107], v[152:155], v[40:43]
    ds_read_b64_tr_b16 v[120:121], v212 offset:28672
    ds_read_b64_tr_b16 v[122:123], v212 offset:29696
    v_mfma_f32_16x16x32_bf16 v[44:47], v[108:111], v[152:155], v[44:47]
    ds_read_b64_tr_b16 v[124:125], v213 offset:28672
    ds_read_b64_tr_b16 v[126:127], v213 offset:29696
    v_mfma_f32_16x16x32_bf16 v[48:51], v[112:115], v[152:155], v[48:51]
    ds_read_b64_tr_b16 v[128:129], v214 offset:28672
    ds_read_b64_tr_b16 v[130:131], v214 offset:29696
    v_mfma_f32_16x16x32_bf16 v[52:55], v[116:119], v[152:155], v[52:55]
    ds_read_b64_tr_b16 v[132:133], v215 offset:28672
    ds_read_b64_tr_b16 v[134:135], v215 offset:29696
    v_mfma_f32_16x16x32_bf16 v[68:71], v[116:119], v[156:159], v[68:71]
    buffer_load_dwordx4 v[224:227], v218, s[32:35], s68 offen offset:0 sc1
    v_mfma_f32_16x16x32_bf16 v[64:67], v[112:115], v[156:159], v[64:67]
    buffer_load_dwordx4 v[228:231], v219, s[32:35], s68 offen offset:0 sc1
    v_mfma_f32_16x16x32_bf16 v[60:63], v[108:111], v[156:159], v[60:63]
    v_mfma_f32_16x16x32_bf16 v[56:59], v[104:107], v[156:159], v[56:59]
    s_waitcnt vmcnt(10) lgkmcnt(0)
    v_mfma_f32_16x16x32_bf16 v[40:43], v[120:123], v[160:163], v[40:43]
    ds_read_b64_tr_b16 v[104:105], v212 offset:32768
    ds_read_b64_tr_b16 v[106:107], v212 offset:33792
    v_mfma_f32_16x16x32_bf16 v[44:47], v[124:127], v[160:163], v[44:47]
    ds_read_b64_tr_b16 v[108:109], v213 offset:32768
    ds_read_b64_tr_b16 v[110:111], v213 offset:33792
    v_mfma_f32_16x16x32_bf16 v[48:51], v[128:131], v[160:163], v[48:51]
    ds_read_b64_tr_b16 v[112:113], v214 offset:32768
    ds_read_b64_tr_b16 v[114:115], v214 offset:33792
    v_mfma_f32_16x16x32_bf16 v[52:55], v[132:135], v[160:163], v[52:55]
    ds_read_b64_tr_b16 v[116:117], v215 offset:32768
    ds_read_b64_tr_b16 v[118:119], v215 offset:33792
    v_mfma_f32_16x16x32_bf16 v[68:71], v[132:135], v[164:167], v[68:71]
    buffer_load_dwordx4 v[232:235], v218, s[32:35], s69 offen offset:0 sc1
    v_mfma_f32_16x16x32_bf16 v[64:67], v[128:131], v[164:167], v[64:67]
    buffer_load_dwordx4 v[236:239], v219, s[32:35], s69 offen offset:0 sc1
    s_xor_b32 s24, s40, 256
    buffer_load_dwordx2 v[200:201], v202, s[8:11], s24 offen sc1
    v_mfma_f32_16x16x32_bf16 v[60:63], v[124:127], v[164:167], v[60:63]
    v_mfma_f32_16x16x32_bf16 v[56:59], v[120:123], v[164:167], v[56:59]
    s_waitcnt vmcnt(10) lgkmcnt(0)
    v_mfma_f32_16x16x32_bf16 v[40:43], v[104:107], v[8:11], v[40:43]
    ds_read_b64_tr_b16 v[120:121], v212 offset:36864
    ds_read_b64_tr_b16 v[122:123], v212 offset:37888
    v_mfma_f32_16x16x32_bf16 v[44:47], v[108:111], v[8:11], v[44:47]
    ds_read_b64_tr_b16 v[124:125], v213 offset:36864
    ds_read_b64_tr_b16 v[126:127], v213 offset:37888
    v_mfma_f32_16x16x32_bf16 v[48:51], v[112:115], v[8:11], v[48:51]
    ds_read_b64_tr_b16 v[128:129], v214 offset:36864
    ds_read_b64_tr_b16 v[130:131], v214 offset:37888
    v_mfma_f32_16x16x32_bf16 v[52:55], v[116:119], v[8:11], v[52:55]
    ds_read_b64_tr_b16 v[132:133], v215 offset:36864
    ds_read_b64_tr_b16 v[134:135], v215 offset:37888
    v_mfma_f32_16x16x32_bf16 v[68:71], v[116:119], v[12:15], v[68:71]
    buffer_load_dwordx4 v[240:243], v218, s[32:35], s70 offen offset:0 sc1
    v_mfma_f32_16x16x32_bf16 v[64:67], v[112:115], v[12:15], v[64:67]
    buffer_load_dwordx4 v[244:247], v219, s[32:35], s70 offen offset:0 sc1
    v_mfma_f32_16x16x32_bf16 v[60:63], v[108:111], v[12:15], v[60:63]
    v_mfma_f32_16x16x32_bf16 v[56:59], v[104:107], v[12:15], v[56:59]
    s_waitcnt vmcnt(10) lgkmcnt(0)
    v_mfma_f32_16x16x32_bf16 v[40:43], v[120:123], v[16:19], v[40:43]
    ds_read_b64_tr_b16 v[104:105], v212 offset:40960
    ds_read_b64_tr_b16 v[106:107], v212 offset:41984
    v_mfma_f32_16x16x32_bf16 v[44:47], v[124:127], v[16:19], v[44:47]
    ds_read_b64_tr_b16 v[108:109], v213 offset:40960
    ds_read_b64_tr_b16 v[110:111], v213 offset:41984
    v_mfma_f32_16x16x32_bf16 v[48:51], v[128:131], v[16:19], v[48:51]
    ds_read_b64_tr_b16 v[112:113], v214 offset:40960
    ds_read_b64_tr_b16 v[114:115], v214 offset:41984
    v_mfma_f32_16x16x32_bf16 v[52:55], v[132:135], v[16:19], v[52:55]
    ds_read_b64_tr_b16 v[116:117], v215 offset:40960
    ds_read_b64_tr_b16 v[118:119], v215 offset:41984
    v_mfma_f32_16x16x32_bf16 v[68:71], v[132:135], v[20:23], v[68:71]
    buffer_load_dwordx4 v[248:251], v218, s[32:35], s71 offen offset:0 sc1
    v_mfma_f32_16x16x32_bf16 v[64:67], v[128:131], v[20:23], v[64:67]
    buffer_load_dwordx4 v[252:255], v219, s[32:35], s71 offen offset:0 sc1
    v_mfma_f32_16x16x32_bf16 v[60:63], v[124:127], v[20:23], v[60:63]
    v_mfma_f32_16x16x32_bf16 v[56:59], v[120:123], v[20:23], v[56:59]
    s_waitcnt vmcnt(10) lgkmcnt(0)
    v_mfma_f32_16x16x32_bf16 v[40:43], v[104:107], v[24:27], v[40:43]
    ds_read_b64_tr_b16 v[120:121], v212 offset:45056
    ds_read_b64_tr_b16 v[122:123], v212 offset:46080
    v_mfma_f32_16x16x32_bf16 v[44:47], v[108:111], v[24:27], v[44:47]
    ds_read_b64_tr_b16 v[124:125], v213 offset:45056
    ds_read_b64_tr_b16 v[126:127], v213 offset:46080
    v_mfma_f32_16x16x32_bf16 v[48:51], v[112:115], v[24:27], v[48:51]
    ds_read_b64_tr_b16 v[128:129], v214 offset:45056
    ds_read_b64_tr_b16 v[130:131], v214 offset:46080
    v_mfma_f32_16x16x32_bf16 v[52:55], v[116:119], v[24:27], v[52:55]
    ds_read_b64_tr_b16 v[132:133], v215 offset:45056
    ds_read_b64_tr_b16 v[134:135], v215 offset:46080
    v_mfma_f32_16x16x32_bf16 v[68:71], v[116:119], v[28:31], v[68:71]
    s_barrier
    s_mov_b32 s82, 0
    s_xor_b32 s24, s40, 256
    s_cmp_lg_u32 s82, -1
    s_cbranch_scc1 Lpollo2
Lpollo2_r:
    buffer_load_dwordx4 v[72:75], v216, s[32:35], s64 offen offset:1024 sc1
    v_mfma_f32_16x16x32_bf16 v[64:67], v[112:115], v[28:31], v[64:67]
    buffer_load_dwordx4 v[76:79], v217, s[32:35], s64 offen offset:1024 sc1
    v_mfma_f32_16x16x32_bf16 v[60:63], v[108:111], v[28:31], v[60:63]
    v_mfma_f32_16x16x32_bf16 v[56:59], v[104:107], v[28:31], v[56:59]
    s_waitcnt vmcnt(10) lgkmcnt(0)
    v_mfma_f32_16x16x32_bf16 v[40:43], v[120:123], v[32:35], v[40:43]
    ds_read_b64_tr_b16 v[104:105], v212 offset:49152
    ds_read_b64_tr_b16 v[106:107], v212 offset:50176
    v_mfma_f32_16x16x32_bf16 v[44:47], v[124:127], v[32:35], v[44:47]
    ds_read_b64_tr_b16 v[108:109], v213 offset:49152
    ds_read_b64_tr_b16 v[110:111], v213 offset:50176
    v_mfma_f32_16x16x32_bf16 v[48:51], v[128:131], v[32:35], v[48:51]
    ds_read_b64_tr_b16 v[112:113], v214 offset:49152
    ds_read_b64_tr_b16 v[114:115], v214 offset:50176
    v_mfma_f32_16x16x32_bf16 v[52:55], v[132:135], v[32:35], v[52:55]
    ds_read_b64_tr_b16 v[116:117], v215 offset:49152
    ds_read_b64_tr_b16 v[118:119], v215 offset:50176
    v_mfma_f32_16x16x32_bf16 v[68:71], v[132:135], v[36:39], v[68:71]
    buffer_load_dwordx4 v[80:83], v216, s[32:35], s65 offen offset:1024 sc1
    v_mfma_f32_16x16x32_bf16 v[64:67], v[128:131], v[36:39], v[64:67]
    buffer_load_dwordx4 v[84:87], v217, s[32:35], s65 offen offset:1024 sc1
    v_mfma_f32_16x16x32_bf16 v[60:63], v[124:127], v[36:39], v[60:63]
    v_mfma_f32_16x16x32_bf16 v[56:59], v[120:123], v[36:39], v[56:59]
    s_waitcnt vmcnt(10) lgkmcnt(0)
    v_mfma_f32_16x16x32_bf16 v[40:43], v[104:107], v[224:227], v[40:43]
    ds_read_b64_tr_b16 v[120:121], v212 offset:53248
    ds_read_b64_tr_b16 v[122:123], v212 offset:54272
    v_mfma_f32_16x16x32_bf16 v[44:47], v[108:111], v[224:227], v[44:47]
    ds_read_b64_tr_b16 v[124:125], v213 offset:53248
    ds_read_b64_tr_b16 v[126:127], v213 offset:54272
    v_mfma_f32_16x16x32_bf16 v[48:51], v[112:115], v[224:227], v[48:51]
    ds_read_b64_tr_b16 v[128:129], v214 offset:53248
    ds_read_b64_tr_b16 v[130:131], v214 offset:54272
    v_mfma_f32_16x16x32_bf16 v[52:55], v[116:119], v[224:227], v[52:55]
    ds_read_b64_tr_b16 v[132:133], v215 offset:53248
    ds_read_b64_tr_b16 v[134:135], v215 offset:54272
    v_mfma_f32_16x16x32_bf16 v[68:71], v[116:119], v[228:231], v[68:71]
    buffer_load_dwordx4 v[88:91], v216, s[32:35], s66 offen offset:1024 sc1
    v_mfma_f32_16x16x32_bf16 v[64:67], v[112:115], v[228:231], v[64:67]
    buffer_load_dwordx4 v[92:95], v217, s[32:35], s66 offen offset:1024 sc1
    v_mfma_f32_16x16x32_bf16 v[60:63], v[108:111], v[228:231], v[60:63]
    v_mfma_f32_16x16x32_bf16 v[56:59], v[104:107], v[228:231], v[56:59]
    s_waitcnt vmcnt(10) lgkmcnt(0)
    v_mfma_f32_16x16x32_bf16 v[40:43], v[120:123], v[232:235], v[40:43]
    ds_read_b64_tr_b16 v[104:105], v212 offset:57344
    ds_read_b64_tr_b16 v[106:107], v212 offset:58368
    v_mfma_f32_16x16x32_bf16 v[44:47], v[124:127], v[232:235], v[44:47]
    ds_read_b64_tr_b16 v[108:109], v213 offset:57344
    ds_read_b64_tr_b16 v[110:111], v213 offset:58368
    v_mfma_f32_16x16x32_bf16 v[48:51], v[128:131], v[232:235], v[48:51]
    ds_read_b64_tr_b16 v[112:113], v214 offset:57344
    ds_read_b64_tr_b16 v[114:115], v214 offset:58368
    v_mfma_f32_16x16x32_bf16 v[52:55], v[132:135], v[232:235], v[52:55]
    ds_read_b64_tr_b16 v[116:117], v215 offset:57344
    ds_read_b64_tr_b16 v[118:119], v215 offset:58368
    v_mfma_f32_16x16x32_bf16 v[68:71], v[132:135], v[236:239], v[68:71]
    buffer_load_dwordx4 v[96:99], v216, s[32:35], s67 offen offset:1024 sc1
    v_mfma_f32_16x16x32_bf16 v[64:67], v[128:131], v[236:239], v[64:67]
    buffer_load_dwordx4 v[100:103], v217, s[32:35], s67 offen offset:1024 sc1
    v_mfma_f32_16x16x32_bf16 v[60:63], v[124:127], v[236:239], v[60:63]
    v_mfma_f32_16x16x32_bf16 v[56:59], v[120:123], v[236:239], v[56:59]
    s_waitcnt vmcnt(10) lgkmcnt(0)
    v_mfma_f32_16x16x32_bf16 v[40:43], v[104:107], v[240:243], v[40:43]
    ds_read_b64_tr_b16 v[120:121], v212 offset:61440
    ds_read_b64_tr_b16 v[122:123], v212 offset:62464
    v_mfma_f32_16x16x32_bf16 v[44:47], v[108:111], v[240:243], v[44:47]
    ds_read_b64_tr_b16 v[124:125], v213 offset:61440
    ds_read_b64_tr_b16 v[126:127], v213 offset:62464
    v_mfma_f32_16x16x32_bf16 v[48:51], v[112:115], v[240:243], v[48:51]
    ds_read_b64_tr_b16 v[128:129], v214 offset:61440
    ds_read_b64_tr_b16 v[130:131], v214 offset:62464
    v_mfma_f32_16x16x32_bf16 v[52:55], v[116:119], v[240:243], v[52:55]
    ds_read_b64_tr_b16 v[132:133], v215 offset:61440
    ds_read_b64_tr_b16 v[134:135], v215 offset:62464
    v_mfma_f32_16x16x32_bf16 v[68:71], v[116:119], v[244:247], v[68:71]
    buffer_load_dwordx4 v[136:139], v216, s[32:35], s68 offen offset:1024 sc1
    v_mfma_f32_16x16x32_bf16 v[64:67], v[112:115], v[244:247], v[64:67]
    buffer_load_dwordx4 v[140:143], v217, s[32:35], s68 offen offset:1024 sc1
    v_mfma_f32_16x16x32_bf16 v[60:63], v[108:111], v[244:247], v[60:63]
    v_mfma_f32_16x16x32_bf16 v[56:59], v[104:107], v[244:247], v[56:59]
    v_add_u32 v212, 4294901760, v212
    v_add_u32 v213, 4294901760, v213
    v_add_u32 v214, 4294901760, v214
    v_add_u32 v215, 4294901760, v215
    s_waitcnt vmcnt(10) lgkmcnt(0)
    v_mfma_f32_16x16x32_bf16 v[40:43], v[120:123], v[248:251], v[40:43]
    ds_read_b64_tr_b16 v[104:105], v212 offset:32768
    ds_read_b64_tr_b16 v[106:107], v212 offset:33792
    v_mfma_f32_16x16x32_bf16 v[44:47], v[124:127], v[248:251], v[44:47]
    ds_read_b64_tr_b16 v[108:109], v213 offset:32768
    ds_read_b64_tr_b16 v[110:111], v213 offset:33792
    v_mfma_f32_16x16x32_bf16 v[48:51], v[128:131], v[248:251], v[48:51]
    ds_read_b64_tr_b16 v[112:113], v214 offset:32768
    ds_read_b64_tr_b16 v[114:115], v214 offset:33792
    v_mfma_f32_16x16x32_bf16 v[52:55], v[132:135], v[248:251], v[52:55]
    ds_read_b64_tr_b16 v[116:117], v215 offset:32768
    ds_read_b64_tr_b16 v[118:119], v215 offset:33792
    v_mfma_f32_16x16x32_bf16 v[68:71], v[132:135], v[252:255], v[68:71]
    buffer_load_dwordx4 v[144:147], v216, s[32:35], s69 offen offset:1024 sc1
    v_mfma_f32_16x16x32_bf16 v[64:67], v[128:131], v[252:255], v[64:67]
    buffer_load_dwordx4 v[148:151], v217, s[32:35], s69 offen offset:1024 sc1
    s_xor_b32 s24, s40, 384
    buffer_load_dwordx2 v[200:201], v202, s[8:11], s24 offen sc1
    v_mfma_f32_16x16x32_bf16 v[60:63], v[124:127], v[252:255], v[60:63]
    v_mfma_f32_16x16x32_bf16 v[56:59], v[120:123], v[252:255], v[56:59]
    s_waitcnt vmcnt(10) lgkmcnt(0)
    v_mfma_f32_16x16x32_bf16 v[40:43], v[104:107], v[72:75], v[40:43]
    ds_read_b64_tr_b16 v[120:121], v212 offset:36864
    ds_read_b64_tr_b16 v[122:123], v212 offset:37888
    v_mfma_f32_16x16x32_bf16 v[44:47], v[108:111], v[72:75], v[44:47]
    ds_read_b64_tr_b16 v[124:125], v213 offset:36864
    ds_read_b64_tr_b16 v[126:127], v213 offset:37888
    v_mfma_f32_16x16x32_bf16 v[48:51], v[112:115], v[72:75], v[48:51]
    ds_read_b64_tr_b16 v[128:129], v214 offset:36864
    ds_read_b64_tr_b16 v[130:131], v214 offset:37888
    v_mfma_f32_16x16x32_bf16 v[52:55], v[116:119], v[72:75], v[52:55]
    ds_read_b64_tr_b16 v[132:133], v215 offset:36864
    ds_read_b64_tr_b16 v[134:135], v215 offset:37888
    v_mfma_f32_16x16x32_bf16 v[68:71], v[116:119], v[76:79], v[68:71]
    buffer_load_dwordx4 v[152:155], v216, s[32:35], s70 offen offset:1024 sc1
    v_mfma_f32_16x16x32_bf16 v[64:67], v[112:115], v[76:79], v[64:67]
    buffer_load_dwordx4 v[156:159], v217, s[32:35], s70 offen offset:1024 sc1
    v_mfma_f32_16x16x32_bf16 v[60:63], v[108:111], v[76:79], v[60:63]
    v_mfma_f32_16x16x32_bf16 v[56:59], v[104:107], v[76:79], v[56:59]
    s_waitcnt vmcnt(10) lgkmcnt(0)
    v_mfma_f32_16x16x32_bf16 v[40:43], v[120:123], v[80:83], v[40:43]
    ds_read_b64_tr_b16 v[104:105], v212 offset:40960
    ds_read_b64_tr_b16 v[106:107], v212 offset:41984
    v_mfma_f32_16x16x32_bf16 v[44:47], v[124:127], v[80:83], v[44:47]
    ds_read_b64_tr_b16 v[108:109], v213 offset:40960
    ds_read_b64_tr_b16 v[110:111], v213 offset:41984
    v_mfma_f32_16x16x32_bf16 v[48:51], v[128:131], v[80:83], v[48:51]
    ds_read_b64_tr_b16 v[112:113], v214 offset:40960
    ds_read_b64_tr_b16 v[114:115], v214 offset:41984
    v_mfma_f32_16x16x32_bf16 v[52:55], v[132:135], v[80:83], v[52:55]
    ds_read_b64_tr_b16 v[116:117], v215 offset:40960
    ds_read_b64_tr_b16 v[118:119], v215 offset:41984
    v_mfma_f32_16x16x32_bf16 v[68:71], v[132:135], v[84:87], v[68:71]
    buffer_load_dwordx4 v[160:163], v216, s[32:35], s71 offen offset:1024 sc1
    v_mfma_f32_16x16x32_bf16 v[64:67], v[128:131], v[84:87], v[64:67]
    buffer_load_dwordx4 v[164:167], v217, s[32:35], s71 offen offset:1024 sc1
    v_mfma_f32_16x16x32_bf16 v[60:63], v[124:127], v[84:87], v[60:63]
    v_mfma_f32_16x16x32_bf16 v[56:59], v[120:123], v[84:87], v[56:59]
    s_waitcnt vmcnt(10) lgkmcnt(0)
    v_mfma_f32_16x16x32_bf16 v[40:43], v[104:107], v[88:91], v[40:43]
    ds_read_b64_tr_b16 v[120:121], v212 offset:45056
    ds_read_b64_tr_b16 v[122:123], v212 offset:46080
    v_mfma_f32_16x16x32_bf16 v[44:47], v[108:111], v[88:91], v[44:47]
    ds_read_b64_tr_b16 v[124:125], v213 offset:45056
    ds_read_b64_tr_b16 v[126:127], v213 offset:46080
    v_mfma_f32_16x16x32_bf16 v[48:51], v[112:115], v[88:91], v[48:51]
    ds_read_b64_tr_b16 v[128:129], v214 offset:45056
    ds_read_b64_tr_b16 v[130:131], v214 offset:46080
    v_mfma_f32_16x16x32_bf16 v[52:55], v[116:119], v[88:91], v[52:55]
    ds_read_b64_tr_b16 v[132:133], v215 offset:45056
    ds_read_b64_tr_b16 v[134:135], v215 offset:46080
    v_mfma_f32_16x16x32_bf16 v[68:71], v[116:119], v[92:95], v[68:71]
    s_waitcnt vmcnt(4)
    v_cmp_eq_u64 s[82:83], s[80:81], v[200:201]
    s_nop 0
    s_cmp_lg_u32 s82, -1
    s_cbranch_scc1 Lpollo3
Lpollo3_r:
    buffer_load_dwordx4 v[8:11], v218, s[32:35], s64 offen offset:1024 sc1
    v_mfma_f32_16x16x32_bf16 v[64:67], v[112:115], v[92:95], v[64:67]
    buffer_load_dwordx4 v[12:15], v219, s[32:35], s64 offen offset:1024 sc1
    v_mfma_f32_16x16x32_bf16 v[60:63], v[108:111], v[92:95], v[60:63]
    v_mfma_f32_16x16x32_bf16 v[56:59], v[104:107], v[92:95], v[56:59]
    s_waitcnt vmcnt(10) lgkmcnt(0)
    v_mfma_f32_16x16x32_bf16 v[40:43], v[120:123], v[96:99], v[40:43]
    ds_read_b64_tr_b16 v[104:105], v212 offset:49152
    ds_read_b64_tr_b16 v[106:107], v212 offset:50176
    v_mfma_f32_16x16x32_bf16 v[44:47], v[124:127], v[96:99], v[44:47]
    ds_read_b64_tr_b16 v[108:109], v213 offset:49152
    ds_read_b64_tr_b16 v[110:111], v213 offset:50176
    v_mfma_f32_16x16x32_bf16 v[48:51], v[128:131], v[96:99], v[48:51]
    ds_read_b64_tr_b16 v[112:113], v214 offset:49152
    ds_read_b64_tr_b16 v[114:115], v214 offset:50176
    v_mfma_f32_16x16x32_bf16 v[52:55], v[132:135], v[96:99], v[52:55]
    ds_read_b64_tr_b16 v[116:117], v215 offset:49152
    ds_read_b64_tr_b16 v[118:119], v215 offset:50176
    v_mfma_f32_16x16x32_bf16 v[68:71], v[132:135], v[100:103], v[68:71]
    buffer_load_dwordx4 v[16:19], v218, s[32:35], s65 offen offset:1024 sc1
    v_mfma_f32_16x16x32_bf16 v[64:67], v[128:131], v[100:103], v[64:67]
    buffer_load_dwordx4 v[20:23], v219, s[32:35], s65 offen offset:1024 sc1
    v_mfma_f32_16x16x32_bf16 v[60:63], v[124:127], v[100:103], v[60:63]
    v_mfma_f32_16x16x32_bf16 v[56:59], v[120:123], v[100:103], v[56:59]
    s_waitcnt vmcnt(10) lgkmcnt(0)
    v_mfma_f32_16x16x32_bf16 v[40:43], v[104:107], v[136:139], v[40:43]
    ds_read_b64_tr_b16 v[120:121], v212 offset:53248
    ds_read_b64_tr_b16 v[122:123], v212 offset:54272
    v_mfma_f32_16x16x32_bf16 v[44:47], v[108:111], v[136:139], v[44:47]
    ds_read_b64_tr_b16 v[124:125], v213 offset:53248
    ds_read_b64_tr_b16 v[126:127], v213 offset:54272
    v_mfma_f32_16x16x32_bf16 v[48:51], v[112:115], v[136:139], v[48:51]
    ds_read_b64_tr_b16 v[128:129], v214 offset:53248
    ds_read_b64_tr_b16 v[130:131], v214 offset:54272
    v_mfma_f32_16x16x32_bf16 v[52:55], v[116:119], v[136:139], v[52:55]
    ds_read_b64_tr_b16 v[132:133], v215 offset:53248
    ds_read_b64_tr_b16 v[134:135], v215 offset:54272
    v_mfma_f32_16x16x32_bf16 v[68:71], v[116:119], v[140:143], v[68:71]
    buffer_load_dwordx4 v[24:27], v218, s[32:35], s66 offen offset:1024 sc1
    v_mfma_f32_16x16x32_bf16 v[64:67], v[112:115], v[140:143], v[64:67]
    buffer_load_dwordx4 v[28:31], v219, s[32:35], s66 offen offset:1024 sc1
    v_mfma_f32_16x16x32_bf16 v[60:63], v[108:111], v[140:143], v[60:63]
    v_mfma_f32_16x16x32_bf16 v[56:59], v[104:107], v[140:143], v[56:59]
    s_waitcnt vmcnt(10) lgkmcnt(0)
    v_mfma_f32_16x16x32_bf16 v[40:43], v[120:123], v[144:147], v[40:43]
    ds_read_b64_tr_b16 v[104:105], v212 offset:57344
    ds_read_b64_tr_b16 v[106:107], v212 offset:58368
    v_mfma_f32_16x16x32_bf16 v[44:47], v[124:127], v[144:147], v[44:47]
    ds_read_b64_tr_b16 v[108:109], v213 offset:57344
    ds_read_b64_tr_b16 v[110:111], v213 offset:58368
    v_mfma_f32_16x16x32_bf16 v[48:51], v[128:131], v[144:147], v[48:51]
    ds_read_b64_tr_b16 v[112:113], v214 offset:57344
    ds_read_b64_tr_b16 v[114:115], v214 offset:58368
    v_mfma_f32_16x16x32_bf16 v[52:55], v[132:135], v[144:147], v[52:55]
    ds_read_b64_tr_b16 v[116:117], v215 offset:57344
    ds_read_b64_tr_b16 v[118:119], v215 offset:58368
    v_mfma_f32_16x16x32_bf16 v[68:71], v[132:135], v[148:151], v[68:71]
    buffer_load_dwordx4 v[32:35], v218, s[32:35], s67 offen offset:1024 sc1
    v_mfma_f32_16x16x32_bf16 v[64:67], v[128:131], v[148:151], v[64:67]
    buffer_load_dwordx4 v[36:39], v219, s[32:35], s67 offen offset:1024 sc1
    v_mfma_f32_16x16x32_bf16 v[60:63], v[124:127], v[148:151], v[60:63]
    v_mfma_f32_16x16x32_bf16 v[56:59], v[120:123], v[148:151], v[56:59]
    s_waitcnt vmcnt(10) lgkmcnt(0)
    v_mfma_f32_16x16x32_bf16 v[40:43], v[104:107], v[152:155], v[40:43]
    ds_read_b64_tr_b16 v[120:121], v212 offset:61440
    ds_read_b64_tr_b16 v[122:123], v212 offset:62464
    v_mfma_f32_16x16x32_bf16 v[44:47], v[108:111], v[152:155], v[44:47]
    ds_read_b64_tr_b16 v[124:125], v213 offset:61440
    ds_read_b64_tr_b16 v[126:127], v213 offset:62464
    v_mfma_f32_16x16x32_bf16 v[48:51], v[112:115], v[152:155], v[48:51]
    ds_read_b64_tr_b16 v[128:129], v214 offset:61440
    ds_read_b64_tr_b16 v[130:131], v214 offset:62464
    v_mfma_f32_16x16x32_bf16 v[52:55], v[116:119], v[152:155], v[52:55]
    ds_read_b64_tr_b16 v[132:133], v215 offset:61440
    ds_read_b64_tr_b16 v[134:135], v215 offset:62464
    v_mfma_f32_16x16x32_bf16 v[68:71], v[116:119], v[156:159], v[68:71]
    buffer_load_dwordx4 v[224:227], v218, s[32:35], s68 offen offset:1024 sc1
    v_mfma_f32_16x16x32_bf16 v[64:67], v[112:115], v[156:159], v[64:67]
    buffer_load_dwordx4 v[228:231], v219, s[32:35], s68 offen offset:1024 sc1
    v_mfma_f32_16x16x32_bf16 v[60:63], v[108:111], v[156:159], v[60:63]
    v_mfma_f32_16x16x32_bf16 v[56:59], v[104:107], v[156:159], v[56:59]
    s_waitcnt vmcnt(10) lgkmcnt(0)
    v_mfma_f32_16x16x32_bf16 v[40:43], v[120:123], v[160:163], v[40:43]
    ds_read_b64_tr_b16 v[104:105], v212 offset:0
    ds_read_b64_tr_b16 v[106:107], v212 offset:1024
    v_mfma_f32_16x16x32_bf16 v[44:47], v[124:127], v[160:163], v[44:47]
    ds_read_b64_tr_b16 v[108:109], v213 offset:0
    ds_read_b64_tr_b16 v[110:111], v213 offset:1024
    v_mfma_f32_16x16x32_bf16 v[48:51], v[128:131], v[160:163], v[48:51]
    ds_read_b64_tr_b16 v[112:113], v214 offset:0
    ds_read_b64_tr_b16 v[114:115], v214 offset:1024
    v_mfma_f32_16x16x32_bf16 v[52:55], v[132:135], v[160:163], v[52:55]
    ds_read_b64_tr_b16 v[116:117], v215 offset:0
    ds_read_b64_tr_b16 v[118:119], v215 offset:1024
    v_mfma_f32_16x16x32_bf16 v[68:71], v[132:135], v[164:167], v[68:71]
    buffer_load_dwordx4 v[232:235], v218, s[32:35], s69 offen offset:1024 sc1
    v_mfma_f32_16x16x32_bf16 v[64:67], v[128:131], v[164:167], v[64:67]
    buffer_load_dwordx4 v[236:239], v219, s[32:35], s69 offen offset:1024 sc1
    v_mfma_f32_16x16x32_bf16 v[60:63], v[124:127], v[164:167], v[60:63]
    v_mfma_f32_16x16x32_bf16 v[56:59], v[120:123], v[164:167], v[56:59]
    s_waitcnt vmcnt(10) lgkmcnt(0)
    v_mfma_f32_16x16x32_bf16 v[40:43], v[104:107], v[8:11], v[40:43]
    ds_read_b64_tr_b16 v[120:121], v212 offset:4096
    ds_read_b64_tr_b16 v[122:123], v212 offset:5120
    v_mfma_f32_16x16x32_bf16 v[44:47], v[108:111], v[8:11], v[44:47]
    ds_read_b64_tr_b16 v[124:125], v213 offset:4096
    ds_read_b64_tr_b16 v[126:127], v213 offset:5120
    v_mfma_f32_16x16x32_bf16 v[48:51], v[112:115], v[8:11], v[48:51]
    ds_read_b64_tr_b16 v[128:129], v214 offset:4096
    ds_read_b64_tr_b16 v[130:131], v214 offset:5120
    v_mfma_f32_16x16x32_bf16 v[52:55], v[116:119], v[8:11], v[52:55]
    ds_read_b64_tr_b16 v[132:133], v215 offset:4096
    ds_read_b64_tr_b16 v[134:135], v215 offset:5120
    v_mfma_f32_16x16x32_bf16 v[68:71], v[116:119], v[12:15], v[68:71]
    buffer_load_dwordx4 v[240:243], v218, s[32:35], s70 offen offset:1024 sc1
    v_mfma_f32_16x16x32_bf16 v[64:67], v[112:115], v[12:15], v[64:67]
    buffer_load_dwordx4 v[244:247], v219, s[32:35], s70 offen offset:1024 sc1
    v_mfma_f32_16x16x32_bf16 v[60:63], v[108:111], v[12:15], v[60:63]
    v_mfma_f32_16x16x32_bf16 v[56:59], v[104:107], v[12:15], v[56:59]
    s_waitcnt vmcnt(10) lgkmcnt(0)
    v_mfma_f32_16x16x32_bf16 v[40:43], v[120:123], v[16:19], v[40:43]
    ds_read_b64_tr_b16 v[104:105], v212 offset:8192
    ds_read_b64_tr_b16 v[106:107], v212 offset:9216
    v_mfma_f32_16x16x32_bf16 v[44:47], v[124:127], v[16:19], v[44:47]
    ds_read_b64_tr_b16 v[108:109], v213 offset:8192
    ds_read_b64_tr_b16 v[110:111], v213 offset:9216
    v_mfma_f32_16x16x32_bf16 v[48:51], v[128:131], v[16:19], v[48:51]
    ds_read_b64_tr_b16 v[112:113], v214 offset:8192
    ds_read_b64_tr_b16 v[114:115], v214 offset:9216
    v_mfma_f32_16x16x32_bf16 v[52:55], v[132:135], v[16:19], v[52:55]
    ds_read_b64_tr_b16 v[116:117], v215 offset:8192
    ds_read_b64_tr_b16 v[118:119], v215 offset:9216
    v_mfma_f32_16x16x32_bf16 v[68:71], v[132:135], v[20:23], v[68:71]
    buffer_load_dwordx4 v[248:251], v218, s[32:35], s71 offen offset:1024 sc1
    v_mfma_f32_16x16x32_bf16 v[64:67], v[128:131], v[20:23], v[64:67]
    buffer_load_dwordx4 v[252:255], v219, s[32:35], s71 offen offset:1024 sc1
    v_mfma_f32_16x16x32_bf16 v[60:63], v[124:127], v[20:23], v[60:63]
    v_mfma_f32_16x16x32_bf16 v[56:59], v[120:123], v[20:23], v[56:59]
    s_waitcnt vmcnt(10) lgkmcnt(0)
    v_mfma_f32_16x16x32_bf16 v[40:43], v[104:107], v[24:27], v[40:43]
    ds_read_b64_tr_b16 v[120:121], v212 offset:12288
    ds_read_b64_tr_b16 v[122:123], v212 offset:13312
    v_mfma_f32_16x16x32_bf16 v[44:47], v[108:111], v[24:27], v[44:47]
    ds_read_b64_tr_b16 v[124:125], v213 offset:12288
    ds_read_b64_tr_b16 v[126:127], v213 offset:13312
    v_mfma_f32_16x16x32_bf16 v[48:51], v[112:115], v[24:27], v[48:51]
    ds_read_b64_tr_b16 v[128:129], v214 offset:12288
    ds_read_b64_tr_b16 v[130:131], v214 offset:13312
    v_mfma_f32_16x16x32_bf16 v[52:55], v[116:119], v[24:27], v[52:55]
    ds_read_b64_tr_b16 v[132:133], v215 offset:12288
    ds_read_b64_tr_b16 v[134:135], v215 offset:13312
    v_mfma_f32_16x16x32_bf16 v[68:71], v[116:119], v[28:31], v[68:71]
    v_mfma_f32_16x16x32_bf16 v[64:67], v[112:115], v[28:31], v[64:67]
    v_mfma_f32_16x16x32_bf16 v[60:63], v[108:111], v[28:31], v[60:63]
    v_mfma_f32_16x16x32_bf16 v[56:59], v[104:107], v[28:31], v[56:59]
    v_add_u32 v212, 131072, v212
    v_add_u32 v213, 131072, v213
    v_add_u32 v214, 131072, v214
    v_add_u32 v215, 131072, v215
    s_waitcnt vmcnt(8) lgkmcnt(0)
    v_mfma_f32_16x16x32_bf16 v[40:43], v[120:123], v[32:35], v[40:43]
    ds_read_b64_tr_b16 v[104:105], v212 offset:0
    ds_read_b64_tr_b16 v[106:107], v212 offset:1024
    v_mfma_f32_16x16x32_bf16 v[44:47], v[124:127], v[32:35], v[44:47]
    ds_read_b64_tr_b16 v[108:109], v213 offset:0
    ds_read_b64_tr_b16 v[110:111], v213 offset:1024
    v_mfma_f32_16x16x32_bf16 v[48:51], v[128:131], v[32:35], v[48:51]
    ds_read_b64_tr_b16 v[112:113], v214 offset:0
    ds_read_b64_tr_b16 v[114:115], v214 offset:1024
    v_mfma_f32_16x16x32_bf16 v[52:55], v[132:135], v[32:35], v[52:55]
    ds_read_b64_tr_b16 v[116:117], v215 offset:0
    ds_read_b64_tr_b16 v[118:119], v215 offset:1024
    v_mfma_f32_16x16x32_bf16 v[68:71], v[132:135], v[36:39], v[68:71]
    v_mfma_f32_16x16x32_bf16 v[64:67], v[128:131], v[36:39], v[64:67]
    v_mfma_f32_16x16x32_bf16 v[60:63], v[124:127], v[36:39], v[60:63]
    v_mfma_f32_16x16x32_bf16 v[56:59], v[120:123], v[36:39], v[56:59]
    s_waitcnt vmcnt(6) lgkmcnt(0)
    v_mfma_f32_16x16x32_bf16 v[40:43], v[104:107], v[224:227], v[40:43]
    ds_read_b64_tr_b16 v[120:121], v212 offset:4096
    ds_read_b64_tr_b16 v[122:123], v212 offset:5120
    v_mfma_f32_16x16x32_bf16 v[44:47], v[108:111], v[224:227], v[44:47]
    ds_read_b64_tr_b16 v[124:125], v213 offset:4096
    ds_read_b64_tr_b16 v[126:127], v213 offset:5120
    v_mfma_f32_16x16x32_bf16 v[48:51], v[112:115], v[224:227], v[48:51]
    ds_read_b64_tr_b16 v[128:129], v214 offset:4096
    ds_read_b64_tr_b16 v[130:131], v214 offset:5120
    v_mfma_f32_16x16x32_bf16 v[52:55], v[116:119], v[224:227], v[52:55]
    ds_read_b64_tr_b16 v[132:133], v215 offset:4096
    ds_read_b64_tr_b16 v[134:135], v215 offset:5120
    v_mfma_f32_16x16x32_bf16 v[68:71], v[116:119], v[228:231], v[68:71]
    v_mfma_f32_16x16x32_bf16 v[64:67], v[112:115], v[228:231], v[64:67]
    v_mfma_f32_16x16x32_bf16 v[60:63], v[108:111], v[228:231], v[60:63]
    v_mfma_f32_16x16x32_bf16 v[56:59], v[104:107], v[228:231], v[56:59]
    s_waitcnt vmcnt(4) lgkmcnt(0)
    v_mfma_f32_16x16x32_bf16 v[40:43], v[120:123], v[232:235], v[40:43]
    ds_read_b64_tr_b16 v[104:105], v212 offset:8192
    ds_read_b64_tr_b16 v[106:107], v212 offset:9216
    v_mfma_f32_16x16x32_bf16 v[44:47], v[124:127], v[232:235], v[44:47]
    ds_read_b64_tr_b16 v[108:109], v213 offset:8192
    ds_read_b64_tr_b16 v[110:111], v213 offset:9216
    v_mfma_f32_16x16x32_bf16 v[48:51], v[128:131], v[232:235], v[48:51]
    ds_read_b64_tr_b16 v[112:113], v214 offset:8192
    ds_read_b64_tr_b16 v[114:115], v214 offset:9216
    v_mfma_f32_16x16x32_bf16 v[52:55], v[132:135], v[232:235], v[52:55]
    ds_read_b64_tr_b16 v[116:117], v215 offset:8192
    ds_read_b64_tr_b16 v[118:119], v215 offset:9216
    v_mfma_f32_16x16x32_bf16 v[68:71], v[132:135], v[236:239], v[68:71]
    v_mfma_f32_16x16x32_bf16 v[64:67], v[128:131], v[236:239], v[64:67]
    v_mfma_f32_16x16x32_bf16 v[60:63], v[124:127], v[236:239], v[60:63]
    v_mfma_f32_16x16x32_bf16 v[56:59], v[120:123], v[236:239], v[56:59]
    s_waitcnt vmcnt(2) lgkmcnt(0)
    v_mfma_f32_16x16x32_bf16 v[40:43], v[104:107], v[240:243], v[40:43]
    ds_read_b64_tr_b16 v[120:121], v212 offset:12288
    ds_read_b64_tr_b16 v[122:123], v212 offset:13312
    v_mfma_f32_16x16x32_bf16 v[44:47], v[108:111], v[240:243], v[44:47]
    ds_read_b64_tr_b16 v[124:125], v213 offset:12288
    ds_read_b64_tr_b16 v[126:127], v213 offset:13312
    v_mfma_f32_16x16x32_bf16 v[48:51], v[112:115], v[240:243], v[48:51]
    ds_read_b64_tr_b16 v[128:129], v214 offset:12288
    ds_read_b64_tr_b16 v[130:131], v214 offset:13312
    v_mfma_f32_16x16x32_bf16 v[52:55], v[116:119], v[240:243], v[52:55]
    ds_read_b64_tr_b16 v[132:133], v215 offset:12288
    ds_read_b64_tr_b16 v[134:135], v215 offset:13312
    v_mfma_f32_16x16x32_bf16 v[68:71], v[116:119], v[244:247], v[68:71]
    v_mfma_f32_16x16x32_bf16 v[64:67], v[112:115], v[244:247], v[64:67]
    v_mfma_f32_16x16x32_bf16 v[60:63], v[108:111], v[244:247], v[60:63]
    v_mfma_f32_16x16x32_bf16 v[56:59], v[104:107], v[244:247], v[56:59]
    s_waitcnt vmcnt(0) lgkmcnt(0)
    v_mfma_f32_16x16x32_bf16 v[40:43], v[120:123], v[248:251], v[40:43]
    v_mfma_f32_16x16x32_bf16 v[44:47], v[124:127], v[248:251], v[44:47]
    v_mfma_f32_16x16x32_bf16 v[48:51], v[128:131], v[248:251], v[48:51]
    v_mfma_f32_16x16x32_bf16 v[52:55], v[132:135], v[248:251], v[52:55]
    v_mfma_f32_16x16x32_bf16 v[68:71], v[132:135], v[252:255], v[68:71]
    v_mfma_f32_16x16x32_bf16 v[64:67], v[128:131], v[252:255], v[64:67]
    v_mfma_f32_16x16x32_bf16 v[60:63], v[124:127], v[252:255], v[60:63]
    v_mfma_f32_16x16x32_bf16 v[56:59], v[120:123], v[252:255], v[56:59]
    s_branch Lproj_e
Lproj_y:
    s_setprio 1
    s_cmp_eq_u32 s41, 1
    s_cbranch_scc1 Learly
    s_mov_b32 s82, 0
    s_xor_b32 s24, s40, 0
    s_cmp_lg_u32 s82, -1
    s_cbranch_scc1 Lpolly0
Lpolly0_r:
    buffer_load_dwordx4 v[72:75], v216, s[32:35], s64 offen offset:0 sc1
    buffer_load_dwordx4 v[76:79], v217, s[32:35], s64 offen offset:0 sc1
    buffer_load_dwordx4 v[80:83], v216, s[32:35], s65 offen offset:0 sc1
    buffer_load_dwordx4 v[84:87], v217, s[32:35], s65 offen offset:0 sc1
    buffer_load_dwordx4 v[88:91], v216, s[32:35], s66 offen offset:0 sc1
    buffer_load_dwordx4 v[92:95], v217, s[32:35], s66 offen offset:0 sc1
    buffer_load_dwordx4 v[96:99], v216, s[32:35], s67 offen offset:0 sc1
    buffer_load_dwordx4 v[100:103], v217, s[32:35], s67 offen offset:0 sc1
Learly:
    buffer_load_dwordx4 v[136:139], v216, s[32:35], s68 offen offset:0 sc1
    buffer_load_dwordx4 v[140:143], v217, s[32:35], s68 offen offset:0 sc1
    ds_read_b64_tr_b16 v[104:105], v212 offset:0
    ds_read_b64_tr_b16 v[106:107], v212 offset:1024
    ds_read_b64_tr_b16 v[108:109], v213 offset:0
    ds_read_b64_tr_b16 v[110:111], v213 offset:1024
    ds_read_b64_tr_b16 v[112:113], v214 offset:0
    ds_read_b64_tr_b16 v[114:115], v214 offset:1024
    ds_read_b64_tr_b16 v[116:117], v215 offset:0
    ds_read_b64_tr_b16 v[118:119], v215 offset:1024
    s_cmp_eq_u32 s41, 1
    s_cbranch_scc1 Lw0a
    s_waitcnt vmcnt(8)
Lw0a:
    s_waitcnt vmcnt(12) lgkmcnt(0)
    v_mfma_f32_16x16x32_bf16 v[40:43], v[104:107], v[72:75], 0
    ds_read_b64_tr_b16 v[120:121], v212 offset:4096
    ds_read_b64_tr_b16 v[122:123], v212 offset:5120
    v_mfma_f32_16x16x32_bf16 v[44:47], v[108:111], v[72:75], 0
    ds_read_b64_tr_b16 v[124:125], v213 offset:4096
    ds_read_b64_tr_b16 v[126:127], v213 offset:5120
    v_mfma_f32_16x16x32_bf16 v[48:51], v[112:115], v[72:75], 0
    ds_read_b64_tr_b16 v[128:129], v214 offset:4096
    ds_read_b64_tr_b16 v[130:131], v214 offset:5120
    v_mfma_f32_16x16x32_bf16 v[52:55], v[116:119], v[72:75], 0
    ds_read_b64_tr_b16 v[132:133], v215 offset:4096
    ds_read_b64_tr_b16 v[134:135], v215 offset:5120
    v_mfma_f32_16x16x32_bf16 v[68:71], v[116:119], v[76:79], 0
    buffer_load_dwordx4 v[144:147], v216, s[32:35], s69 offen offset:0 sc1
    v_mfma_f32_16x16x32_bf16 v[64:67], v[112:115], v[76:79], 0
    buffer_load_dwordx4 v[148:151], v217, s[32:35], s69 offen offset:0 sc1
    s_xor_b32 s24, s40, 128
    buffer_load_dwordx2 v[200:201], v202, s[8:11], s24 offen sc1
    v_mfma_f32_16x16x32_bf16 v[60:63], v[108:111], v[76:79], 0
    v_mfma_f32_16x16x32_bf16 v[56:59], v[104:107], v[76:79], 0
    s_cmp_eq_u32 s41, 1
    s_cbranch_scc1 Lw1a
    s_waitcnt vmcnt(8)
Lw1a:
    s_waitcnt vmcnt(12) lgkmcnt(0)
    v_mfma_f32_16x16x32_bf16 v[40:43], v[120:123], v[80:83], v[40:43]
    ds_read_b64_tr_b16 v[104:105], v212 offset:8192
    ds_read_b64_tr_b16 v[106:107], v212 offset:9216
    v_mfma_f32_16x16x32_bf16 v[44:47], v[124:127], v[80:83], v[44:47]
    ds_read_b64_tr_b16 v[108:109], v213 offset:8192
    ds_read_b64_tr_b16 v[110:111], v213 offset:9216
    v_mfma_f32_16x16x32_bf16 v[48:51], v[128:131], v[80:83], v[48:51]
    ds_read_b64_tr_b16 v[112:113], v214 offset:8192
    ds_read_b64_tr_b16 v[114:115], v214 offset:9216
    v_mfma_f32_16x16x32_bf16 v[52:55], v[132:135], v[80:83], v[52:55]
    ds_read_b64_tr_b16 v[116:117], v215 offset:8192
    ds_read_b64_tr_b16 v[118:119], v215 offset:9216
    v_mfma_f32_16x16x32_bf16 v[68:71], v[132:135], v[84:87], v[68:71]
    buffer_load_dwordx4 v[152:155], v216, s[32:35], s70 offen offset:0 sc1
    v_mfma_f32_16x16x32_bf16 v[64:67], v[128:131], v[84:87], v[64:67]
    buffer_load_dwordx4 v[156:159], v217, s[32:35], s70 offen offset:0 sc1
    v_mfma_f32_16x16x32_bf16 v[60:63], v[124:127], v[84:87], v[60:63]
    v_mfma_f32_16x16x32_bf16 v[56:59], v[120:123], v[84:87], v[56:59]
    s_cmp_eq_u32 s41, 1
    s_cbranch_scc1 Lw2a
    s_waitcnt vmcnt(8)
Lw2a:
    s_waitcnt vmcnt(12) lgkmcnt(0)
    s_waitcnt vmcnt(6)
    s_mov_b64 exec, 1
    buffer_store_dwordx2 v[222:223], v220, s[8:11], 0 offen sc1
    s_mov_b64 exec, -1
    v_mfma_f32_16x16x32_bf16 v[40:43], v[104:107], v[88:91], v[40:43]
    ds_read_b64_tr_b16 v[120:121], v212 offset:12288
    ds_read_b64_tr_b16 v[122:123], v212 offset:13312
    v_mfma_f32_16x16x32_bf16 v[44:47], v[108:111], v[88:91], v[44:47]
    ds_read_b64_tr_b16 v[124:125], v213 offset:12288
    ds_read_b64_tr_b16 v[126:127], v213 offset:13312
    v_mfma_f32_16x16x32_bf16 v[48:51], v[112:115], v[88:91], v[48:51]
    ds_read_b64_tr_b16 v[128:129], v214 offset:12288
    ds_read_b64_tr_b16 v[130:131], v214 offset:13312
    v_mfma_f32_16x16x32_bf16 v[52:55], v[116:119], v[88:91], v[52:55]
    ds_read_b64_tr_b16 v[132:133], v215 offset:12288
    ds_read_b64_tr_b16 v[134:135], v215 offset:13312
    v_mfma_f32_16x16x32_bf16 v[68:71], v[116:119], v[92:95], v[68:71]
    buffer_load_dwordx4 v[160:163], v216, s[32:35], s71 offen offset:0 sc1
    v_mfma_f32_16x16x32_bf16 v[64:67], v[112:115], v[92:95], v[64:67]
    buffer_load_dwordx4 v[164:167], v217, s[32:35], s71 offen offset:0 sc1
    v_mfma_f32_16x16x32_bf16 v[60:63], v[108:111], v[92:95], v[60:63]
    v_mfma_f32_16x16x32_bf16 v[56:59], v[104:107], v[92:95], v[56:59]
    s_cmp_eq_u32 s41, 1
    s_cbranch_scc1 Lw3a
    s_waitcnt vmcnt(8)
Lw3a:
    s_waitcnt vmcnt(12) lgkmcnt(0)
    v_mfma_f32_16x16x32_bf16 v[40:43], v[120:123], v[96:99], v[40:43]
    ds_read_b64_tr_b16 v[104:105], v212 offset:16384
    ds_read_b64_tr_b16 v[106:107], v212 offset:17408
    v_mfma_f32_16x16x32_bf16 v[44:47], v[124:127], v[96:99], v[44:47]
    ds_read_b64_tr_b16 v[108:109], v213 offset:16384
    ds_read_b64_tr_b16 v[110:111], v213 offset:17408
    v_mfma_f32_16x16x32_bf16 v[48:51], v[128:131], v[96:99], v[48:51]
    ds_read_b64_tr_b16 v[112:113], v214 offset:16384
    ds_read_b64_tr_b16 v[114:115], v214 offset:17408
    v_mfma_f32_16x16x32_bf16 v[52:55], v[132:135], v[96:99], v[52:55]
    ds_read_b64_tr_b16 v[116:117], v215 offset:16384
    ds_read_b64_tr_b16 v[118:119], v215 offset:17408
    v_mfma_f32_16x16x32_bf16 v[68:71], v[132:135], v[100:103], v[68:71]
    s_waitcnt vmcnt(4)
    v_cmp_eq_u64 s[82:83], s[80:81], v[200:201]
    s_nop 0
    s_cmp_lg_u32 s82, -1
    s_cbranch_scc1 Lpolly1
Lpolly1_r:
    buffer_load_dwordx4 v[8:11], v218, s[32:35], s64 offen offset:0 sc1
    v_mfma_f32_16x16x32_bf16 v[64:67], v[128:131], v[100:103], v[64:67]
    buffer_load_dwordx4 v[12:15], v219, s[32:35], s64 offen offset:0 sc1
    v_mfma_f32_16x16x32_bf16 v[60:63], v[124:127], v[100:103], v[60:63]
    v_mfma_f32_16x16x32_bf16 v[56:59], v[120:123], v[100:103], v[56:59]
    s_waitcnt vmcnt(8) lgkmcnt(0)
    v_mfma_f32_16x16x32_bf16 v[40:43], v[104:107], v[136:139], v[40:43]
    ds_read_b64_tr_b16 v[120:121], v212 offset:20480
    ds_read_b64_tr_b16 v[122:123], v212 offset:21504
    v_mfma_f32_16x16x32_bf16 v[44:47], v[108:111], v[136:139], v[44:47]
    ds_read_b64_tr_b16 v[124:125], v213 offset:20480
    ds_read_b64_tr_b16 v[126:127], v213 offset:21504
    v_mfma_f32_16x16x32_bf16 v[48:51], v[112:115], v[136:139], v[48:51]
    ds_read_b64_tr_b16 v[128:129], v214 offset:20480
    ds_read_b64_tr_b16 v[130:131], v214 offset:21504
    v_mfma_f32_16x16x32_bf16 v[52:55], v[116:119], v[136:139], v[52:55]
    ds_read_b64_tr_b16 v[132:133], v215 offset:20480
    ds_read_b64_tr_b16 v[134:135], v215 offset:21504
    v_mfma_f32_16x16x32_bf16 v[68:71], v[116:119], v[140:143], v[68:71]
    buffer_load_dwordx4 v[16:19], v218, s[32:35], s65 offen offset:0 sc1
    v_mfma_f32_16x16x32_bf16 v[64:67], v[112:115], v[140:143], v[64:67]
    buffer_load_dwordx4 v[20:23], v219, s[32:35], s65 offen offset:0 sc1
    v_mfma_f32_16x16x32_bf16 v[60:63], v[108:111], v[140:143], v[60:63]
    v_mfma_f32_16x16x32_bf16 v[56:59], v[104:107], v[140:143], v[56:59]
    s_waitcnt vmcnt(8) lgkmcnt(0)
    v_mfma_f32_16x16x32_bf16 v[40:43], v[120:123], v[144:147], v[40:43]
    ds_read_b64_tr_b16 v[104:105], v212 offset:24576
    ds_read_b64_tr_b16 v[106:107], v212 offset:25600
    s_barrier
    v_mfma_f32_16x16x32_bf16 v[44:47], v[124:127], v[144:147], v[44:47]
    ds_read_b64_tr_b16 v[108:109], v213 offset:24576
    ds_read_b64_tr_b16 v[110:111], v213 offset:25600
    v_mfma_f32_16x16x32_bf16 v[48:51], v[128:131], v[144:147], v[48:51]
    ds_read_b64_tr_b16 v[112:113], v214 offset:24576
    ds_read_b64_tr_b16 v[114:115], v214 offset:25600
    v_mfma_f32_16x16x32_bf16 v[52:55], v[132:135], v[144:147], v[52:55]
    ds_read_b64_tr_b16 v[116:117], v215 offset:24576
    ds_read_b64_tr_b16 v[118:119], v215 offset:25600
    v_mfma_f32_16x16x32_bf16 v[68:71], v[132:135], v[148:151], v[68:71]
    buffer_load_dwordx4 v[24:27], v218, s[32:35], s66 offen offset:0 sc1
    v_mfma_f32_16x16x32_bf16 v[64:67], v[128:131], v[148:151], v[64:67]
    buffer_load_dwordx4 v[28:31], v219, s[32:35], s66 offen offset:0 sc1
    v_mfma_f32_16x16x32_bf16 v[60:63], v[124:127], v[148:151], v[60:63]
    v_mfma_f32_16x16x32_bf16 v[56:59], v[120:123], v[148:151], v[56:59]
    s_waitcnt vmcnt(8) lgkmcnt(0)
    v_mfma_f32_16x16x32_bf16 v[40:43], v[104:107], v[152:155], v[40:43]
    ds_read_b64_tr_b16 v[120:121], v212 offset:28672
    ds_read_b64_tr_b16 v[122:123], v212 offset:29696
    v_mfma_f32_16x16x32_bf16 v[44:47], v[108:111], v[152:155], v[44:47]
    ds_read_b64_tr_b16 v[124:125], v213 offset:28672
    ds_read_b64_tr_b16 v[126:127], v213 offset:29696
    v_mfma_f32_16x16x32_bf16 v[48:51], v[112:115], v[152:155], v[48:51]
    ds_read_b64_tr_b16 v[128:129], v214 offset:28672
    ds_read_b64_tr_b16 v[130:131], v214 offset:29696
    v_mfma_f32_16x16x32_bf16 v[52:55], v[116:119], v[152:155], v[52:55]
    ds_read_b64_tr_b16 v[132:133], v215 offset:28672
    ds_read_b64_tr_b16 v[134:135], v215 offset:29696
    v_mfma_f32_16x16x32_bf16 v[68:71], v[116:119], v[156:159], v[68:71]
    buffer_load_dwordx4 v[32:35], v218, s[32:35], s67 offen offset:0 sc1
    v_mfma_f32_16x16x32_bf16 v[64:67], v[112:115], v[156:159], v[64:67]
    buffer_load_dwordx4 v[36:39], v219, s[32:35], s67 offen offset:0 sc1
    v_mfma_f32_16x16x32_bf16 v[60:63], v[108:111], v[156:159], v[60:63]
    v_mfma_f32_16x16x32_bf16 v[56:59], v[104:107], v[156:159], v[56:59]
    s_waitcnt vmcnt(8) lgkmcnt(0)
    v_mfma_f32_16x16x32_bf16 v[40:43], v[120:123], v[160:163], v[40:43]
    ds_read_b64_tr_b16 v[104:105], v212 offset:32768
    ds_read_b64_tr_b16 v[106:107], v212 offset:33792
    v_mfma_f32_16x16x32_bf16 v[44:47], v[124:127], v[160:163], v[44:47]
    ds_read_b64_tr_b16 v[108:109], v213 offset:32768
    ds_read_b64_tr_b16 v[110:111], v213 offset:33792
    v_mfma_f32_16x16x32_bf16 v[48:51], v[128:131], v[160:163], v[48:51]
    ds_read_b64_tr_b16 v[112:113], v214 offset:32768
    ds_read_b64_tr_b16 v[114:115], v214 offset:33792
    v_mfma_f32_16x16x32_bf16 v[52:55], v[132:135], v[160:163], v[52:55]
    ds_read_b64_tr_b16 v[116:117], v215 offset:32768
    ds_read_b64_tr_b16 v[118:119], v215 offset:33792
    v_mfma_f32_16x16x32_bf16 v[68:71], v[132:135], v[164:167], v[68:71]
    buffer_load_dwordx4 v[224:227], v218, s[32:35], s68 offen offset:0 sc1
    v_mfma_f32_16x16x32_bf16 v[64:67], v[128:131], v[164:167], v[64:67]
    buffer_load_dwordx4 v[228:231], v219, s[32:35], s68 offen offset:0 sc1
    v_mfma_f32_16x16x32_bf16 v[60:63], v[124:127], v[164:167], v[60:63]
    v_mfma_f32_16x16x32_bf16 v[56:59], v[120:123], v[164:167], v[56:59]
    s_waitcnt vmcnt(8) lgkmcnt(0)
    v_mfma_f32_16x16x32_bf16 v[40:43], v[104:107], v[8:11], v[40:43]
    ds_read_b64_tr_b16 v[120:121], v212 offset:36864
    ds_read_b64_tr_b16 v[122:123], v212 offset:37888
    v_mfma_f32_16x16x32_bf16 v[44:47], v[108:111], v[8:11], v[44:47]
    ds_read_b64_tr_b16 v[124:125], v213 offset:36864
    ds_read_b64_tr_b16 v[126:127], v213 offset:37888
    v_mfma_f32_16x16x32_bf16 v[48:51], v[112:115], v[8:11], v[48:51]
    ds_read_b64_tr_b16 v[128:129], v214 offset:36864
    ds_read_b64_tr_b16 v[130:131], v214 offset:37888
    v_mfma_f32_16x16x32_bf16 v[52:55], v[116:119], v[8:11], v[52:55]
    ds_read_b64_tr_b16 v[132:133], v215 offset:36864
    ds_read_b64_tr_b16 v[134:135], v215 offset:37888
    v_mfma_f32_16x16x32_bf16 v[68:71], v[116:119], v[12:15], v[68:71]
    buffer_load_dwordx4 v[232:235], v218, s[32:35], s69 offen offset:0 sc1
    v_mfma_f32_16x16x32_bf16 v[64:67], v[112:115], v[12:15], v[64:67]
    buffer_load_dwordx4 v[236:239], v219, s[32:35], s69 offen offset:0 sc1
    s_xor_b32 s24, s40, 256
    buffer_load_dwordx2 v[200:201], v202, s[8:11], s24 offen sc1
    v_mfma_f32_16x16x32_bf16 v[60:63], v[108:111], v[12:15], v[60:63]
    v_mfma_f32_16x16x32_bf16 v[56:59], v[104:107], v[12:15], v[56:59]
    s_waitcnt vmcnt(8) lgkmcnt(0)
    v_mfma_f32_16x16x32_bf16 v[40:43], v[120:123], v[16:19], v[40:43]
    ds_read_b64_tr_b16 v[104:105], v212 offset:40960
    ds_read_b64_tr_b16 v[106:107], v212 offset:41984
    v_mfma_f32_16x16x32_bf16 v[44:47], v[124:127], v[16:19], v[44:47]
    ds_read_b64_tr_b16 v[108:109], v213 offset:40960
    ds_read_b64_tr_b16 v[110:111], v213 offset:41984
    v_mfma_f32_16x16x32_bf16 v[48:51], v[128:131], v[16:19], v[48:51]
    ds_read_b64_tr_b16 v[112:113], v214 offset:40960
    ds_read_b64_tr_b16 v[114:115], v214 offset:41984
    v_mfma_f32_16x16x32_bf16 v[52:55], v[132:135], v[16:19], v[52:55]
    ds_read_b64_tr_b16 v[116:117], v215 offset:40960
    ds_read_b64_tr_b16 v[118:119], v215 offset:41984
    v_mfma_f32_16x16x32_bf16 v[68:71], v[132:135], v[20:23], v[68:71]
    buffer_load_dwordx4 v[240:243], v218, s[32:35], s70 offen offset:0 sc1
    v_mfma_f32_16x16x32_bf16 v[64:67], v[128:131], v[20:23], v[64:67]
    buffer_load_dwordx4 v[244:247], v219, s[32:35], s70 offen offset:0 sc1
    v_mfma_f32_16x16x32_bf16 v[60:63], v[124:127], v[20:23], v[60:63]
    v_mfma_f32_16x16x32_bf16 v[56:59], v[120:123], v[20:23], v[56:59]
    s_waitcnt vmcnt(8) lgkmcnt(0)
    v_mfma_f32_16x16x32_bf16 v[40:43], v[104:107], v[24:27], v[40:43]
    ds_read_b64_tr_b16 v[120:121], v212 offset:45056
    ds_read_b64_tr_b16 v[122:123], v212 offset:46080
    v_mfma_f32_16x16x32_bf16 v[44:47], v[108:111], v[24:27], v[44:47]
    ds_read_b64_tr_b16 v[124:125], v213 offset:45056
    ds_read_b64_tr_b16 v[126:127], v213 offset:46080
    v_mfma_f32_16x16x32_bf16 v[48:51], v[112:115], v[24:27], v[48:51]
    ds_read_b64_tr_b16 v[128:129], v214 offset:45056
    ds_read_b64_tr_b16 v[130:131], v214 offset:46080
    v_mfma_f32_16x16x32_bf16 v[52:55], v[116:119], v[24:27], v[52:55]
    ds_read_b64_tr_b16 v[132:133], v215 offset:45056
    ds_read_b64_tr_b16 v[134:135], v215 offset:46080
    v_mfma_f32_16x16x32_bf16 v[68:71], v[116:119], v[28:31], v[68:71]
    buffer_load_dwordx4 v[248:251], v218, s[32:35], s71 offen offset:0 sc1
    v_mfma_f32_16x16x32_bf16 v[64:67], v[112:115], v[28:31], v[64:67]
    buffer_load_dwordx4 v[252:255], v219, s[32:35], s71 offen offset:0 sc1
    v_mfma_f32_16x16x32_bf16 v[60:63], v[108:111], v[28:31], v[60:63]
    v_mfma_f32_16x16x32_bf16 v[56:59], v[104:107], v[28:31], v[56:59]
    s_waitcnt vmcnt(8) lgkmcnt(0)
    v_mfma_f32_16x16x32_bf16 v[40:43], v[120:123], v[32:35], v[40:43]
    ds_read_b64_tr_b16 v[104:105], v212 offset:49152
    ds_read_b64_tr_b16 v[106:107], v212 offset:50176
    v_mfma_f32_16x16x32_bf16 v[44:47], v[124:127], v[32:35], v[44:47]
    ds_read_b64_tr_b16 v[108:109], v213 offset:49152
    ds_read_b64_tr_b16 v[110:111], v213 offset:50176
    v_mfma_f32_16x16x32_bf16 v[48:51], v[128:131], v[32:35], v[48:51]
    ds_read_b64_tr_b16 v[112:113], v214 offset:49152
    ds_read_b64_tr_b16 v[114:115], v214 offset:50176
    v_mfma_f32_16x16x32_bf16 v[52:55], v[132:135], v[32:35], v[52:55]
    ds_read_b64_tr_b16 v[116:117], v215 offset:49152
    ds_read_b64_tr_b16 v[118:119], v215 offset:50176
    v_mfma_f32_16x16x32_bf16 v[68:71], v[132:135], v[36:39], v[68:71]
    s_waitcnt vmcnt(4)
    v_cmp_eq_u64 s[82:83], s[80:81], v[200:201]
    s_nop 0
    s_cmp_lg_u32 s82, -1
    s_cbranch_scc1 Lpolly2
Lpolly2_r:
    buffer_load_dwordx4 v[72:75], v216, s[32:35], s64 offen offset:1024 sc1
    v_mfma_f32_16x16x32_bf16 v[64:67], v[128:131], v[36:39], v[64:67]
    buffer_load_dwordx4 v[76:79], v217, s[32:35], s64 offen offset:1024 sc1
    v_mfma_f32_16x16x32_bf16 v[60:63], v[124:127], v[36:39], v[60:63]
    v_mfma_f32_16x16x32_bf16 v[56:59], v[120:123], v[36:39], v[56:59]
    s_waitcnt vmcnt(8) lgkmcnt(0)
    v_mfma_f32_16x16x32_bf16 v[40:43], v[104:107], v[224:227], v[40:43]
    ds_read_b64_tr_b16 v[120:121], v212 offset:53248
    ds_read_b64_tr_b16 v[122:123], v212 offset:54272
    v_mfma_f32_16x16x32_bf16 v[44:47], v[108:111], v[224:227], v[44:47]
    ds_read_b64_tr_b16 v[124:125], v213 offset:53248
    ds_read_b64_tr_b16 v[126:127], v213 offset:54272
    v_mfma_f32_16x16x32_bf16 v[48:51], v[112:115], v[224:227], v[48:51]
    ds_read_b64_tr_b16 v[128:129], v214 offset:53248
    ds_read_b64_tr_b16 v[130:131], v214 offset:54272
    v_mfma_f32_16x16x32_bf16 v[52:55], v[116:119], v[224:227], v[52:55]
    ds_read_b64_tr_b16 v[132:133], v215 offset:53248
    ds_read_b64_tr_b16 v[134:135], v215 offset:54272
    v_mfma_f32_16x16x32_bf16 v[68:71], v[116:119], v[228:231], v[68:71]
    buffer_load_dwordx4 v[80:83], v216, s[32:35], s65 offen offset:1024 sc1
    v_mfma_f32_16x16x32_bf16 v[64:67], v[112:115], v[228:231], v[64:67]
    buffer_load_dwordx4 v[84:87], v217, s[32:35], s65 offen offset:1024 sc1
    v_mfma_f32_16x16x32_bf16 v[60:63], v[108:111], v[228:231], v[60:63]
    v_mfma_f32_16x16x32_bf16 v[56:59], v[104:107], v[228:231], v[56:59]
    s_waitcnt vmcnt(8) lgkmcnt(0)
    v_mfma_f32_16x16x32_bf16 v[40:43], v[120:123], v[232:235], v[40:43]
    ds_read_b64_tr_b16 v[104:105], v212 offset:57344
    ds_read_b64_tr_b16 v[106:107], v212 offset:58368
    v_mfma_f32_16x16x32_bf16 v[44:47], v[124:127], v[232:235], v[44:47]
    ds_read_b64_tr_b16 v[108:109], v213 offset:57344
    ds_read_b64_tr_b16 v[110:111], v213 offset:58368
    v_mfma_f32_16x16x32_bf16 v[48:51], v[128:131], v[232:235], v[48:51]
    ds_read_b64_tr_b16 v[112:113], v214 offset:57344
    ds_read_b64_tr_b16 v[114:115], v214 offset:58368
    v_mfma_f32_16x16x32_bf16 v[52:55], v[132:135], v[232:235], v[52:55]
    ds_read_b64_tr_b16 v[116:117], v215 offset:57344
    ds_read_b64_tr_b16 v[118:119], v215 offset:58368
    v_mfma_f32_16x16x32_bf16 v[68:71], v[132:135], v[236:239], v[68:71]
    buffer_load_dwordx4 v[88:91], v216, s[32:35], s66 offen offset:1024 sc1
    v_mfma_f32_16x16x32_bf16 v[64:67], v[128:131], v[236:239], v[64:67]
    buffer_load_dwordx4 v[92:95], v217, s[32:35], s66 offen offset:1024 sc1
    v_mfma_f32_16x16x32_bf16 v[60:63], v[124:127], v[236:239], v[60:63]
    v_mfma_f32_16x16x32_bf16 v[56:59], v[120:123], v[236:239], v[56:59]
    s_waitcnt vmcnt(8) lgkmcnt(0)
    v_mfma_f32_16x16x32_bf16 v[40:43], v[104:107], v[240:243], v[40:43]
    ds_read_b64_tr_b16 v[120:121], v212 offset:61440
    ds_read_b64_tr_b16 v[122:123], v212 offset:62464
    v_mfma_f32_16x16x32_bf16 v[44:47], v[108:111], v[240:243], v[44:47]
    ds_read_b64_tr_b16 v[124:125], v213 offset:61440
    ds_read_b64_tr_b16 v[126:127], v213 offset:62464
    v_mfma_f32_16x16x32_bf16 v[48:51], v[112:115], v[240:243], v[48:51]
    ds_read_b64_tr_b16 v[128:129], v214 offset:61440
    ds_read_b64_tr_b16 v[130:131], v214 offset:62464
    v_mfma_f32_16x16x32_bf16 v[52:55], v[116:119], v[240:243], v[52:55]
    ds_read_b64_tr_b16 v[132:133], v215 offset:61440
    ds_read_b64_tr_b16 v[134:135], v215 offset:62464
    v_mfma_f32_16x16x32_bf16 v[68:71], v[116:119], v[244:247], v[68:71]
    buffer_load_dwordx4 v[96:99], v216, s[32:35], s67 offen offset:1024 sc1
    v_mfma_f32_16x16x32_bf16 v[64:67], v[112:115], v[244:247], v[64:67]
    buffer_load_dwordx4 v[100:103], v217, s[32:35], s67 offen offset:1024 sc1
    v_mfma_f32_16x16x32_bf16 v[60:63], v[108:111], v[244:247], v[60:63]
    v_mfma_f32_16x16x32_bf16 v[56:59], v[104:107], v[244:247], v[56:59]
    v_add_u32 v212, 4294901760, v212
    v_add_u32 v213, 4294901760, v213
    v_add_u32 v214, 4294901760, v214
    v_add_u32 v215, 4294901760, v215
    s_waitcnt vmcnt(8) lgkmcnt(0)
    v_mfma_f32_16x16x32_bf16 v[40:43], v[120:123], v[248:251], v[40:43]
    ds_read_b64_tr_b16 v[104:105], v212 offset:32768
    ds_read_b64_tr_b16 v[106:107], v212 offset:33792
    v_mfma_f32_16x16x32_bf16 v[44:47], v[124:127], v[248:251], v[44:47]
    ds_read_b64_tr_b16 v[108:109], v213 offset:32768
    ds_read_b64_tr_b16 v[110:111], v213 offset:33792
    v_mfma_f32_16x16x32_bf16 v[48:51], v[128:131], v[248:251], v[48:51]
    ds_read_b64_tr_b16 v[112:113], v214 offset:32768
    ds_read_b64_tr_b16 v[114:115], v214 offset:33792
    v_mfma_f32_16x16x32_bf16 v[52:55], v[132:135], v[248:251], v[52:55]
    ds_read_b64_tr_b16 v[116:117], v215 offset:32768
    ds_read_b64_tr_b16 v[118:119], v215 offset:33792
    v_mfma_f32_16x16x32_bf16 v[68:71], v[132:135], v[252:255], v[68:71]
    buffer_load_dwordx4 v[136:139], v216, s[32:35], s68 offen offset:1024 sc1
    v_mfma_f32_16x16x32_bf16 v[64:67], v[128:131], v[252:255], v[64:67]
    buffer_load_dwordx4 v[140:143], v217, s[32:35], s68 offen offset:1024 sc1
    v_mfma_f32_16x16x32_bf16 v[60:63], v[124:127], v[252:255], v[60:63]
    v_mfma_f32_16x16x32_bf16 v[56:59], v[120:123], v[252:255], v[56:59]
    s_waitcnt vmcnt(8) lgkmcnt(0)
    v_mfma_f32_16x16x32_bf16 v[40:43], v[104:107], v[72:75], v[40:43]
    ds_read_b64_tr_b16 v[120:121], v212 offset:36864
    ds_read_b64_tr_b16 v[122:123], v212 offset:37888
    v_mfma_f32_16x16x32_bf16 v[44:47], v[108:111], v[72:75], v[44:47]
    ds_read_b64_tr_b16 v[124:125], v213 offset:36864
    ds_read_b64_tr_b16 v[126:127], v213 offset:37888
    v_mfma_f32_16x16x32_bf16 v[48:51], v[112:115], v[72:75], v[48:51]
    ds_read_b64_tr_b16 v[128:129], v214 offset:36864
    ds_read_b64_tr_b16 v[130:131], v214 offset:37888
    v_mfma_f32_16x16x32_bf16 v[52:55], v[116:119], v[72:75], v[52:55]
    ds_read_b64_tr_b16 v[132:133], v215 offset:36864
    ds_read_b64_tr_b16 v[134:135], v215 offset:37888
    v_mfma_f32_16x16x32_bf16 v[68:71], v[116:119], v[76:79], v[68:71]
    buffer_load_dwordx4 v[144:147], v216, s[32:35], s69 offen offset:1024 sc1
    v_mfma_f32_16x16x32_bf16 v[64:67], v[112:115], v[76:79], v[64:67]
    buffer_load_dwordx4 v[148:151], v217, s[32:35], s69 offen offset:1024 sc1
    s_xor_b32 s24, s40, 384
    buffer_load_dwordx2 v[200:201], v202, s[8:11], s24 offen sc1
    v_mfma_f32_16x16x32_bf16 v[60:63], v[108:111], v[76:79], v[60:63]
    v_mfma_f32_16x16x32_bf16 v[56:59], v[104:107], v[76:79], v[56:59]
    s_waitcnt vmcnt(8) lgkmcnt(0)
    v_mfma_f32_16x16x32_bf16 v[40:43], v[120:123], v[80:83], v[40:43]
    ds_read_b64_tr_b16 v[104:105], v212 offset:40960
    ds_read_b64_tr_b16 v[106:107], v212 offset:41984
    v_mfma_f32_16x16x32_bf16 v[44:47], v[124:127], v[80:83], v[44:47]
    ds_read_b64_tr_b16 v[108:109], v213 offset:40960
    ds_read_b64_tr_b16 v[110:111], v213 offset:41984
    v_mfma_f32_16x16x32_bf16 v[48:51], v[128:131], v[80:83], v[48:51]
    ds_read_b64_tr_b16 v[112:113], v214 offset:40960
    ds_read_b64_tr_b16 v[114:115], v214 offset:41984
    v_mfma_f32_16x16x32_bf16 v[52:55], v[132:135], v[80:83], v[52:55]
    ds_read_b64_tr_b16 v[116:117], v215 offset:40960
    ds_read_b64_tr_b16 v[118:119], v215 offset:41984
    v_mfma_f32_16x16x32_bf16 v[68:71], v[132:135], v[84:87], v[68:71]
    buffer_load_dwordx4 v[152:155], v216, s[32:35], s70 offen offset:1024 sc1
    v_mfma_f32_16x16x32_bf16 v[64:67], v[128:131], v[84:87], v[64:67]
    buffer_load_dwordx4 v[156:159], v217, s[32:35], s70 offen offset:1024 sc1
    v_mfma_f32_16x16x32_bf16 v[60:63], v[124:127], v[84:87], v[60:63]
    v_mfma_f32_16x16x32_bf16 v[56:59], v[120:123], v[84:87], v[56:59]
    s_waitcnt vmcnt(8) lgkmcnt(0)
    v_mfma_f32_16x16x32_bf16 v[40:43], v[104:107], v[88:91], v[40:43]
    ds_read_b64_tr_b16 v[120:121], v212 offset:45056
    ds_read_b64_tr_b16 v[122:123], v212 offset:46080
    v_mfma_f32_16x16x32_bf16 v[44:47], v[108:111], v[88:91], v[44:47]
    ds_read_b64_tr_b16 v[124:125], v213 offset:45056
    ds_read_b64_tr_b16 v[126:127], v213 offset:46080
    v_mfma_f32_16x16x32_bf16 v[48:51], v[112:115], v[88:91], v[48:51]
    ds_read_b64_tr_b16 v[128:129], v214 offset:45056
    ds_read_b64_tr_b16 v[130:131], v214 offset:46080
    v_mfma_f32_16x16x32_bf16 v[52:55], v[116:119], v[88:91], v[52:55]
    ds_read_b64_tr_b16 v[132:133], v215 offset:45056
    ds_read_b64_tr_b16 v[134:135], v215 offset:46080
    v_mfma_f32_16x16x32_bf16 v[68:71], v[116:119], v[92:95], v[68:71]
    buffer_load_dwordx4 v[160:163], v216, s[32:35], s71 offen offset:1024 sc1
    v_mfma_f32_16x16x32_bf16 v[64:67], v[112:115], v[92:95], v[64:67]
    buffer_load_dwordx4 v[164:167], v217, s[32:35], s71 offen offset:1024 sc1
    v_mfma_f32_16x16x32_bf16 v[60:63], v[108:111], v[92:95], v[60:63]
    v_mfma_f32_16x16x32_bf16 v[56:59], v[104:107], v[92:95], v[56:59]
    s_waitcnt vmcnt(8) lgkmcnt(0)
    v_mfma_f32_16x16x32_bf16 v[40:43], v[120:123], v[96:99], v[40:43]
    ds_read_b64_tr_b16 v[104:105], v212 offset:49152
    ds_read_b64_tr_b16 v[106:107], v212 offset:50176
    v_mfma_f32_16x16x32_bf16 v[44:47], v[124:127], v[96:99], v[44:47]
    ds_read_b64_tr_b16 v[108:109], v213 offset:49152
    ds_read_b64_tr_b16 v[110:111], v213 offset:50176
    v_mfma_f32_16x16x32_bf16 v[48:51], v[128:131], v[96:99], v[48:51]
    ds_read_b64_tr_b16 v[112:113], v214 offset:49152
    ds_read_b64_tr_b16 v[114:115], v214 offset:50176
    v_mfma_f32_16x16x32_bf16 v[52:55], v[132:135], v[96:99], v[52:55]
    ds_read_b64_tr_b16 v[116:117], v215 offset:49152
    ds_read_b64_tr_b16 v[118:119], v215 offset:50176
    v_mfma_f32_16x16x32_bf16 v[68:71], v[132:135], v[100:103], v[68:71]
    s_waitcnt vmcnt(4)
    v_cmp_eq_u64 s[82:83], s[80:81], v[200:201]
    s_nop 0
    s_cmp_lg_u32 s82, -1
    s_cbranch_scc1 Lpolly3
Lpolly3_r:
    buffer_load_dwordx4 v[8:11], v218, s[32:35], s64 offen offset:1024 sc1
    v_mfma_f32_16x16x32_bf16 v[64:67], v[128:131], v[100:103], v[64:67]
    buffer_load_dwordx4 v[12:15], v219, s[32:35], s64 offen offset:1024 sc1
    v_mfma_f32_16x16x32_bf16 v[60:63], v[124:127], v[100:103], v[60:63]
    v_mfma_f32_16x16x32_bf16 v[56:59], v[120:123], v[100:103], v[56:59]
    s_waitcnt vmcnt(8) lgkmcnt(0)
    v_mfma_f32_16x16x32_bf16 v[40:43], v[104:107], v[136:139], v[40:43]
    ds_read_b64_tr_b16 v[120:121], v212 offset:53248
    ds_read_b64_tr_b16 v[122:123], v212 offset:54272
    v_mfma_f32_16x16x32_bf16 v[44:47], v[108:111], v[136:139], v[44:47]
    ds_read_b64_tr_b16 v[124:125], v213 offset:53248
    ds_read_b64_tr_b16 v[126:127], v213 offset:54272
    v_mfma_f32_16x16x32_bf16 v[48:51], v[112:115], v[136:139], v[48:51]
    ds_read_b64_tr_b16 v[128:129], v214 offset:53248
    ds_read_b64_tr_b16 v[130:131], v214 offset:54272
    v_mfma_f32_16x16x32_bf16 v[52:55], v[116:119], v[136:139], v[52:55]
    ds_read_b64_tr_b16 v[132:133], v215 offset:53248
    ds_read_b64_tr_b16 v[134:135], v215 offset:54272
    v_mfma_f32_16x16x32_bf16 v[68:71], v[116:119], v[140:143], v[68:71]
    buffer_load_dwordx4 v[16:19], v218, s[32:35], s65 offen offset:1024 sc1
    v_mfma_f32_16x16x32_bf16 v[64:67], v[112:115], v[140:143], v[64:67]
    buffer_load_dwordx4 v[20:23], v219, s[32:35], s65 offen offset:1024 sc1
    v_mfma_f32_16x16x32_bf16 v[60:63], v[108:111], v[140:143], v[60:63]
    v_mfma_f32_16x16x32_bf16 v[56:59], v[104:107], v[140:143], v[56:59]
    s_waitcnt vmcnt(8) lgkmcnt(0)
    v_mfma_f32_16x16x32_bf16 v[40:43], v[120:123], v[144:147], v[40:43]
    ds_read_b64_tr_b16 v[104:105], v212 offset:57344
    ds_read_b64_tr_b16 v[106:107], v212 offset:58368
    v_mfma_f32_16x16x32_bf16 v[44:47], v[124:127], v[144:147], v[44:47]
    ds_read_b64_tr_b16 v[108:109], v213 offset:57344
    ds_read_b64_tr_b16 v[110:111], v213 offset:58368
    v_mfma_f32_16x16x32_bf16 v[48:51], v[128:131], v[144:147], v[48:51]
    ds_read_b64_tr_b16 v[112:113], v214 offset:57344
    ds_read_b64_tr_b16 v[114:115], v214 offset:58368
    v_mfma_f32_16x16x32_bf16 v[52:55], v[132:135], v[144:147], v[52:55]
    ds_read_b64_tr_b16 v[116:117], v215 offset:57344
    ds_read_b64_tr_b16 v[118:119], v215 offset:58368
    v_mfma_f32_16x16x32_bf16 v[68:71], v[132:135], v[148:151], v[68:71]
    buffer_load_dwordx4 v[24:27], v218, s[32:35], s66 offen offset:1024 sc1
    v_mfma_f32_16x16x32_bf16 v[64:67], v[128:131], v[148:151], v[64:67]
    buffer_load_dwordx4 v[28:31], v219, s[32:35], s66 offen offset:1024 sc1
    v_mfma_f32_16x16x32_bf16 v[60:63], v[124:127], v[148:151], v[60:63]
    v_mfma_f32_16x16x32_bf16 v[56:59], v[120:123], v[148:151], v[56:59]
    s_waitcnt vmcnt(8) lgkmcnt(0)
    v_mfma_f32_16x16x32_bf16 v[40:43], v[104:107], v[152:155], v[40:43]
    ds_read_b64_tr_b16 v[120:121], v212 offset:61440
    ds_read_b64_tr_b16 v[122:123], v212 offset:62464
    v_mfma_f32_16x16x32_bf16 v[44:47], v[108:111], v[152:155], v[44:47]
    ds_read_b64_tr_b16 v[124:125], v213 offset:61440
    ds_read_b64_tr_b16 v[126:127], v213 offset:62464
    v_mfma_f32_16x16x32_bf16 v[48:51], v[112:115], v[152:155], v[48:51]
    ds_read_b64_tr_b16 v[128:129], v214 offset:61440
    ds_read_b64_tr_b16 v[130:131], v214 offset:62464
    v_mfma_f32_16x16x32_bf16 v[52:55], v[116:119], v[152:155], v[52:55]
    ds_read_b64_tr_b16 v[132:133], v215 offset:61440
    ds_read_b64_tr_b16 v[134:135], v215 offset:62464
    v_mfma_f32_16x16x32_bf16 v[68:71], v[116:119], v[156:159], v[68:71]
    buffer_load_dwordx4 v[32:35], v218, s[32:35], s67 offen offset:1024 sc1
    v_mfma_f32_16x16x32_bf16 v[64:67], v[112:115], v[156:159], v[64:67]
    buffer_load_dwordx4 v[36:39], v219, s[32:35], s67 offen offset:1024 sc1
    v_mfma_f32_16x16x32_bf16 v[60:63], v[108:111], v[156:159], v[60:63]
    v_mfma_f32_16x16x32_bf16 v[56:59], v[104:107], v[156:159], v[56:59]
    s_waitcnt vmcnt(8) lgkmcnt(0)
    v_mfma_f32_16x16x32_bf16 v[40:43], v[120:123], v[160:163], v[40:43]
    ds_read_b64_tr_b16 v[104:105], v212 offset:0
    ds_read_b64_tr_b16 v[106:107], v212 offset:1024
    v_mfma_f32_16x16x32_bf16 v[44:47], v[124:127], v[160:163], v[44:47]
    ds_read_b64_tr_b16 v[108:109], v213 offset:0
    ds_read_b64_tr_b16 v[110:111], v213 offset:1024
    v_mfma_f32_16x16x32_bf16 v[48:51], v[128:131], v[160:163], v[48:51]
    ds_read_b64_tr_b16 v[112:113], v214 offset:0
    ds_read_b64_tr_b16 v[114:115], v214 offset:1024
    v_mfma_f32_16x16x32_bf16 v[52:55], v[132:135], v[160:163], v[52:55]
    ds_read_b64_tr_b16 v[116:117], v215 offset:0
    ds_read_b64_tr_b16 v[118:119], v215 offset:1024
    v_mfma_f32_16x16x32_bf16 v[68:71], v[132:135], v[164:167], v[68:71]
    buffer_load_dwordx4 v[224:227], v218, s[32:35], s68 offen offset:1024 sc1
    v_mfma_f32_16x16x32_bf16 v[64:67], v[128:131], v[164:167], v[64:67]
    buffer_load_dwordx4 v[228:231], v219, s[32:35], s68 offen offset:1024 sc1
    v_mfma_f32_16x16x32_bf16 v[60:63], v[124:127], v[164:167], v[60:63]
    v_mfma_f32_16x16x32_bf16 v[56:59], v[120:123], v[164:167], v[56:59]
    s_waitcnt vmcnt(8) lgkmcnt(0)
    v_mfma_f32_16x16x32_bf16 v[40:43], v[104:107], v[8:11], v[40:43]
    ds_read_b64_tr_b16 v[120:121], v212 offset:4096
    ds_read_b64_tr_b16 v[122:123], v212 offset:5120
    v_mfma_f32_16x16x32_bf16 v[44:47], v[108:111], v[8:11], v[44:47]
    ds_read_b64_tr_b16 v[124:125], v213 offset:4096
    ds_read_b64_tr_b16 v[126:127], v213 offset:5120
    v_mfma_f32_16x16x32_bf16 v[48:51], v[112:115], v[8:11], v[48:51]
    ds_read_b64_tr_b16 v[128:129], v214 offset:4096
    ds_read_b64_tr_b16 v[130:131], v214 offset:5120
    v_mfma_f32_16x16x32_bf16 v[52:55], v[116:119], v[8:11], v[52:55]
    ds_read_b64_tr_b16 v[132:133], v215 offset:4096
    ds_read_b64_tr_b16 v[134:135], v215 offset:5120
    v_mfma_f32_16x16x32_bf16 v[68:71], v[116:119], v[12:15], v[68:71]
    buffer_load_dwordx4 v[232:235], v218, s[32:35], s69 offen offset:1024 sc1
    v_mfma_f32_16x16x32_bf16 v[64:67], v[112:115], v[12:15], v[64:67]
    buffer_load_dwordx4 v[236:239], v219, s[32:35], s69 offen offset:1024 sc1
    v_mfma_f32_16x16x32_bf16 v[60:63], v[108:111], v[12:15], v[60:63]
    v_mfma_f32_16x16x32_bf16 v[56:59], v[104:107], v[12:15], v[56:59]
    s_waitcnt vmcnt(8) lgkmcnt(0)
    v_mfma_f32_16x16x32_bf16 v[40:43], v[120:123], v[16:19], v[40:43]
    ds_read_b64_tr_b16 v[104:105], v212 offset:8192
    ds_read_b64_tr_b16 v[106:107], v212 offset:9216
    v_mfma_f32_16x16x32_bf16 v[44:47], v[124:127], v[16:19], v[44:47]
    ds_read_b64_tr_b16 v[108:109], v213 offset:8192
    ds_read_b64_tr_b16 v[110:111], v213 offset:9216
    v_mfma_f32_16x16x32_bf16 v[48:51], v[128:131], v[16:19], v[48:51]
    ds_read_b64_tr_b16 v[112:113], v214 offset:8192
    ds_read_b64_tr_b16 v[114:115], v214 offset:9216
    v_mfma_f32_16x16x32_bf16 v[52:55], v[132:135], v[16:19], v[52:55]
    ds_read_b64_tr_b16 v[116:117], v215 offset:8192
    ds_read_b64_tr_b16 v[118:119], v215 offset:9216
    v_mfma_f32_16x16x32_bf16 v[68:71], v[132:135], v[20:23], v[68:71]
    buffer_load_dwordx4 v[240:243], v218, s[32:35], s70 offen offset:1024 sc1
    v_mfma_f32_16x16x32_bf16 v[64:67], v[128:131], v[20:23], v[64:67]
    buffer_load_dwordx4 v[244:247], v219, s[32:35], s70 offen offset:1024 sc1
    v_mfma_f32_16x16x32_bf16 v[60:63], v[124:127], v[20:23], v[60:63]
    v_mfma_f32_16x16x32_bf16 v[56:59], v[120:123], v[20:23], v[56:59]
    s_waitcnt vmcnt(8) lgkmcnt(0)
    v_mfma_f32_16x16x32_bf16 v[40:43], v[104:107], v[24:27], v[40:43]
    ds_read_b64_tr_b16 v[120:121], v212 offset:12288
    ds_read_b64_tr_b16 v[122:123], v212 offset:13312
    v_mfma_f32_16x16x32_bf16 v[44:47], v[108:111], v[24:27], v[44:47]
    ds_read_b64_tr_b16 v[124:125], v213 offset:12288
    ds_read_b64_tr_b16 v[126:127], v213 offset:13312
    v_mfma_f32_16x16x32_bf16 v[48:51], v[112:115], v[24:27], v[48:51]
    ds_read_b64_tr_b16 v[128:129], v214 offset:12288
    ds_read_b64_tr_b16 v[130:131], v214 offset:13312
    v_mfma_f32_16x16x32_bf16 v[52:55], v[116:119], v[24:27], v[52:55]
    ds_read_b64_tr_b16 v[132:133], v215 offset:12288
    ds_read_b64_tr_b16 v[134:135], v215 offset:13312
    v_mfma_f32_16x16x32_bf16 v[68:71], v[116:119], v[28:31], v[68:71]
    buffer_load_dwordx4 v[248:251], v218, s[32:35], s71 offen offset:1024 sc1
    v_mfma_f32_16x16x32_bf16 v[64:67], v[112:115], v[28:31], v[64:67]
    buffer_load_dwordx4 v[252:255], v219, s[32:35], s71 offen offset:1024 sc1
    v_mfma_f32_16x16x32_bf16 v[60:63], v[108:111], v[28:31], v[60:63]
    v_mfma_f32_16x16x32_bf16 v[56:59], v[104:107], v[28:31], v[56:59]
    v_add_u32 v212, 131072, v212
    v_add_u32 v213, 131072, v213
    v_add_u32 v214, 131072, v214
    v_add_u32 v215, 131072, v215
    s_waitcnt vmcnt(8) lgkmcnt(0)
    v_mfma_f32_16x16x32_bf16 v[40:43], v[120:123], v[32:35], v[40:43]
    ds_read_b64_tr_b16 v[104:105], v212 offset:0
    ds_read_b64_tr_b16 v[106:107], v212 offset:1024
    v_mfma_f32_16x16x32_bf16 v[44:47], v[124:127], v[32:35], v[44:47]
    ds_read_b64_tr_b16 v[108:109], v213 offset:0
    ds_read_b64_tr_b16 v[110:111], v213 offset:1024
    v_mfma_f32_16x16x32_bf16 v[48:51], v[128:131], v[32:35], v[48:51]
    ds_read_b64_tr_b16 v[112:113], v214 offset:0
    ds_read_b64_tr_b16 v[114:115], v214 offset:1024
    v_mfma_f32_16x16x32_bf16 v[52:55], v[132:135], v[32:35], v[52:55]
    ds_read_b64_tr_b16 v[116:117], v215 offset:0
    ds_read_b64_tr_b16 v[118:119], v215 offset:1024
    v_mfma_f32_16x16x32_bf16 v[68:71], v[132:135], v[36:39], v[68:71]
    v_mfma_f32_16x16x32_bf16 v[64:67], v[128:131], v[36:39], v[64:67]
    v_mfma_f32_16x16x32_bf16 v[60:63], v[124:127], v[36:39], v[60:63]
    v_mfma_f32_16x16x32_bf16 v[56:59], v[120:123], v[36:39], v[56:59]
    s_waitcnt vmcnt(6) lgkmcnt(0)
    v_mfma_f32_16x16x32_bf16 v[40:43], v[104:107], v[224:227], v[40:43]
    ds_read_b64_tr_b16 v[120:121], v212 offset:4096
    ds_read_b64_tr_b16 v[122:123], v212 offset:5120
    v_mfma_f32_16x16x32_bf16 v[44:47], v[108:111], v[224:227], v[44:47]
    ds_read_b64_tr_b16 v[124:125], v213 offset:4096
    ds_read_b64_tr_b16 v[126:127], v213 offset:5120
    v_mfma_f32_16x16x32_bf16 v[48:51], v[112:115], v[224:227], v[48:51]
    ds_read_b64_tr_b16 v[128:129], v214 offset:4096
    ds_read_b64_tr_b16 v[130:131], v214 offset:5120
    v_mfma_f32_16x16x32_bf16 v[52:55], v[116:119], v[224:227], v[52:55]
    ds_read_b64_tr_b16 v[132:133], v215 offset:4096
    ds_read_b64_tr_b16 v[134:135], v215 offset:5120
    v_mfma_f32_16x16x32_bf16 v[68:71], v[116:119], v[228:231], v[68:71]
    v_mfma_f32_16x16x32_bf16 v[64:67], v[112:115], v[228:231], v[64:67]
    v_mfma_f32_16x16x32_bf16 v[60:63], v[108:111], v[228:231], v[60:63]
    v_mfma_f32_16x16x32_bf16 v[56:59], v[104:107], v[228:231], v[56:59]
    s_waitcnt vmcnt(4) lgkmcnt(0)
    v_mfma_f32_16x16x32_bf16 v[40:43], v[120:123], v[232:235], v[40:43]
    ds_read_b64_tr_b16 v[104:105], v212 offset:8192
    ds_read_b64_tr_b16 v[106:107], v212 offset:9216
    v_mfma_f32_16x16x32_bf16 v[44:47], v[124:127], v[232:235], v[44:47]
    ds_read_b64_tr_b16 v[108:109], v213 offset:8192
    ds_read_b64_tr_b16 v[110:111], v213 offset:9216
    v_mfma_f32_16x16x32_bf16 v[48:51], v[128:131], v[232:235], v[48:51]
    ds_read_b64_tr_b16 v[112:113], v214 offset:8192
    ds_read_b64_tr_b16 v[114:115], v214 offset:9216
    v_mfma_f32_16x16x32_bf16 v[52:55], v[132:135], v[232:235], v[52:55]
    ds_read_b64_tr_b16 v[116:117], v215 offset:8192
    ds_read_b64_tr_b16 v[118:119], v215 offset:9216
    v_mfma_f32_16x16x32_bf16 v[68:71], v[132:135], v[236:239], v[68:71]
    v_mfma_f32_16x16x32_bf16 v[64:67], v[128:131], v[236:239], v[64:67]
    v_mfma_f32_16x16x32_bf16 v[60:63], v[124:127], v[236:239], v[60:63]
    v_mfma_f32_16x16x32_bf16 v[56:59], v[120:123], v[236:239], v[56:59]
    s_waitcnt vmcnt(2) lgkmcnt(0)
    v_mfma_f32_16x16x32_bf16 v[40:43], v[104:107], v[240:243], v[40:43]
    ds_read_b64_tr_b16 v[120:121], v212 offset:12288
    ds_read_b64_tr_b16 v[122:123], v212 offset:13312
    v_mfma_f32_16x16x32_bf16 v[44:47], v[108:111], v[240:243], v[44:47]
    ds_read_b64_tr_b16 v[124:125], v213 offset:12288
    ds_read_b64_tr_b16 v[126:127], v213 offset:13312
    v_mfma_f32_16x16x32_bf16 v[48:51], v[112:115], v[240:243], v[48:51]
    ds_read_b64_tr_b16 v[128:129], v214 offset:12288
    ds_read_b64_tr_b16 v[130:131], v214 offset:13312
    v_mfma_f32_16x16x32_bf16 v[52:55], v[116:119], v[240:243], v[52:55]
    ds_read_b64_tr_b16 v[132:133], v215 offset:12288
    ds_read_b64_tr_b16 v[134:135], v215 offset:13312
    v_mfma_f32_16x16x32_bf16 v[68:71], v[116:119], v[244:247], v[68:71]
    v_mfma_f32_16x16x32_bf16 v[64:67], v[112:115], v[244:247], v[64:67]
    v_mfma_f32_16x16x32_bf16 v[60:63], v[108:111], v[244:247], v[60:63]
    v_mfma_f32_16x16x32_bf16 v[56:59], v[104:107], v[244:247], v[56:59]
    s_waitcnt vmcnt(0) lgkmcnt(0)
    v_mfma_f32_16x16x32_bf16 v[40:43], v[120:123], v[248:251], v[40:43]
    v_mfma_f32_16x16x32_bf16 v[44:47], v[124:127], v[248:251], v[44:47]
    v_mfma_f32_16x16x32_bf16 v[48:51], v[128:131], v[248:251], v[48:51]
    v_mfma_f32_16x16x32_bf16 v[52:55], v[132:135], v[248:251], v[52:55]
    v_mfma_f32_16x16x32_bf16 v[68:71], v[132:135], v[252:255], v[68:71]
    v_mfma_f32_16x16x32_bf16 v[64:67], v[128:131], v[252:255], v[64:67]
    v_mfma_f32_16x16x32_bf16 v[60:63], v[124:127], v[252:255], v[60:63]
    v_mfma_f32_16x16x32_bf16 v[56:59], v[120:123], v[252:255], v[56:59]
Lproj_e:
    v_lshrrev_b32 v4, 4, v1
    v_and_b32 v2, 15, v1
    v_lshlrev_b32 v2, 12, v2
    v_and_b32 v3, 1, v4
    v_lshl_add_u32 v2, v3, 5, v2
    v_lshrrev_b32 v3, 1, v4
    v_lshl_add_u32 v2, v3, 4, v2
    s_mov_b32 s26, 65536
    s_nop 3
    v_cvt_pk_bf16_f32 v168, v40, v41
    v_cvt_pk_bf16_f32 v169, v42, v43
    v_cvt_pk_bf16_f32 v170, v44, v45
    v_cvt_pk_bf16_f32 v171, v46, v47
    s_nop 1
    v_permlane16_swap_b32 v168, v170
    v_permlane16_swap_b32 v169, v171
    buffer_store_dwordx4 v[168:171], v2, s[36:39], 0 offen offset:0 nt
    v_cvt_pk_bf16_f32 v172, v48, v49
    v_cvt_pk_bf16_f32 v173, v50, v51
    v_cvt_pk_bf16_f32 v174, v52, v53
    v_cvt_pk_bf16_f32 v175, v54, v55
    s_nop 1
    v_permlane16_swap_b32 v172, v174
    v_permlane16_swap_b32 v173, v175
    buffer_store_dwordx4 v[172:175], v2, s[36:39], 0 offen offset:64 nt
    v_cvt_pk_bf16_f32 v176, v56, v57
    v_cvt_pk_bf16_f32 v177, v58, v59
    v_cvt_pk_bf16_f32 v178, v60, v61
    v_cvt_pk_bf16_f32 v179, v62, v63
    s_nop 1
    v_permlane16_swap_b32 v176, v178
    v_permlane16_swap_b32 v177, v179
    buffer_store_dwordx4 v[176:179], v2, s[36:39], s26 offen offset:0 nt
    v_cvt_pk_bf16_f32 v180, v64, v65
    v_cvt_pk_bf16_f32 v181, v66, v67
    v_cvt_pk_bf16_f32 v182, v68, v69
    v_cvt_pk_bf16_f32 v183, v70, v71
    s_nop 1
    v_permlane16_swap_b32 v180, v182
    v_permlane16_swap_b32 v181, v183
    buffer_store_dwordx4 v[180:183], v2, s[36:39], s26 offen offset:64 nt
Lend:
    s_endpgm
Lspin_c1a:
    s_mov_b32 s91, 131072
Lspin_c1a_l:
    buffer_load_dwordx2 v[200:201], v202, s[8:11], s24 offen sc1
    s_waitcnt vmcnt(0)
    v_cmp_eq_u64 s[82:83], s[80:81], v[200:201]
    s_sub_u32 s91, s91, 1
    s_cbranch_scc1 Lspin_c1a_r
    s_lshr_b32 s26, s82, s90
    s_andn2_b32 s26, 0x11, s26
    s_cbranch_scc1 Lspin_c1a_l
    s_branch Lspin_c1a_r
Lspin_c1:
    s_mov_b32 s91, 131072
Lspin_c1_l:
    buffer_load_dwordx2 v[200:201], v202, s[8:11], s24 offen sc1
    s_waitcnt vmcnt(0)
    v_cmp_eq_u64 s[82:83], s[80:81], v[200:201]
    s_sub_u32 s91, s91, 1
    s_cbranch_scc1 Lspin_c1_r
    s_lshr_b32 s26, s82, s90
    s_andn2_b32 s26, 0x11, s26
    s_cbranch_scc1 Lspin_c1_l
    s_branch Lspin_c1_r
Lspin_loop:
    s_mov_b32 s91, 131072
Lspin_loop_l:
    buffer_load_dwordx2 v[200:201], v202, s[8:11], s24 offen sc1
    s_waitcnt vmcnt(0)
    v_cmp_eq_u64 s[82:83], s[80:81], v[200:201]
    s_sub_u32 s91, s91, 1
    s_cbranch_scc1 Lspin_loop_r
    s_lshr_b32 s26, s82, s90
    s_andn2_b32 s26, 0x11, s26
    s_cbranch_scc1 Lspin_loop_l
    s_branch Lspin_loop_r
Lspin_15:
    s_mov_b32 s91, 131072
Lspin_15_l:
    buffer_load_dwordx2 v[200:201], v202, s[8:11], s24 offen sc1
    s_waitcnt vmcnt(0)
    v_cmp_eq_u64 s[82:83], s[80:81], v[200:201]
    s_sub_u32 s91, s91, 1
    s_cbranch_scc1 Lspin_15_r
    s_lshr_b32 s26, s82, s90
    s_andn2_b32 s26, 0x11, s26
    s_cbranch_scc1 Lspin_15_l
    s_branch Lspin_15_r
Lnonce_spin:
    s_mov_b32 s91, 131072
Lnonce_l:
    buffer_load_dwordx2 v[222:223], v221, s[92:95], 0 offen sc1
    s_waitcnt vmcnt(0)
    v_readfirstlane_b32 s80, v222
    v_readfirstlane_b32 s81, v223
    s_sub_u32 s91, s91, 1
    s_cbranch_scc1 Lnonce_ok
    s_cmp_eq_u32 s80, 0
    s_cbranch_scc1 Lnonce_l
    s_branch Lnonce_ok
Lpollo0:
    s_mov_b32 s91, 131072
Lpollo0_l:
    buffer_load_dwordx2 v[200:201], v202, s[8:11], s24 offen sc1
    s_waitcnt vmcnt(0)
    v_cmp_eq_u64 s[82:83], s[80:81], v[200:201]
    s_sub_u32 s91, s91, 1
    s_cbranch_scc1 Lpollo0_r
    s_cmp_lg_u32 s82, -1
    s_cbranch_scc1 Lpollo0_l
    s_branch Lpollo0_r
Lpollo1:
    s_mov_b32 s91, 131072
Lpollo1_l:
    buffer_load_dwordx2 v[200:201], v202, s[8:11], s24 offen sc1
    s_waitcnt vmcnt(0)
    v_cmp_eq_u64 s[82:83], s[80:81], v[200:201]
    s_sub_u32 s91, s91, 1
    s_cbranch_scc1 Lpollo1_r
    s_cmp_lg_u32 s82, -1
    s_cbranch_scc1 Lpollo1_l
    s_branch Lpollo1_r
Lpollo2:
    s_mov_b32 s91, 131072
Lpollo2_l:
    buffer_load_dwordx2 v[200:201], v202, s[8:11], s24 offen sc1
    s_waitcnt vmcnt(0)
    v_cmp_eq_u64 s[82:83], s[80:81], v[200:201]
    s_sub_u32 s91, s91, 1
    s_cbranch_scc1 Lpollo2_r
    s_cmp_lg_u32 s82, -1
    s_cbranch_scc1 Lpollo2_l
    s_branch Lpollo2_r
Lpollo3:
    s_mov_b32 s91, 131072
Lpollo3_l:
    buffer_load_dwordx2 v[200:201], v202, s[8:11], s24 offen sc1
    s_waitcnt vmcnt(0)
    v_cmp_eq_u64 s[82:83], s[80:81], v[200:201]
    s_sub_u32 s91, s91, 1
    s_cbranch_scc1 Lpollo3_r
    s_cmp_lg_u32 s82, -1
    s_cbranch_scc1 Lpollo3_l
    s_branch Lpollo3_r
Lpolly0:
    s_mov_b32 s91, 131072
Lpolly0_l:
    buffer_load_dwordx2 v[200:201], v202, s[8:11], s24 offen sc1
    s_waitcnt vmcnt(0)
    v_cmp_eq_u64 s[82:83], s[80:81], v[200:201]
    s_sub_u32 s91, s91, 1
    s_cbranch_scc1 Lpolly0_r
    s_cmp_lg_u32 s82, -1
    s_cbranch_scc1 Lpolly0_l
    s_branch Lpolly0_r
Lpolly1:
    s_mov_b32 s91, 131072
Lpolly1_l:
    buffer_load_dwordx2 v[200:201], v202, s[8:11], s24 offen sc1
    s_waitcnt vmcnt(0)
    v_cmp_eq_u64 s[82:83], s[80:81], v[200:201]
    s_sub_u32 s91, s91, 1
    s_cbranch_scc1 Lpolly1_r
    s_cmp_lg_u32 s82, -1
    s_cbranch_scc1 Lpolly1_l
    s_branch Lpolly1_r
Lpolly2:
    s_mov_b32 s91, 131072
Lpolly2_l:
    buffer_load_dwordx2 v[200:201], v202, s[8:11], s24 offen sc1
    s_waitcnt vmcnt(0)
    v_cmp_eq_u64 s[82:83], s[80:81], v[200:201]
    s_sub_u32 s91, s91, 1
    s_cbranch_scc1 Lpolly2_r
    s_cmp_lg_u32 s82, -1
    s_cbranch_scc1 Lpolly2_l
    s_branch Lpolly2_r
Lpolly3:
    s_mov_b32 s91, 131072
Lpolly3_l:
    buffer_load_dwordx2 v[200:201], v202, s[8:11], s24 offen sc1
    s_waitcnt vmcnt(0)
    v_cmp_eq_u64 s[82:83], s[80:81], v[200:201]
    s_sub_u32 s91, s91, 1
    s_cbranch_scc1 Lpolly3_r
    s_cmp_lg_u32 s82, -1
    s_cbranch_scc1 Lpolly3_l
    s_branch Lpolly3_r
Lattn_fallback:
    s_waitcnt vmcnt(0) lgkmcnt(0)
    s_lshl_b32 s26, s17, 5
    s_lshl_b32 s28, s19, 1
    s_add_u32 s26, s26, s28
    s_lshr_b32 s28, s16, 2
    s_add_u32 s26, s26, s28
    s_lshl_b32 s30, s26, 18
    s_add_u32 s4, s48, s30
    s_addc_u32 s5, s49, 0
    s_and_b32 s5, s5, 0xffff
    s_mov_b32 s6, 262144
    s_mov_b32 s7, 0x00020000
    s_mov_b32 s91, 131072
    v_lshrrev_b32 v2, 3, v1
    v_lshl_add_u32 v2, v2, 7, v202
Lfb_poll:
    buffer_load_dwordx2 v[200:201], v2, s[8:11], 0 offen sc1
    s_waitcnt vmcnt(0)
    v_cmp_eq_u64 vcc, s[80:81], v[200:201]
    s_sub_u32 s91, s91, 1
    s_cbranch_scc1 Lfb_go
    s_cmp_eq_u64 vcc, -1
    s_cbranch_scc0 Lfb_poll
Lfb_go:
    v_mov_b32 v224, 0
    v_mov_b32 v225, 0
    v_mov_b32 v226, 0
    v_mov_b32 v227, 0
    v_mov_b32 v228, 0
    v_mov_b32 v229, 0
    v_mov_b32 v230, 0
    v_mov_b32 v231, 0
    v_mov_b32 v232, 0
    v_mov_b32 v233, 0
    v_mov_b32 v234, 0
    v_mov_b32 v235, 0
    v_mov_b32 v236, 0
    v_mov_b32 v237, 0
    v_mov_b32 v238, 0
    v_mov_b32 v239, 0
    v_mov_b32 v240, 0
    v_mov_b32 v241, 0
    v_mov_b32 v242, 0
    v_mov_b32 v243, 0
    v_mov_b32 v244, 0
    v_mov_b32 v245, 0
    v_mov_b32 v246, 0
    v_mov_b32 v247, 0
    v_mov_b32 v248, 0
    v_mov_b32 v249, 0
    v_mov_b32 v250, 0
    v_mov_b32 v251, 0
    v_mov_b32 v252, 0
    v_mov_b32 v253, 0
    v_mov_b32 v254, 0
    v_mov_b32 v255, 0
    v_mov_b32 v184, 0
    v_mov_b32 v185, 0
    v_mov_b32 v186, 0
    v_mov_b32 v187, 0
    v_mov_b32 v188, 0
    v_mov_b32 v189, 0
    v_mov_b32 v190, 0
    v_mov_b32 v191, 0
    v_mov_b32 v120, 0xff800000
    v_mov_b32 v136, 0xff800000
    s_mov_b32 s26, 0
Lfb_loop:
    buffer_load_dwordx4 v[152:155], v206, s[4:7], s26 offen offset:0 sc1
    buffer_load_dwordx4 v[156:159], v206, s[4:7], s26 offen offset:1024 sc1
    buffer_load_dwordx4 v[168:171], v198, s[4:7], s26 offen offset:2048 sc1
    buffer_load_dwordx4 v[172:175], v198, s[4:7], s26 offen offset:3072 sc1
    s_waitcnt vmcnt(0)
    v_mfma_f32_32x32x16_bf16 v[8:23], v[152:155], v[104:107], 0
    v_mfma_f32_32x32x16_bf16 v[8:23], v[156:159], v[108:111], v[8:23]
    s_nop 15
    v_max3_f32 v2, v8, v9, v10
    v_max3_f32 v2, v2, v11, v12
    v_max3_f32 v2, v2, v13, v14
    v_max3_f32 v2, v2, v15, v16
    v_max3_f32 v2, v2, v17, v18
    v_max3_f32 v2, v2, v19, v20
    v_max3_f32 v2, v2, v21, v22
    v_max_f32 v2, v2, v23
    v_mov_b32 v3, v2
    s_nop 1
    v_permlane32_swap_b32 v2, v3
    s_nop 0
    v_max_f32 v2, v2, v3
    v_max_f32 v2, v2, v120
    v_sub_f32 v3, v120, v2
    v_exp_f32 v3, v3
    v_mov_b32 v120, v2
    v_sub_f32 v8, v8, v2
    v_sub_f32 v9, v9, v2
    v_sub_f32 v10, v10, v2
    v_sub_f32 v11, v11, v2
    v_sub_f32 v12, v12, v2
    v_sub_f32 v13, v13, v2
    v_sub_f32 v14, v14, v2
    v_sub_f32 v15, v15, v2
    v_sub_f32 v16, v16, v2
    v_sub_f32 v17, v17, v2
    v_sub_f32 v18, v18, v2
    v_sub_f32 v19, v19, v2
    v_sub_f32 v20, v20, v2
    v_sub_f32 v21, v21, v2
    v_sub_f32 v22, v22, v2
    v_sub_f32 v23, v23, v2
    v_exp_f32 v8, v8
    v_exp_f32 v9, v9
    v_exp_f32 v10, v10
    v_exp_f32 v11, v11
    v_exp_f32 v12, v12
    v_exp_f32 v13, v13
    v_exp_f32 v14, v14
    v_exp_f32 v15, v15
    v_exp_f32 v16, v16
    v_exp_f32 v17, v17
    v_exp_f32 v18, v18
    v_exp_f32 v19, v19
    v_exp_f32 v20, v20
    v_exp_f32 v21, v21
    v_exp_f32 v22, v22
    v_exp_f32 v23, v23
    v_mul_f32 v224, v3, v224
    v_mul_f32 v225, v3, v225
    v_mul_f32 v226, v3, v226
    v_mul_f32 v227, v3, v227
    v_mul_f32 v228, v3, v228
    v_mul_f32 v229, v3, v229
    v_mul_f32 v230, v3, v230
    v_mul_f32 v231, v3, v231
    v_mul_f32 v232, v3, v232
    v_mul_f32 v233, v3, v233
    v_mul_f32 v234, v3, v234
    v_mul_f32 v235, v3, v235
    v_mul_f32 v236, v3, v236
    v_mul_f32 v237, v3, v237
    v_mul_f32 v238, v3, v238
    v_mul_f32 v239, v3, v239
    v_mul_f32 v184, v3, v184
    v_mul_f32 v185, v3, v185
    v_mul_f32 v186, v3, v186
    v_mul_f32 v187, v3, v187
    s_nop 1
    v_smfmac_f32_32x32x32_bf16 v[224:239], v[168:171], v[8:15], v196
    v_smfmac_f32_16x16x64_bf16 v[184:187], v[192:195], v[8:15], v196
    v_smfmac_f32_32x32x32_bf16 v[224:239], v[172:175], v[16:23], v196
    v_smfmac_f32_16x16x64_bf16 v[184:187], v[192:195], v[16:23], v196
    s_nop 15
    v_mfma_f32_32x32x16_bf16 v[8:23], v[152:155], v[112:115], 0
    v_mfma_f32_32x32x16_bf16 v[8:23], v[156:159], v[116:119], v[8:23]
    s_nop 15
    v_max3_f32 v2, v8, v9, v10
    v_max3_f32 v2, v2, v11, v12
    v_max3_f32 v2, v2, v13, v14
    v_max3_f32 v2, v2, v15, v16
    v_max3_f32 v2, v2, v17, v18
    v_max3_f32 v2, v2, v19, v20
    v_max3_f32 v2, v2, v21, v22
    v_max_f32 v2, v2, v23
    v_mov_b32 v3, v2
    s_nop 1
    v_permlane32_swap_b32 v2, v3
    s_nop 0
    v_max_f32 v2, v2, v3
    v_max_f32 v2, v2, v136
    v_sub_f32 v3, v136, v2
    v_exp_f32 v3, v3
    v_mov_b32 v136, v2
    v_sub_f32 v8, v8, v2
    v_sub_f32 v9, v9, v2
    v_sub_f32 v10, v10, v2
    v_sub_f32 v11, v11, v2
    v_sub_f32 v12, v12, v2
    v_sub_f32 v13, v13, v2
    v_sub_f32 v14, v14, v2
    v_sub_f32 v15, v15, v2
    v_sub_f32 v16, v16, v2
    v_sub_f32 v17, v17, v2
    v_sub_f32 v18, v18, v2
    v_sub_f32 v19, v19, v2
    v_sub_f32 v20, v20, v2
    v_sub_f32 v21, v21, v2
    v_sub_f32 v22, v22, v2
    v_sub_f32 v23, v23, v2
    v_exp_f32 v8, v8
    v_exp_f32 v9, v9
    v_exp_f32 v10, v10
    v_exp_f32 v11, v11
    v_exp_f32 v12, v12
    v_exp_f32 v13, v13
    v_exp_f32 v14, v14
    v_exp_f32 v15, v15
    v_exp_f32 v16, v16
    v_exp_f32 v17, v17
    v_exp_f32 v18, v18
    v_exp_f32 v19, v19
    v_exp_f32 v20, v20
    v_exp_f32 v21, v21
    v_exp_f32 v22, v22
    v_exp_f32 v23, v23
    v_mul_f32 v240, v3, v240
    v_mul_f32 v241, v3, v241
    v_mul_f32 v242, v3, v242
    v_mul_f32 v243, v3, v243
    v_mul_f32 v244, v3, v244
    v_mul_f32 v245, v3, v245
    v_mul_f32 v246, v3, v246
    v_mul_f32 v247, v3, v247
    v_mul_f32 v248, v3, v248
    v_mul_f32 v249, v3, v249
    v_mul_f32 v250, v3, v250
    v_mul_f32 v251, v3, v251
    v_mul_f32 v252, v3, v252
    v_mul_f32 v253, v3, v253
    v_mul_f32 v254, v3, v254
    v_mul_f32 v255, v3, v255
    v_mul_f32 v188, v3, v188
    v_mul_f32 v189, v3, v189
    v_mul_f32 v190, v3, v190
    v_mul_f32 v191, v3, v191
    s_nop 1
    v_smfmac_f32_32x32x32_bf16 v[240:255], v[168:171], v[8:15], v196
    v_smfmac_f32_16x16x64_bf16 v[188:191], v[192:195], v[8:15], v196
    v_smfmac_f32_32x32x32_bf16 v[240:255], v[172:175], v[16:23], v196
    v_smfmac_f32_16x16x64_bf16 v[188:191], v[192:195], v[16:23], v196
    s_nop 15
    s_add_u32 s26, s26, 4096
    s_cmp_lt_u32 s26, 262144
    s_cbranch_scc1 Lfb_loop
    s_branch Lattn_fin
Lcode_end:
.section .rodata,"a"
.p2align 6
.amdhsa_kernel concat_heads__mha_block__softmax_full_mha__prompt_kernel
  .amdhsa_next_free_vgpr 256
  .amdhsa_next_free_sgpr 96
  .amdhsa_accum_offset 256
  .amdhsa_group_segment_fixed_size 0
  .amdhsa_kernarg_size 72
  .amdhsa_user_sgpr_count 2
  .amdhsa_user_sgpr_kernarg_segment_ptr 1
  .amdhsa_system_sgpr_workgroup_id_x 1
  .amdhsa_float_denorm_mode_32 3
.end_amdhsa_kernel
```
